```python
import torch

def _softmax(x, axis=-1):
    return torch.softmax(x, dim=axis)
def _gelu(x):
    return torch.nn.functional.gelu(x, approximate="tanh")
def _silu(x):
    return torch.nn.functional.silu(x)
def _sigmoid(x):
    return torch.sigmoid(x)
def _layernorm(x, axis=-1, eps=1e-5):
    m = x.mean(dim=axis, keepdim=True)
    v = x.var(dim=axis, keepdim=True, unbiased=False)
    return (x - m) / torch.sqrt(v + eps)
def _scatter_add(tgt, idx, src, axis=0):
    return tgt.clone().index_add_(axis, idx, src)
def _segment_sum(src, seg, n):
    out = torch.zeros((n,) + src.shape[1:], dtype=src.dtype)
    return out.index_add_(0, seg, src)
def _pad(x, pw):
    flat = tuple(v for pair in reversed(pw) for v in pair)
    return torch.nn.functional.pad(x, flat)

kernel_name = 'recurrent_scan__grouped_kv_mqa__dense_activation_squared_relu__prompt'

def setup_inputs():

    _w = (lambda a: (lambda t: t.to(torch.bfloat16) if t.is_floating_point() else t)(torch.as_tensor(a)))
    def _A_setup():
        B, S, D, H = 1, 2048, 512, 32
        Dh = D // H
        return {
            "x": _w((lambda *s: torch.randn(*s, dtype=torch.bfloat16) * 0.05)(B, S, D)),
            "wq": _w((lambda *s: torch.randn(*s, dtype=torch.bfloat16) * 0.05)(D, H * Dh)),
            "wk": _w((lambda *s: torch.randn(*s, dtype=torch.bfloat16) * 0.05)(D, Dh)),
            "wv": _w((lambda *s: torch.randn(*s, dtype=torch.bfloat16) * 0.05)(D, Dh)),
            "wo": _w((lambda *s: torch.randn(*s, dtype=torch.bfloat16) * 0.05)(H * Dh, D)),
        }
    _A_in = _A_setup()

    def _B_setup():
        B, S, D, F = 1, 2048, 512, 1792
        return {
            "x": _w((lambda *s: torch.randn(*s, dtype=torch.bfloat16) * 0.05)(B, S, D)),
            "w1": _w((lambda *s: torch.randn(*s, dtype=torch.bfloat16) * 0.05)(D, F)),
            "b1": _w((lambda *s: torch.randn(*s, dtype=torch.bfloat16) * 0.4)(F)),
            "w2": _w((lambda *s: torch.randn(*s, dtype=torch.bfloat16) * 0.05)(F, D)),
            "b2": _w((lambda *s: torch.randn(*s, dtype=torch.bfloat16) * 1.6)(D)),
        }
    _B_in = _B_setup()

    return {
        "A_x": _A_in["x"],
        "A_wq": _A_in["wq"],
        "A_wk": _A_in["wk"],
        "A_wv": _A_in["wv"],
        "A_wo": _A_in["wo"],
        "B_x": _B_in["x"],
        "B_w1": _B_in["w1"],
        "B_b1": _B_in["b1"],
        "B_w2": _B_in["w2"],
        "B_b2": _B_in["b2"],
    }

def reference(A_x, A_wq, A_wk, A_wv, A_wo, B_x, B_w1, B_b1, B_w2, B_b2):
    def _A_ref(x, wq, wk, wv, wo):
        B, S, D = x.shape
        H = 32
        Dh = D // H
        q = (lambda x, *d: x.permute(*d))((x @ wq).reshape(B, S, H, Dh), 0, 2, 1, 3)
        k = x @ wk
        v = x @ wv
        scores = torch.einsum("bhqd,bkd->bhqk", q, k) * (Dh ** -0.5)
        p = _softmax(scores, axis=-1)
        o = torch.einsum("bhqk,bkd->bhqd", p, v)
        return (lambda x, *d: x.permute(*d))(o, 0, 2, 1, 3).reshape(B, S, H * Dh) @ wo

    def _B_ref(x, w1, b1, w2, b2):
        h = torch.einsum("bsd,df->bsf", x, w1) + b1
        zero = torch.zeros_like(h)
        r = torch.where(h > zero, h, zero)
        h = r * r
        out = torch.einsum("bsf,fd->bsd", h, w2) + b2
        return out

    x = A_x
    xn = _layernorm(x, axis=-1)
    s = _A_ref(xn, A_wq, A_wk, A_wv, A_wo)
    g = _silu(_B_ref(xn, B_w1, B_b1, B_w2, B_b2))
    return x + s * g
```

```asm
; @launch grid=(256,1,1) block=(512,1,1) lds=163136
.amdgcn_target "amdgcn-amd-amdhsa--gfx950"
.text
.globl recurrent_scan__grouped_kv_mqa__dense_activation_squared_relu__prompt_kernel
.p2align 8
.type recurrent_scan__grouped_kv_mqa__dense_activation_squared_relu__prompt_kernel,@function
recurrent_scan__grouped_kv_mqa__dense_activation_squared_relu__prompt_kernel:
    s_load_dwordx2 s[8:9], s[0:1], 0
    s_load_dwordx2 s[44:45], s[0:1], 96
    v_lshrrev_b32 v2, 6, v0
    s_cmpk_ge_u32 s2, 256
    s_cbranch_scc1 L_end
    v_readfirstlane_b32 s3, v2
    s_lshr_b32 s60, s2, 3
    s_getpc_b64 s[48:49]
    s_mul_i32 s62, s60, 1408
    v_lshl_add_u32 v3, v0, 7, s62
    v_min_u32 v3, L_end-recurrent_scan__grouped_kv_mqa__dense_activation_squared_relu__prompt_kernel-256, v3
    v_cmp_gt_u32 vcc, 11, v0
    s_and_saveexec_b64 s[64:65], vcc
    s_cbranch_execz L_nopf
    global_load_dword v27, v3, s[48:49]
L_nopf:
    s_mov_b64 exec, -1
    s_and_b32 s61, s2, 8
    s_add_u32 s61, s61, 16
    s_load_dwordx2 s[16:17], s[0:1], s61
    s_load_dwordx2 s[12:13], s[0:1], 8
    s_and_b32 s5, s60, 7
    s_lshr_b32 s51, s60, 3
    s_and_b32 s52, s2, 7
    s_lshl2_add_u32 s4, s52, s51
    s_xor_b32 s50, s3, 4
    s_xor_b32 s50, s50, s5
    s_lshl3_add_u32 s54, s4, s50
    s_lshl_b32 s54, s54, 13
    v_and_b32 v1, 63, v0
    v_and_b32 v4, 7, v1
    v_lshrrev_b32 v3, 3, v1
    v_lshlrev_b32 v4, 4, v4
    v_lshl_or_b32 v5, v3, 10, v4
    v_lshlrev_b32 v9, 7, v1
    s_mov_b32 s10, 2097152
    s_mov_b32 s11, 0x20000
    s_cmp_lt_u32 s3, 4
    s_cbranch_scc1 L_first
    s_waitcnt lgkmcnt(0)
    buffer_load_dwordx4 v[28:31], v5, s[8:11], s54 offen offset:0
    buffer_load_dwordx4 v[32:35], v5, s[8:11], s54 offen offset:128
    buffer_load_dwordx4 v[36:39], v5, s[8:11], s54 offen offset:256
    buffer_load_dwordx4 v[40:43], v5, s[8:11], s54 offen offset:384
    buffer_load_dwordx4 v[44:47], v5, s[8:11], s54 offen offset:512
    buffer_load_dwordx4 v[48:51], v5, s[8:11], s54 offen offset:640
    buffer_load_dwordx4 v[52:55], v5, s[8:11], s54 offen offset:768
    buffer_load_dwordx4 v[56:59], v5, s[8:11], s54 offen offset:896
    s_mov_b32 s18, 16384
    s_mov_b32 s19, 0x20000
    s_mov_b32 s14, 524288
    s_mov_b32 s15, 0x20000
    s_mov_b32 s46, 16777216
    s_mov_b32 s47, 0x20000
    s_branch L_common
L_first:
    s_mov_b32 s18, 16384
    s_mov_b32 s19, 0x20000
    s_mov_b32 s14, 524288
    s_mov_b32 s15, 0x20000
    s_mov_b32 s46, 16777216
    s_mov_b32 s47, 0x20000
    s_cmp_lg_u32 s3, 3
    s_cbranch_scc1 L_first2
    s_lshr_b32 s62, s60, 1
    s_lshl_b32 s62, s62, 10
    s_lshl_b32 s63, s2, 11
    s_mov_b64 exec, 0xff
    s_waitcnt lgkmcnt(0)
    buffer_load_dword v27, v9, s[16:19], s62 offen
    s_mov_b64 exec, 0xffff
    buffer_load_dword v27, v9, s[12:15], s63 offen
L_first2:
    s_cmp_lg_u32 s3, 2
    s_cbranch_scc1 L_first1
    s_lshl3_add_u32 s62, s51, s52
    s_lshl3_add_u32 s62, s62, s5
    s_lshr_b32 s61, s62, 2
    s_lshl_b32 s61, s61, 12
    s_add_u32 s61, s61, 524288
    s_and_b32 s64, s5, 3
    s_lshl_b32 s64, s64, 9
    s_add_u32 s64, s64, s61
    v_add_u32 v26, s64, v9
    s_add_u32 s61, s61, 2048
    s_lshl_b32 s62, s62, 7
    s_add_u32 s62, s62, 32768
    v_writelane_b32 v26, s61, 4
    v_writelane_b32 v26, s62, 5
    s_mov_b64 exec, 63
    s_waitcnt lgkmcnt(0)
    buffer_load_dword v27, v26, s[44:47], 0 offen sc1
L_first1:
L_first0:
    s_mov_b64 exec, -1
L_common:
    v_mov_b32 v13, 0
    v_mov_b32 v11, 162816
    v_and_b32 v12, 15, v1
    v_lshl_add_u32 v12, v12, 2, v11
    ds_write_b32 v12, v13
    s_and_b32 s6, s3, 3
    s_lshl_b32 s53, s5, 7
    s_getreg_b32 s48, hwreg(HW_REG_XCC_ID, 0, 4)
    v_and_b32 v6, 16, v1
    v_lshlrev_b32 v6, 2, v6
    v_xor_b32 v6, v5, v6
    v_add_u32 v6, s53, v6
    v_lshlrev_b32 v7, 4, v1
    s_cmp_lt_u32 s3, 4
    s_cbranch_scc1 L_att
    s_cmp_eq_u32 s6, 0
    s_cselect_b32 s60, 0, 1073741824
    v_mov_b32 v20, s60
    buffer_load_dword v20, v20, s[44:47], 0 offen sc1
    s_load_dwordx2 s[20:21], s[0:1], 32
    s_load_dwordx2 s[24:25], s[0:1], 48
    s_load_dwordx2 s[32:33], s[0:1], 64
    s_load_dwordx2 s[28:29], s[0:1], 56
    s_load_dwordx2 s[36:37], s[0:1], 72
    s_add_u32 s70, s51, s6
    s_and_b32 s70, s70, 3
    s_lshl_b32 s71, s70, 14
    s_lshl_b32 s70, s70, 17
    s_mul_i32 s60, s50, 8320
    v_mul_u32_u24 v23, 1040, v3
    v_add3_u32 v23, v23, v4, s60
    v_mov_b32 v12, 1
    v_mov_b64 v[124:125], 0
    v_mov_b32 v126, 0x3727c5ac
    s_lshl_b32 s60, s50, 5
    s_add_u32 s60, s60, 162880
    v_lshl_add_u32 v127, v3, 2, s60
    s_mov_b32 s56, 0x3f803f80
    s_mov_b32 s57, 0x00003f80
    s_mov_b32 s58, 0x3f800000
    s_mov_b32 s59, 0x3b000000
    v_and_b32 v21, 15, v1
    v_lshrrev_b32 v22, 4, v1
    v_lshlrev_b32 v16, 3, v21
    v_lshl_or_b32 v16, v22, 8, v16
    v_add_u32 v16, 132096, v16
    s_lshr_b32 s60, s5, 1
    s_mul_i32 s61, s60, 16640
    v_mul_u32_u24 v17, 1040, v21
    v_lshl_add_u32 v17, v22, 4, v17
    v_add_u32 v17, s61, v17
    s_lshl_b32 s61, s60, 6
    s_add_u32 s61, s61, 162880
    v_lshl_add_u32 v114, v21, 2, s61
    v_lshl_add_u32 v115, v22, 4, s61
    s_lshl_b32 s62, s51, 3
    s_add_u32 s62, s62, s52
    s_lshl_b32 s100, s62, 1
    s_lshr_b32 s63, s5, 2
    s_add_u32 s100, s100, s63
    s_lshl_b32 s100, s100, 12
    s_add_u32 s100, s100, 262144
    s_lshl_b32 s101, s62, 3
    s_add_u32 s101, s101, s5
    s_lshl_b32 s101, s101, 6
    s_add_u32 s101, s101, 4096
    s_and_b32 s60, s60, 1
    s_lshl_b32 s61, s60, 8
    s_lshl_b32 s62, s60, 9
    s_add_u32 s62, s62, 1024
    s_bitcmp1_b32 s5, 0
    s_cselect_b32 s61, s62, s61
    s_cselect_b32 s62, 3, 9
    s_cselect_b32 s63, 8, 3
    v_lshl_add_u32 v18, v21, 4, s61
    v_and_b32 v25, 1, v22
    v_lshl_add_u32 v18, v25, s62, v18
    v_lshrrev_b32 v25, 1, v22
    v_lshl_add_u32 v18, v25, s63, v18
    s_and_b32 s60, s5, 3
    s_cmp_eq_u32 s60, 1
    s_cselect_b32 s60, 2048, 1073741824
    v_mov_b32 v116, 0x3f803f80
    v_and_b32 v117, 3, v1
    v_lshl_add_u32 v117, v117, 2, s60
    s_waitcnt lgkmcnt(0)
    s_barrier
    s_setprio 3
    s_waitcnt vmcnt(8)
    v_dot2c_f32_bf16 v124, s56, v28
    v_dot2c_f32_bf16 v124, s56, v29
    v_dot2c_f32_bf16 v124, s56, v30
    v_dot2c_f32_bf16 v124, s56, v31
    s_waitcnt vmcnt(7)
    v_dot2c_f32_bf16 v124, s56, v32
    v_dot2c_f32_bf16 v124, s56, v33
    v_dot2c_f32_bf16 v124, s56, v34
    v_dot2c_f32_bf16 v124, s56, v35
    s_waitcnt vmcnt(6)
    v_dot2c_f32_bf16 v124, s56, v36
    v_dot2c_f32_bf16 v124, s56, v37
    v_dot2c_f32_bf16 v124, s56, v38
    v_dot2c_f32_bf16 v124, s56, v39
    s_waitcnt vmcnt(5)
    v_dot2c_f32_bf16 v124, s56, v40
    v_dot2c_f32_bf16 v124, s56, v41
    v_dot2c_f32_bf16 v124, s56, v42
    v_dot2c_f32_bf16 v124, s56, v43
    s_waitcnt vmcnt(4)
    v_dot2c_f32_bf16 v124, s56, v44
    v_dot2c_f32_bf16 v124, s56, v45
    v_dot2c_f32_bf16 v124, s56, v46
    v_dot2c_f32_bf16 v124, s56, v47
    s_waitcnt vmcnt(3)
    v_dot2c_f32_bf16 v124, s56, v48
    v_dot2c_f32_bf16 v124, s56, v49
    v_dot2c_f32_bf16 v124, s56, v50
    v_dot2c_f32_bf16 v124, s56, v51
    s_waitcnt vmcnt(2)
    v_dot2c_f32_bf16 v124, s56, v52
    v_dot2c_f32_bf16 v124, s56, v53
    v_dot2c_f32_bf16 v124, s56, v54
    v_dot2c_f32_bf16 v124, s56, v55
    s_waitcnt vmcnt(1)
    v_dot2c_f32_bf16 v124, s56, v56
    v_dot2c_f32_bf16 v124, s56, v57
    v_dot2c_f32_bf16 v124, s56, v58
    v_dot2c_f32_bf16 v124, s56, v59
    s_nop 2
    v_add_f32_dpp v124, v124, v124 quad_perm:[1,0,3,2] row_mask:0xf bank_mask:0xf
    s_nop 1
    v_add_f32_dpp v124, v124, v124 quad_perm:[2,3,0,1] row_mask:0xf bank_mask:0xf
    s_nop 1
    v_add_f32_dpp v124, v124, v124 row_half_mirror row_mask:0xf bank_mask:0xf
    v_mul_f32 v124, 0xbb000000, v124
    v_dot2_f32_bf16 v60, v28, s57, v124
    v_dot2_f32_bf16 v61, v28, s58, v124
    v_dot2_f32_bf16 v62, v29, s57, v124
    v_dot2_f32_bf16 v63, v29, s58, v124
    v_dot2_f32_bf16 v64, v30, s57, v124
    v_dot2_f32_bf16 v65, v30, s58, v124
    v_dot2_f32_bf16 v66, v31, s57, v124
    v_dot2_f32_bf16 v67, v31, s58, v124
    v_dot2_f32_bf16 v68, v32, s57, v124
    v_dot2_f32_bf16 v69, v32, s58, v124
    v_dot2_f32_bf16 v70, v33, s57, v124
    v_dot2_f32_bf16 v71, v33, s58, v124
    v_dot2_f32_bf16 v72, v34, s57, v124
    v_dot2_f32_bf16 v73, v34, s58, v124
    v_dot2_f32_bf16 v74, v35, s57, v124
    v_dot2_f32_bf16 v75, v35, s58, v124
    v_cvt_pk_bf16_f32 v28, v60, v61
    v_cvt_pk_bf16_f32 v29, v62, v63
    v_cvt_pk_bf16_f32 v30, v64, v65
    v_cvt_pk_bf16_f32 v31, v66, v67
    ds_write_b128 v23, v[28:31] offset:0
    v_dot2c_f32_bf16 v125, v28, v28
    v_dot2c_f32_bf16 v125, v29, v29
    v_dot2c_f32_bf16 v125, v30, v30
    v_dot2c_f32_bf16 v125, v31, v31
    v_dot2_f32_bf16 v60, v36, s57, v124
    v_dot2_f32_bf16 v61, v36, s58, v124
    v_dot2_f32_bf16 v62, v37, s57, v124
    v_dot2_f32_bf16 v63, v37, s58, v124
    v_dot2_f32_bf16 v64, v38, s57, v124
    v_dot2_f32_bf16 v65, v38, s58, v124
    v_dot2_f32_bf16 v66, v39, s57, v124
    v_dot2_f32_bf16 v67, v39, s58, v124
    v_cvt_pk_bf16_f32 v32, v68, v69
    v_cvt_pk_bf16_f32 v33, v70, v71
    v_cvt_pk_bf16_f32 v34, v72, v73
    v_cvt_pk_bf16_f32 v35, v74, v75
    ds_write_b128 v23, v[32:35] offset:128
    v_dot2c_f32_bf16 v125, v32, v32
    v_dot2c_f32_bf16 v125, v33, v33
    v_dot2c_f32_bf16 v125, v34, v34
    v_dot2c_f32_bf16 v125, v35, v35
    v_dot2_f32_bf16 v68, v40, s57, v124
    v_dot2_f32_bf16 v69, v40, s58, v124
    v_dot2_f32_bf16 v70, v41, s57, v124
    v_dot2_f32_bf16 v71, v41, s58, v124
    v_dot2_f32_bf16 v72, v42, s57, v124
    v_dot2_f32_bf16 v73, v42, s58, v124
    v_dot2_f32_bf16 v74, v43, s57, v124
    v_dot2_f32_bf16 v75, v43, s58, v124
    v_cvt_pk_bf16_f32 v36, v60, v61
    v_cvt_pk_bf16_f32 v37, v62, v63
    v_cvt_pk_bf16_f32 v38, v64, v65
    v_cvt_pk_bf16_f32 v39, v66, v67
    ds_write_b128 v23, v[36:39] offset:256
    v_dot2c_f32_bf16 v125, v36, v36
    v_dot2c_f32_bf16 v125, v37, v37
    v_dot2c_f32_bf16 v125, v38, v38
    v_dot2c_f32_bf16 v125, v39, v39
    v_dot2_f32_bf16 v60, v44, s57, v124
    v_dot2_f32_bf16 v61, v44, s58, v124
    v_dot2_f32_bf16 v62, v45, s57, v124
    v_dot2_f32_bf16 v63, v45, s58, v124
    v_dot2_f32_bf16 v64, v46, s57, v124
    v_dot2_f32_bf16 v65, v46, s58, v124
    v_dot2_f32_bf16 v66, v47, s57, v124
    v_dot2_f32_bf16 v67, v47, s58, v124
    v_cvt_pk_bf16_f32 v40, v68, v69
    v_cvt_pk_bf16_f32 v41, v70, v71
    v_cvt_pk_bf16_f32 v42, v72, v73
    v_cvt_pk_bf16_f32 v43, v74, v75
    ds_write_b128 v23, v[40:43] offset:384
    v_dot2c_f32_bf16 v125, v40, v40
    v_dot2c_f32_bf16 v125, v41, v41
    v_dot2c_f32_bf16 v125, v42, v42
    v_dot2c_f32_bf16 v125, v43, v43
    v_dot2_f32_bf16 v68, v48, s57, v124
    v_dot2_f32_bf16 v69, v48, s58, v124
    v_dot2_f32_bf16 v70, v49, s57, v124
    v_dot2_f32_bf16 v71, v49, s58, v124
    v_dot2_f32_bf16 v72, v50, s57, v124
    v_dot2_f32_bf16 v73, v50, s58, v124
    v_dot2_f32_bf16 v74, v51, s57, v124
    v_dot2_f32_bf16 v75, v51, s58, v124
    v_cvt_pk_bf16_f32 v44, v60, v61
    v_cvt_pk_bf16_f32 v45, v62, v63
    v_cvt_pk_bf16_f32 v46, v64, v65
    v_cvt_pk_bf16_f32 v47, v66, v67
    ds_write_b128 v23, v[44:47] offset:512
    v_dot2c_f32_bf16 v125, v44, v44
    v_dot2c_f32_bf16 v125, v45, v45
    v_dot2c_f32_bf16 v125, v46, v46
    v_dot2c_f32_bf16 v125, v47, v47
    v_dot2_f32_bf16 v60, v52, s57, v124
    v_dot2_f32_bf16 v61, v52, s58, v124
    v_dot2_f32_bf16 v62, v53, s57, v124
    v_dot2_f32_bf16 v63, v53, s58, v124
    v_dot2_f32_bf16 v64, v54, s57, v124
    v_dot2_f32_bf16 v65, v54, s58, v124
    v_dot2_f32_bf16 v66, v55, s57, v124
    v_dot2_f32_bf16 v67, v55, s58, v124
    v_cvt_pk_bf16_f32 v48, v68, v69
    v_cvt_pk_bf16_f32 v49, v70, v71
    v_cvt_pk_bf16_f32 v50, v72, v73
    v_cvt_pk_bf16_f32 v51, v74, v75
    ds_write_b128 v23, v[48:51] offset:640
    v_dot2c_f32_bf16 v125, v48, v48
    v_dot2c_f32_bf16 v125, v49, v49
    v_dot2c_f32_bf16 v125, v50, v50
    v_dot2c_f32_bf16 v125, v51, v51
    v_dot2_f32_bf16 v68, v56, s57, v124
    v_dot2_f32_bf16 v69, v56, s58, v124
    v_dot2_f32_bf16 v70, v57, s57, v124
    v_dot2_f32_bf16 v71, v57, s58, v124
    v_dot2_f32_bf16 v72, v58, s57, v124
    v_dot2_f32_bf16 v73, v58, s58, v124
    v_dot2_f32_bf16 v74, v59, s57, v124
    v_dot2_f32_bf16 v75, v59, s58, v124
    v_cvt_pk_bf16_f32 v52, v60, v61
    v_cvt_pk_bf16_f32 v53, v62, v63
    v_cvt_pk_bf16_f32 v54, v64, v65
    v_cvt_pk_bf16_f32 v55, v66, v67
    ds_write_b128 v23, v[52:55] offset:768
    v_dot2c_f32_bf16 v125, v52, v52
    v_dot2c_f32_bf16 v125, v53, v53
    v_dot2c_f32_bf16 v125, v54, v54
    v_dot2c_f32_bf16 v125, v55, v55
    s_nop 1
    v_cvt_pk_bf16_f32 v56, v68, v69
    v_cvt_pk_bf16_f32 v57, v70, v71
    v_cvt_pk_bf16_f32 v58, v72, v73
    v_cvt_pk_bf16_f32 v59, v74, v75
    ds_write_b128 v23, v[56:59] offset:896
    v_dot2c_f32_bf16 v125, v56, v56
    v_dot2c_f32_bf16 v125, v57, v57
    v_dot2c_f32_bf16 v125, v58, v58
    v_dot2c_f32_bf16 v125, v59, v59
    s_nop 2
    v_add_f32_dpp v125, v125, v125 quad_perm:[1,0,3,2] row_mask:0xf bank_mask:0xf
    s_nop 1
    v_add_f32_dpp v125, v125, v125 quad_perm:[2,3,0,1] row_mask:0xf bank_mask:0xf
    s_nop 1
    v_add_f32_dpp v125, v125, v125 row_half_mirror row_mask:0xf bank_mask:0xf
    v_fma_f32 v125, v125, s59, v126
    v_sqrt_f32 v125, v125
    s_mov_b32 exec_lo, 0x01010101
    s_mov_b32 exec_hi, 0x01010101
    ds_write_b32 v127, v125
    s_mov_b64 exec, -1
    s_cmp_lg_u32 s6, 0
    s_cbranch_scc1 L_nokv
    s_waitcnt vmcnt(0)
    v_add_u32 v20, 0x9E3779B9, v20
    s_mov_b64 exec, 1
    ds_write_b32 v11, v20 offset:36
    ds_add_u32 v11, v12 offset:32
    s_mov_b64 exec, -1
    s_mov_b32 s84, 1600000
L_spin_ln:
    ds_read_b32 v27, v11 offset:0
    s_waitcnt lgkmcnt(0)
    v_cmp_ne_u32 vcc, 5, v27
    s_cbranch_vccz L_spun_ln
    s_sleep 1
    s_sub_u32 s84, s84, 1
    s_cmp_lg_u32 s84, 0
    s_cbranch_scc1 L_spin_ln
L_spun_ln:
    s_bitcmp1_b32 s5, 0
    s_cbranch_scc1 L_isv
    ds_read_b128 v[28:31], v17 offset:0
    ds_read_b64_tr_b16 v[192:193], v16 offset:0
    ds_read_b64_tr_b16 v[194:195], v16 offset:128
    ds_read_b128 v[32:35], v17 offset:64
    ds_read_b64_tr_b16 v[196:197], v16 offset:1024
    ds_read_b64_tr_b16 v[198:199], v16 offset:1152
    ds_read_b128 v[36:39], v17 offset:128
    ds_read_b64_tr_b16 v[200:201], v16 offset:2048
    ds_read_b64_tr_b16 v[202:203], v16 offset:2176
    ds_read_b128 v[40:43], v17 offset:192
    ds_read_b64_tr_b16 v[204:205], v16 offset:3072
    ds_read_b64_tr_b16 v[206:207], v16 offset:3200
    ds_read_b128 v[44:47], v17 offset:256
    ds_read_b64_tr_b16 v[208:209], v16 offset:4096
    ds_read_b64_tr_b16 v[210:211], v16 offset:4224
    ds_read_b128 v[48:51], v17 offset:320
    ds_read_b64_tr_b16 v[212:213], v16 offset:5120
    ds_read_b64_tr_b16 v[214:215], v16 offset:5248
    ds_read_b128 v[52:55], v17 offset:384
    ds_read_b64_tr_b16 v[216:217], v16 offset:6144
    ds_read_b64_tr_b16 v[218:219], v16 offset:6272
    ds_read_b128 v[56:59], v17 offset:448
    ds_read_b64_tr_b16 v[220:221], v16 offset:7168
    ds_read_b64_tr_b16 v[222:223], v16 offset:7296
    s_waitcnt lgkmcnt(12)
    v_mfma_f32_16x16x32_bf16 v[96:99], v[192:195], v[28:31], 0
    v_mfma_f32_16x16x32_bf16 v[100:103], v[196:199], v[32:35], 0
    v_mfma_f32_16x16x32_bf16 v[104:107], v[200:203], v[36:39], 0
    v_mfma_f32_16x16x32_bf16 v[108:111], v[204:207], v[40:43], 0
    ds_read_b128 v[60:63], v17 offset:512
    ds_read_b64_tr_b16 v[224:225], v16 offset:8192
    ds_read_b64_tr_b16 v[226:227], v16 offset:8320
    ds_read_b128 v[64:67], v17 offset:576
    ds_read_b64_tr_b16 v[228:229], v16 offset:9216
    ds_read_b64_tr_b16 v[230:231], v16 offset:9344
    ds_read_b128 v[68:71], v17 offset:640
    ds_read_b64_tr_b16 v[232:233], v16 offset:10240
    ds_read_b64_tr_b16 v[234:235], v16 offset:10368
    ds_read_b128 v[72:75], v17 offset:704
    ds_read_b64_tr_b16 v[236:237], v16 offset:11264
    ds_read_b64_tr_b16 v[238:239], v16 offset:11392
    s_waitcnt lgkmcnt(12)
    v_mfma_f32_16x16x32_bf16 v[96:99], v[208:211], v[44:47], v[96:99]
    v_mfma_f32_16x16x32_bf16 v[100:103], v[212:215], v[48:51], v[100:103]
    v_mfma_f32_16x16x32_bf16 v[104:107], v[216:219], v[52:55], v[104:107]
    v_mfma_f32_16x16x32_bf16 v[108:111], v[220:223], v[56:59], v[108:111]
    ds_read_b128 v[76:79], v17 offset:768
    ds_read_b64_tr_b16 v[240:241], v16 offset:12288
    ds_read_b64_tr_b16 v[242:243], v16 offset:12416
    ds_read_b128 v[80:83], v17 offset:832
    ds_read_b64_tr_b16 v[244:245], v16 offset:13312
    ds_read_b64_tr_b16 v[246:247], v16 offset:13440
    ds_read_b128 v[84:87], v17 offset:896
    ds_read_b64_tr_b16 v[248:249], v16 offset:14336
    ds_read_b64_tr_b16 v[250:251], v16 offset:14464
    ds_read_b128 v[88:91], v17 offset:960
    ds_read_b64_tr_b16 v[252:253], v16 offset:15360
    ds_read_b64_tr_b16 v[254:255], v16 offset:15488
    ds_read_b32 v24, v114
    ds_read_b32 v25, v114
    ds_read_b32 v26, v114
    ds_read_b32 v27, v114
    s_waitcnt lgkmcnt(14)
    v_mfma_f32_16x16x32_bf16 v[96:99], v[224:227], v[60:63], v[96:99]
    v_mfma_f32_16x16x32_bf16 v[100:103], v[228:231], v[64:67], v[100:103]
    v_mfma_f32_16x16x32_bf16 v[104:107], v[232:235], v[68:71], v[104:107]
    v_mfma_f32_16x16x32_bf16 v[108:111], v[236:239], v[72:75], v[108:111]
    s_waitcnt lgkmcnt(4)
    v_mfma_f32_16x16x32_bf16 v[96:99], v[240:243], v[76:79], v[96:99]
    v_mfma_f32_16x16x32_bf16 v[100:103], v[244:247], v[80:83], v[100:103]
    v_mfma_f32_16x16x32_bf16 v[104:107], v[248:251], v[84:87], v[104:107]
    v_mfma_f32_16x16x32_bf16 v[108:111], v[252:255], v[88:91], v[108:111]
    s_waitcnt lgkmcnt(0)
    s_branch L_kvd
L_isv:
    ds_read_b128 v[28:31], v17 offset:0
    ds_read_b64_tr_b16 v[192:193], v16 offset:0
    ds_read_b64_tr_b16 v[194:195], v16 offset:128
    ds_read_b128 v[32:35], v17 offset:64
    ds_read_b64_tr_b16 v[196:197], v16 offset:1024
    ds_read_b64_tr_b16 v[198:199], v16 offset:1152
    ds_read_b128 v[36:39], v17 offset:128
    ds_read_b64_tr_b16 v[200:201], v16 offset:2048
    ds_read_b64_tr_b16 v[202:203], v16 offset:2176
    ds_read_b128 v[40:43], v17 offset:192
    ds_read_b64_tr_b16 v[204:205], v16 offset:3072
    ds_read_b64_tr_b16 v[206:207], v16 offset:3200
    ds_read_b128 v[44:47], v17 offset:256
    ds_read_b64_tr_b16 v[208:209], v16 offset:4096
    ds_read_b64_tr_b16 v[210:211], v16 offset:4224
    ds_read_b128 v[48:51], v17 offset:320
    ds_read_b64_tr_b16 v[212:213], v16 offset:5120
    ds_read_b64_tr_b16 v[214:215], v16 offset:5248
    ds_read_b128 v[52:55], v17 offset:384
    ds_read_b64_tr_b16 v[216:217], v16 offset:6144
    ds_read_b64_tr_b16 v[218:219], v16 offset:6272
    ds_read_b128 v[56:59], v17 offset:448
    ds_read_b64_tr_b16 v[220:221], v16 offset:7168
    ds_read_b64_tr_b16 v[222:223], v16 offset:7296
    s_waitcnt lgkmcnt(12)
    v_mfma_f32_16x16x32_bf16 v[96:99], v[28:31], v[192:195], 0
    v_mfma_f32_16x16x32_bf16 v[100:103], v[32:35], v[196:199], 0
    v_mfma_f32_16x16x32_bf16 v[104:107], v[36:39], v[200:203], 0
    v_mfma_f32_16x16x32_bf16 v[108:111], v[40:43], v[204:207], 0
    ds_read_b128 v[60:63], v17 offset:512
    ds_read_b64_tr_b16 v[224:225], v16 offset:8192
    ds_read_b64_tr_b16 v[226:227], v16 offset:8320
    ds_read_b128 v[64:67], v17 offset:576
    ds_read_b64_tr_b16 v[228:229], v16 offset:9216
    ds_read_b64_tr_b16 v[230:231], v16 offset:9344
    ds_read_b128 v[68:71], v17 offset:640
    ds_read_b64_tr_b16 v[232:233], v16 offset:10240
    ds_read_b64_tr_b16 v[234:235], v16 offset:10368
    ds_read_b128 v[72:75], v17 offset:704
    ds_read_b64_tr_b16 v[236:237], v16 offset:11264
    ds_read_b64_tr_b16 v[238:239], v16 offset:11392
    s_waitcnt lgkmcnt(12)
    v_mfma_f32_16x16x32_bf16 v[96:99], v[44:47], v[208:211], v[96:99]
    v_mfma_f32_16x16x32_bf16 v[100:103], v[48:51], v[212:215], v[100:103]
    v_mfma_f32_16x16x32_bf16 v[104:107], v[52:55], v[216:219], v[104:107]
    v_mfma_f32_16x16x32_bf16 v[108:111], v[56:59], v[220:223], v[108:111]
    ds_read_b128 v[76:79], v17 offset:768
    ds_read_b64_tr_b16 v[240:241], v16 offset:12288
    ds_read_b64_tr_b16 v[242:243], v16 offset:12416
    ds_read_b128 v[80:83], v17 offset:832
    ds_read_b64_tr_b16 v[244:245], v16 offset:13312
    ds_read_b64_tr_b16 v[246:247], v16 offset:13440
    ds_read_b128 v[84:87], v17 offset:896
    ds_read_b64_tr_b16 v[248:249], v16 offset:14336
    ds_read_b64_tr_b16 v[250:251], v16 offset:14464
    ds_read_b128 v[88:91], v17 offset:960
    ds_read_b64_tr_b16 v[252:253], v16 offset:15360
    ds_read_b64_tr_b16 v[254:255], v16 offset:15488
    ds_read_b128 v[24:27], v115
    s_waitcnt lgkmcnt(13)
    v_mfma_f32_16x16x32_bf16 v[96:99], v[60:63], v[224:227], v[96:99]
    v_mfma_f32_16x16x32_bf16 v[100:103], v[64:67], v[228:231], v[100:103]
    v_mfma_f32_16x16x32_bf16 v[104:107], v[68:71], v[232:235], v[104:107]
    v_mfma_f32_16x16x32_bf16 v[108:111], v[72:75], v[236:239], v[108:111]
    s_waitcnt lgkmcnt(1)
    v_mfma_f32_16x16x32_bf16 v[96:99], v[76:79], v[240:243], v[96:99]
    v_mfma_f32_16x16x32_bf16 v[100:103], v[80:83], v[244:247], v[100:103]
    v_mfma_f32_16x16x32_bf16 v[104:107], v[84:87], v[248:251], v[104:107]
    v_mfma_f32_16x16x32_bf16 v[108:111], v[88:91], v[252:255], v[108:111]
    s_waitcnt lgkmcnt(0)
L_kvd:
    v_mov_b32 v21, s48
    v_add3_u32 v22, v20, v21, 1
    s_add_u32 s60, s100, 262144
    s_lshl_b32 s61, s101, 1
    s_add_u32 s61, s61, 24576
    buffer_store_dword v116, v117, s[44:47], s60 offen
    v_rcp_f32 v24, v24
    v_rcp_f32 v25, v25
    v_rcp_f32 v26, v26
    v_rcp_f32 v27, v27
    v_add_f32 v96, v96, v100
    v_add_f32 v97, v97, v101
    v_add_f32 v98, v98, v102
    v_add_f32 v99, v99, v103
    v_add_f32 v96, v96, v104
    v_add_f32 v97, v97, v105
    v_add_f32 v98, v98, v106
    v_add_f32 v99, v99, v107
    v_add_f32 v96, v96, v108
    v_add_f32 v97, v97, v109
    v_add_f32 v98, v98, v110
    v_add_f32 v99, v99, v111
    v_mul_f32 v96, v96, v24
    v_mul_f32 v97, v97, v25
    v_mul_f32 v98, v98, v26
    v_mul_f32 v99, v99, v27
    v_cvt_pk_bf16_f32 v112, v96, v97
    v_cvt_pk_bf16_f32 v113, v98, v99
    buffer_store_dwordx2 v[112:113], v18, s[44:47], s60 offen
    buffer_store_dwordx2 v[112:113], v18, s[44:47], s100 offen sc1
    buffer_store_dword v116, v117, s[44:47], s100 offen sc1
    s_waitcnt vmcnt(2)
    s_mov_b64 exec, 1
    buffer_store_dword v22, v13, s[44:47], s61 offen
    s_mov_b64 exec, -1
    s_setprio 0
    s_waitcnt vmcnt(0)
    s_mov_b64 exec, 1
    buffer_store_dwordx2 v[20:21], v13, s[44:47], s101 offen sc1
    s_mov_b64 exec, -1
    s_branch L_bar1
L_nokv:
    s_cmp_lg_u32 s6, 1
    s_cbranch_scc1 L_nosig
    s_mov_b64 exec, 1
    ds_add_u32 v11, v12 offset:0
    s_mov_b64 exec, -1
L_nosig:
    s_setprio 0
    buffer_load_dwordx4 v[192:195], v6, s[12:15], s70 offen
    s_add_u32 s70, s70, 8192
    buffer_load_dwordx4 v[196:199], v6, s[12:15], s70 offen
    s_add_u32 s70, s70, 8192
    buffer_load_dwordx4 v[200:203], v6, s[12:15], s70 offen
    s_add_u32 s70, s70, 8192
    buffer_load_dwordx4 v[204:207], v6, s[12:15], s70 offen
    s_add_u32 s70, s70, 8192
    buffer_load_dwordx4 v[208:211], v6, s[12:15], s70 offen
    s_add_u32 s70, s70, 8192
    buffer_load_dwordx4 v[212:215], v6, s[12:15], s70 offen
    s_add_u32 s70, s70, 8192
    buffer_load_dwordx4 v[216:219], v6, s[12:15], s70 offen
    s_add_u32 s70, s70, 8192
    buffer_load_dwordx4 v[220:223], v6, s[12:15], s70 offen
    s_add_u32 s70, s70, 8192
    buffer_load_dwordx4 v[224:227], v6, s[12:15], s70 offen
    s_add_u32 s70, s70, 8192
    buffer_load_dwordx4 v[228:231], v6, s[12:15], s70 offen
    s_add_u32 s70, s70, 8192
    buffer_load_dwordx4 v[232:235], v6, s[12:15], s70 offen
    s_add_u32 s70, s70, 8192
    buffer_load_dwordx4 v[236:239], v6, s[12:15], s70 offen
    s_add_u32 s70, s70, 8192
    buffer_load_dwordx4 v[240:243], v6, s[12:15], s70 offen
    s_add_u32 s70, s70, 8192
    buffer_load_dwordx4 v[244:247], v6, s[12:15], s70 offen
    s_add_u32 s70, s70, 8192
    buffer_load_dwordx4 v[248:251], v6, s[12:15], s70 offen
    s_add_u32 s70, s70, 8192
    buffer_load_dwordx4 v[252:255], v6, s[12:15], s70 offen
    s_add_u32 s71, s71, 66560
    v_add_u32 v27, s71, v7
    s_waitcnt vmcnt(15)
    ds_write_b128 v27, v[192:195] offset:0
    s_waitcnt vmcnt(14)
    ds_write_b128 v27, v[196:199] offset:1024
    s_waitcnt vmcnt(13)
    ds_write_b128 v27, v[200:203] offset:2048
    s_waitcnt vmcnt(12)
    ds_write_b128 v27, v[204:207] offset:3072
    s_waitcnt vmcnt(11)
    ds_write_b128 v27, v[208:211] offset:4096
    s_waitcnt vmcnt(10)
    ds_write_b128 v27, v[212:215] offset:5120
    s_waitcnt vmcnt(9)
    ds_write_b128 v27, v[216:219] offset:6144
    s_waitcnt vmcnt(8)
    ds_write_b128 v27, v[220:223] offset:7168
    s_waitcnt vmcnt(7)
    ds_write_b128 v27, v[224:227] offset:8192
    s_waitcnt vmcnt(6)
    ds_write_b128 v27, v[228:231] offset:9216
    s_waitcnt vmcnt(5)
    ds_write_b128 v27, v[232:235] offset:10240
    s_waitcnt vmcnt(4)
    ds_write_b128 v27, v[236:239] offset:11264
    s_waitcnt vmcnt(3)
    ds_write_b128 v27, v[240:243] offset:12288
    s_waitcnt vmcnt(2)
    ds_write_b128 v27, v[244:247] offset:13312
    s_waitcnt vmcnt(1)
    ds_write_b128 v27, v[248:251] offset:14336
    s_waitcnt vmcnt(0)
    ds_write_b128 v27, v[252:255] offset:15360
    s_waitcnt vmcnt(0)
    s_mov_b64 exec, 1
    ds_add_u32 v11, v12 offset:32
    s_mov_b64 exec, -1
L_bar1:
    s_mov_b32 s30, 3584
    s_mov_b32 s31, 0x20000
    s_mov_b32 s38, 1024
    s_mov_b32 s39, 0x20000
    s_mov_b32 s22, 524288
    s_mov_b32 s23, 0x20000
    s_mov_b32 s26, 1835008
    s_mov_b32 s27, 0x20000
    s_mov_b32 s34, 1835008
    s_mov_b32 s35, 0x20000
    v_and_b32 v19, 3, v1
    v_lshlrev_b32 v19, 3, v19
    v_and_b32 v25, 16, v1
    v_lshl_or_b32 v19, v25, 1, v19
    v_and_b32 v25, 8, v1
    v_lshl_or_b32 v19, v25, 3, v19
    v_and_b32 v25, 12, v1
    v_lshl_or_b32 v19, v25, 5, v19
    s_cmp_lt_u32 s5, 7
    s_cselect_b32 s64, s5, 0
    s_mov_b32 s16, s44
    s_mov_b32 s17, s45
    s_cselect_b32 s18, s46, 0
    s_mul_i32 s65, s6, 7
    s_add_u32 s65, s65, s64
    s_lshl_b32 s78, s65, 7
    s_lshr_b32 s66, s6, 1
    s_lshl_b32 s66, s66, 6
    s_and_b32 s67, s6, 1
    s_add_u32 s60, s53, s66
    v_and_b32 v10, 32, v1
    v_and_b32 v24, 31, v1
    v_lshlrev_b32 v26, 1, v24
    v_lshl_or_b32 v26, v10, 10, v26
    v_add_u32 v180, s78, v26
    v_add_u32 v166, s60, v26
    v_mov_b32 v170, v9
    s_lshl_b32 s87, s6, 11
    s_add_u32 s87, s87, 115712
    v_and_b32 v26, 7, v1
    s_and_b32 s60, s101, 0xfffffe00
    v_lshl_add_u32 v167, v26, 6, s60
    v_lshl_or_b32 v160, v10, 5, v19
    v_add_u32 v160, s87, v160
    v_xor_b32 v161, 64, v160
    s_lshl_b32 s60, s67, 7
    s_xor_b32 s61, s60, 128
    s_add_u32 s60, s60, 162880
    s_add_u32 s61, s61, 162880
    v_lshl_add_u32 v172, v24, 2, s60
    v_lshl_add_u32 v173, v24, 2, s61
    s_mul_i32 s60, s67, 33280
    s_sub_u32 s61, 33280, s60
    v_mul_u32_u24 v24, 1040, v24
    v_lshrrev_b32 v25, 1, v10
    v_add3_u32 v164, v24, v25, s60
    v_add3_u32 v165, v24, v25, s61
    v_mul_u32_u24 v162, 3584, v3
    v_and_b32 v24, 0x70, v6
    v_add_u32 v162, v162, v24
    v_add_u32 v163, 27648, v162
    v_mov_b32 v177, 0
    v_mov_b64 v[178:179], 0
    v_mov_b32 v181, 0
    v_mov_b64 v[182:183], 0
    v_mov_b32 v185, 0
    v_mov_b64 v[186:187], 0
    v_mov_b32 v189, 0
    v_mov_b64 v[190:191], 0
    s_mul_i32 s68, s4, 229376
    s_add_u32 s68, s68, 4194304
    s_lshl_b32 s69, s4, 12
    s_add_u32 s69, s69, 65536
    v_lshlrev_b32 v14, 10, v3
    v_and_b32 v25, 6, v3
    v_xor_b32 v25, v25, v26
    v_lshl_or_b32 v14, v25, 4, v14
    v_add_u32 v14, s53, v14
    v_lshl_or_b32 v2, v10, 4, v19
    v_xor_b32 v2, s66, v2
    v_add_u32 v2, s87, v2
    v_xor_b32 v3, 64, v2
    v_add_u32 v5, 7168, v6
    s_lshl_b32 s60, s67, 10
    s_xor_b32 s61, s60, 0x400
    s_add_u32 s60, s60, s68
    s_add_u32 s61, s61, s68
    v_add_u32 v4, s60, v7
    v_add_u32 v8, s61, v7
    s_mul_i32 s76, s6, 57344
    s_add_u32 s77, s76, 57344
    s_lshl_b32 s55, s65, 13
    s_add_u32 s75, s55, 6144
    s_lshl_b32 s73, s76, 3
    s_lshl_b32 s74, s77, 3
    s_lshl_b32 s72, s55, 3
    s_mul_i32 s60, s6, 896
    s_add_u32 s60, s60, s69
    v_min_u32 v0, 5, v1
    v_add3_u32 v0, v0, s64, 1
    v_subrev_u32 v24, 7, v0
    v_min_u32 v0, v0, v24
    v_lshl_add_u32 v0, v0, 7, s60
    s_add_u32 s98, s78, s69
    s_lshl_b32 s79, s5, 3
    s_add_u32 s79, s79, s6
    s_add_u32 s79, s79, 12
    s_lshl_b32 s79, s79, 13
    s_lshl_b32 s86, s6, 10
    s_mov_b32 s84, 1600000
L_spin_xh:
    ds_read_b32 v27, v11 offset:32
    s_waitcnt lgkmcnt(0)
    v_cmp_ne_u32 vcc, 8, v27
    s_cbranch_vccz L_spun_xh
    s_sleep 2
    s_sub_u32 s84, s84, 1
    s_cmp_lg_u32 s84, 0
    s_cbranch_scc1 L_spin_xh
L_spun_xh:
    ds_read_b32 v9, v11 offset:36
    ds_read_b32 v25, v172
    ds_read_b32 v26, v173
    s_waitcnt lgkmcnt(0)
    v_readfirstlane_b32 s7, v9
    v_mul_f32 v24, v25, v25
    v_and_b32 v27, 0xffff0000, v25
    v_sub_f32 v25, v25, v27
    v_cvt_pk_bf16_f32 v184, v27, v25
    v_and_b32 v27, 0xffff0000, v26
    v_sub_f32 v26, v26, v27
    v_cvt_pk_bf16_f32 v188, v27, v26
    v_and_b32 v27, 0xffff0000, v24
    v_sub_f32 v24, v24, v27
    v_cvt_pk_bf16_f32 v171, v27, v24
    s_barrier
    s_barrier
    s_cmp_eq_u32 s5, 7
    s_cbranch_scc1 L_skip7
    s_add_u32 m0, s87, 16384
    s_nop 0
    buffer_load_dwordx4 v162, s[24:27], s78 offen lds
    buffer_load_dwordx4 v163, s[24:27], s78 offen offset:1024 lds
    s_add_u32 m0, s87, 24576
    s_add_u32 s78, s78, 57344
    buffer_load_dwordx4 v162, s[24:27], s78 offen lds
    buffer_load_dwordx4 v163, s[24:27], s78 offen offset:1024 lds
    s_add_u32 m0, s87, 0
    s_add_u32 s78, s78, 57344
    buffer_load_dwordx4 v162, s[24:27], s78 offen lds
    buffer_load_dwordx4 v163, s[24:27], s78 offen offset:1024 lds
    s_add_u32 m0, s87, 8192
    s_add_u32 s78, s78, 57344
    buffer_load_dwordx4 v162, s[24:27], s78 offen lds
    buffer_load_dwordx4 v163, s[24:27], s78 offen offset:1024 lds
    ds_read_b128 v[136:139], v164 offset:0
    ds_read_b128 v[140:143], v165 offset:0
    s_waitcnt vmcnt(6)
    ds_read_b64_tr_b16 v[128:129], v160 offset:16384
    ds_read_b64_tr_b16 v[130:131], v160 offset:16896
    ds_read_b64_tr_b16 v[132:133], v161 offset:16384
    ds_read_b64_tr_b16 v[134:135], v161 offset:16896
    s_waitcnt lgkmcnt(0)
    v_mfma_f32_32x32x16_bf16 v[192:207], v[128:131], v[136:139], 0
    v_mfma_f32_32x32x16_bf16 v[208:223], v[128:131], v[140:143], 0
    s_add_u32 m0, s87, 32768
    s_add_u32 s78, s78, 57344
    buffer_load_dwordx4 v162, s[24:27], s78 offen lds
    buffer_load_dwordx4 v163, s[24:27], s78 offen offset:1024 lds
    ds_read_b128 v[152:155], v164 offset:32
    ds_read_b128 v[156:159], v165 offset:32
    s_waitcnt vmcnt(6)
    ds_read_b64_tr_b16 v[144:145], v160 offset:24576
    ds_read_b64_tr_b16 v[146:147], v160 offset:25088
    ds_read_b64_tr_b16 v[148:149], v161 offset:24576
    ds_read_b64_tr_b16 v[150:151], v161 offset:25088
    v_mfma_f32_32x32x16_bf16 v[224:239], v[132:135], v[136:139], 0
    v_mfma_f32_32x32x16_bf16 v[240:255], v[132:135], v[140:143], 0
    s_add_u32 m0, s87, 16384
    s_add_u32 s78, s78, 57344
    buffer_load_dwordx4 v162, s[24:27], s78 offen lds
    buffer_load_dwordx4 v163, s[24:27], s78 offen offset:1024 lds
    s_waitcnt lgkmcnt(0)
    v_mfma_f32_32x32x16_bf16 v[192:207], v[144:147], v[152:155], v[192:207]
    v_mfma_f32_32x32x16_bf16 v[208:223], v[144:147], v[156:159], v[208:223]
    ds_read_b128 v[136:139], v164 offset:64
    ds_read_b128 v[140:143], v165 offset:64
    s_waitcnt vmcnt(6)
    ds_read_b64_tr_b16 v[128:129], v160 offset:0
    ds_read_b64_tr_b16 v[130:131], v160 offset:512
    ds_read_b64_tr_b16 v[132:133], v161 offset:0
    ds_read_b64_tr_b16 v[134:135], v161 offset:512
    v_mfma_f32_32x32x16_bf16 v[224:239], v[148:151], v[152:155], v[224:239]
    v_mfma_f32_32x32x16_bf16 v[240:255], v[148:151], v[156:159], v[240:255]
    s_add_u32 m0, s87, 24576
    s_add_u32 s78, s78, 57344
    buffer_load_dwordx4 v162, s[24:27], s78 offen lds
    buffer_load_dwordx4 v163, s[24:27], s78 offen offset:1024 lds
    buffer_load_ushort v176, v180, s[28:31], 0 offen
    buffer_load_ushort v180, v180, s[28:31], 0 offen offset:64
    buffer_load_ushort v166, v166, s[36:39], 0 offen
    s_waitcnt lgkmcnt(0)
    v_mfma_f32_32x32x16_bf16 v[192:207], v[128:131], v[136:139], v[192:207]
    v_mfma_f32_32x32x16_bf16 v[208:223], v[128:131], v[140:143], v[208:223]
    ds_read_b128 v[152:155], v164 offset:96
    ds_read_b128 v[156:159], v165 offset:96
    s_waitcnt vmcnt(9)
    ds_read_b64_tr_b16 v[144:145], v160 offset:8192
    ds_read_b64_tr_b16 v[146:147], v160 offset:8704
    ds_read_b64_tr_b16 v[148:149], v161 offset:8192
    ds_read_b64_tr_b16 v[150:151], v161 offset:8704
    v_mfma_f32_32x32x16_bf16 v[224:239], v[132:135], v[136:139], v[224:239]
    v_mfma_f32_32x32x16_bf16 v[240:255], v[132:135], v[140:143], v[240:255]
    s_waitcnt vmcnt(8)
    s_add_u32 m0, s87, 0
    s_add_u32 s78, s78, 57344
    buffer_load_dwordx4 v162, s[24:27], s78 offen lds
    buffer_load_dwordx4 v163, s[24:27], s78 offen offset:1024 lds
    s_waitcnt lgkmcnt(0)
    v_mfma_f32_32x32x16_bf16 v[192:207], v[144:147], v[152:155], v[192:207]
    v_mfma_f32_32x32x16_bf16 v[208:223], v[144:147], v[156:159], v[208:223]
    ds_read_b128 v[136:139], v164 offset:128
    ds_read_b128 v[140:143], v165 offset:128
    s_waitcnt vmcnt(9)
    ds_read_b64_tr_b16 v[128:129], v160 offset:32768
    ds_read_b64_tr_b16 v[130:131], v160 offset:33280
    ds_read_b64_tr_b16 v[132:133], v161 offset:32768
    ds_read_b64_tr_b16 v[134:135], v161 offset:33280
    v_mfma_f32_32x32x16_bf16 v[224:239], v[148:151], v[152:155], v[224:239]
    v_mfma_f32_32x32x16_bf16 v[240:255], v[148:151], v[156:159], v[240:255]
    s_waitcnt vmcnt(8)
    s_add_u32 m0, s87, 8192
    s_add_u32 s78, s78, 57344
    buffer_load_dwordx4 v162, s[24:27], s78 offen lds
    buffer_load_dwordx4 v163, s[24:27], s78 offen offset:1024 lds
    s_waitcnt lgkmcnt(0)
    v_mfma_f32_32x32x16_bf16 v[192:207], v[128:131], v[136:139], v[192:207]
    v_mfma_f32_32x32x16_bf16 v[208:223], v[128:131], v[140:143], v[208:223]
    ds_read_b128 v[152:155], v164 offset:160
    ds_read_b128 v[156:159], v165 offset:160
    s_waitcnt vmcnt(9)
    ds_read_b64_tr_b16 v[144:145], v160 offset:16384
    ds_read_b64_tr_b16 v[146:147], v160 offset:16896
    ds_read_b64_tr_b16 v[148:149], v161 offset:16384
    ds_read_b64_tr_b16 v[150:151], v161 offset:16896
    v_mfma_f32_32x32x16_bf16 v[224:239], v[132:135], v[136:139], v[224:239]
    v_mfma_f32_32x32x16_bf16 v[240:255], v[132:135], v[140:143], v[240:255]
    s_waitcnt vmcnt(8)
    s_add_u32 m0, s87, 32768
    s_add_u32 s78, s78, 57344
    buffer_load_dwordx4 v162, s[24:27], s78 offen lds
    buffer_load_dwordx4 v163, s[24:27], s78 offen offset:1024 lds
    s_waitcnt lgkmcnt(0)
    v_mfma_f32_32x32x16_bf16 v[192:207], v[144:147], v[152:155], v[192:207]
    v_mfma_f32_32x32x16_bf16 v[208:223], v[144:147], v[156:159], v[208:223]
    ds_read_b128 v[136:139], v164 offset:192
    ds_read_b128 v[140:143], v165 offset:192
    s_waitcnt vmcnt(9)
    ds_read_b64_tr_b16 v[128:129], v160 offset:24576
    ds_read_b64_tr_b16 v[130:131], v160 offset:25088
    ds_read_b64_tr_b16 v[132:133], v161 offset:24576
    ds_read_b64_tr_b16 v[134:135], v161 offset:25088
    v_mfma_f32_32x32x16_bf16 v[224:239], v[148:151], v[152:155], v[224:239]
    v_mfma_f32_32x32x16_bf16 v[240:255], v[148:151], v[156:159], v[240:255]
    s_waitcnt vmcnt(8)
    s_add_u32 m0, s87, 16384
    s_nop 0
    buffer_load_dwordx4 v6, s[32:35], s72 offen lds
    buffer_load_dwordx4 v5, s[32:35], s72 offen offset:1024 lds
    s_waitcnt lgkmcnt(0)
    v_mfma_f32_32x32x16_bf16 v[192:207], v[128:131], v[136:139], v[192:207]
    v_mfma_f32_32x32x16_bf16 v[208:223], v[128:131], v[140:143], v[208:223]
    ds_read_b128 v[152:155], v164 offset:224
    ds_read_b128 v[156:159], v165 offset:224
    s_waitcnt vmcnt(6)
    ds_read_b64_tr_b16 v[144:145], v160 offset:0
    ds_read_b64_tr_b16 v[146:147], v160 offset:512
    ds_read_b64_tr_b16 v[148:149], v161 offset:0
    ds_read_b64_tr_b16 v[150:151], v161 offset:512
    v_mfma_f32_32x32x16_bf16 v[224:239], v[132:135], v[136:139], v[224:239]
    v_mfma_f32_32x32x16_bf16 v[240:255], v[132:135], v[140:143], v[240:255]
    s_add_u32 m0, s87, 24576
    s_add_u32 s78, s78, 57344
    buffer_load_dwordx4 v162, s[24:27], s78 offen lds
    buffer_load_dwordx4 v163, s[24:27], s78 offen offset:1024 lds
    buffer_load_dword v10, v0, s[44:47], 0 offen sc1
    buffer_load_dwordx2 v[168:169], v167, s[44:47], 0 offen sc1
    s_waitcnt lgkmcnt(0)
    v_mfma_f32_32x32x16_bf16 v[192:207], v[144:147], v[152:155], v[192:207]
    v_mfma_f32_32x32x16_bf16 v[208:223], v[144:147], v[156:159], v[208:223]
    ds_read_b128 v[136:139], v164 offset:256
    ds_read_b128 v[140:143], v165 offset:256
    s_waitcnt vmcnt(8)
    ds_read_b64_tr_b16 v[128:129], v160 offset:8192
    ds_read_b64_tr_b16 v[130:131], v160 offset:8704
    ds_read_b64_tr_b16 v[132:133], v161 offset:8192
    ds_read_b64_tr_b16 v[134:135], v161 offset:8704
    v_mfma_f32_32x32x16_bf16 v[224:239], v[148:151], v[152:155], v[224:239]
    v_mfma_f32_32x32x16_bf16 v[240:255], v[148:151], v[156:159], v[240:255]
    s_add_u32 m0, s87, 0
    s_add_u32 s72, s72, 16384
    buffer_load_dwordx4 v6, s[32:35], s72 offen lds
    buffer_load_dwordx4 v5, s[32:35], s72 offen offset:1024 lds
    s_waitcnt lgkmcnt(0)
    v_mfma_f32_32x32x16_bf16 v[192:207], v[128:131], v[136:139], v[192:207]
    v_mfma_f32_32x32x16_bf16 v[208:223], v[128:131], v[140:143], v[208:223]
    ds_read_b128 v[152:155], v164 offset:288
    ds_read_b128 v[156:159], v165 offset:288
    s_waitcnt vmcnt(8)
    ds_read_b64_tr_b16 v[144:145], v160 offset:32768
    ds_read_b64_tr_b16 v[146:147], v160 offset:33280
    ds_read_b64_tr_b16 v[148:149], v161 offset:32768
    ds_read_b64_tr_b16 v[150:151], v161 offset:33280
    v_mfma_f32_32x32x16_bf16 v[224:239], v[132:135], v[136:139], v[224:239]
    v_mfma_f32_32x32x16_bf16 v[240:255], v[132:135], v[140:143], v[240:255]
    s_add_u32 m0, s87, 8192
    s_add_u32 s78, s78, 57344
    buffer_load_dwordx4 v162, s[24:27], s78 offen lds
    buffer_load_dwordx4 v163, s[24:27], s78 offen offset:1024 lds
    s_waitcnt vmcnt(4)
    s_setprio 2
    v_cmp_ne_u32 vcc, s7, v168
    v_cmp_ne_u32 s[60:61], s48, v169
    v_lshl_or_b32 v176, v176, 16, v176
    v_lshl_or_b32 v180, v180, 16, v180
    s_or_b64 vcc, vcc, s[60:61]
    s_cselect_b32 s49, 0, 1
    v_mov_b32 v10, s49
    s_setprio 0
    s_mov_b64 exec, 1
    ds_add_u32 v11, v10 offset:12
    s_mov_b64 exec, -1
    ds_read_b64_tr_b16 v[16:17], v2 offset:16384
    ds_read_b64_tr_b16 v[18:19], v2 offset:17408
    ds_read_b64_tr_b16 v[20:21], v3 offset:16384
    ds_read_b64_tr_b16 v[22:23], v3 offset:17408
    s_waitcnt lgkmcnt(5)
    v_mfma_f32_32x32x16_bf16 v[192:207], v[144:147], v[152:155], v[192:207]
    v_mfma_f32_32x32x16_bf16 v[208:223], v[144:147], v[156:159], v[208:223]
    s_add_u32 m0, s87, 32768
    s_add_u32 s78, s78, 57344
    buffer_load_dwordx4 v162, s[24:27], s78 offen lds
    buffer_load_dwordx4 v163, s[24:27], s78 offen offset:1024 lds
    ds_read_b128 v[136:139], v164 offset:320
    ds_read_b128 v[140:143], v165 offset:320
    ds_read_b64_tr_b16 v[128:129], v160 offset:24576
    ds_read_b64_tr_b16 v[130:131], v160 offset:25088
    ds_read_b64_tr_b16 v[132:133], v161 offset:24576
    ds_read_b64_tr_b16 v[134:135], v161 offset:25088
    v_mfma_f32_32x32x16_bf16 v[224:239], v[148:151], v[152:155], v[224:239]
    v_mfma_f32_32x32x16_bf16 v[240:255], v[148:151], v[156:159], v[240:255]
    s_waitcnt lgkmcnt(6)
    s_add_u32 m0, s87, 16384
    s_add_u32 s72, s72, 16384
    buffer_load_dwordx4 v6, s[32:35], s72 offen lds
    buffer_load_dwordx4 v5, s[32:35], s72 offen offset:1024 lds
    s_waitcnt vmcnt(6)
    ds_read_b64_tr_b16 v[24:25], v2 offset:0
    ds_read_b64_tr_b16 v[26:27], v2 offset:1024
    ds_read_b64_tr_b16 v[28:29], v3 offset:0
    ds_read_b64_tr_b16 v[30:31], v3 offset:1024
    s_waitcnt lgkmcnt(4)
    v_mfma_f32_32x32x16_bf16 v[192:207], v[128:131], v[136:139], v[192:207]
    v_mfma_f32_32x32x16_bf16 v[208:223], v[128:131], v[140:143], v[208:223]
    s_add_u32 m0, s87, 24576
    s_add_u32 s78, s78, 57344
    buffer_load_dwordx4 v162, s[24:27], s78 offen lds
    buffer_load_dwordx4 v163, s[24:27], s78 offen offset:1024 lds
    ds_read_b128 v[152:155], v164 offset:352
    ds_read_b128 v[156:159], v165 offset:352
    s_waitcnt vmcnt(6)
    ds_read_b64_tr_b16 v[144:145], v160 offset:8192
    ds_read_b64_tr_b16 v[146:147], v160 offset:8704
    ds_read_b64_tr_b16 v[148:149], v161 offset:8192
    ds_read_b64_tr_b16 v[150:151], v161 offset:8704
    v_mfma_f32_32x32x16_bf16 v[224:239], v[132:135], v[136:139], v[224:239]
    v_mfma_f32_32x32x16_bf16 v[240:255], v[132:135], v[140:143], v[240:255]
    s_waitcnt lgkmcnt(6)
    s_add_u32 m0, s87, 0
    s_add_u32 s72, s72, 16384
    buffer_load_dwordx4 v6, s[32:35], s72 offen lds
    buffer_load_dwordx4 v5, s[32:35], s72 offen offset:1024 lds
    s_waitcnt lgkmcnt(0)
    v_mfma_f32_32x32x16_bf16 v[192:207], v[144:147], v[152:155], v[192:207]
    v_mfma_f32_32x32x16_bf16 v[208:223], v[144:147], v[156:159], v[208:223]
    ds_read_b128 v[136:139], v164 offset:384
    ds_read_b128 v[140:143], v165 offset:384
    s_waitcnt vmcnt(6)
    ds_read_b64_tr_b16 v[128:129], v160 offset:32768
    ds_read_b64_tr_b16 v[130:131], v160 offset:33280
    ds_read_b64_tr_b16 v[132:133], v161 offset:32768
    ds_read_b64_tr_b16 v[134:135], v161 offset:33280
    v_mfma_f32_32x32x16_bf16 v[224:239], v[148:151], v[152:155], v[224:239]
    v_mfma_f32_32x32x16_bf16 v[240:255], v[148:151], v[156:159], v[240:255]
    s_add_u32 m0, s87, 8192
    s_add_u32 s78, s78, 57344
    buffer_load_dwordx4 v162, s[24:27], s78 offen lds
    buffer_load_dwordx4 v163, s[24:27], s78 offen offset:1024 lds
    s_waitcnt vmcnt(6)
    ds_read_b64_tr_b16 v[32:33], v2 offset:16384
    ds_read_b64_tr_b16 v[34:35], v2 offset:17408
    ds_read_b64_tr_b16 v[36:37], v3 offset:16384
    ds_read_b64_tr_b16 v[38:39], v3 offset:17408
    s_waitcnt lgkmcnt(4)
    v_mfma_f32_32x32x16_bf16 v[192:207], v[128:131], v[136:139], v[192:207]
    v_mfma_f32_32x32x16_bf16 v[208:223], v[128:131], v[140:143], v[208:223]
    s_add_u32 m0, s87, 32768
    s_add_u32 s78, s78, 57344
    buffer_load_dwordx4 v162, s[24:27], s78 offen lds
    buffer_load_dwordx4 v163, s[24:27], s78 offen offset:1024 lds
    ds_read_b128 v[152:155], v164 offset:416
    ds_read_b128 v[156:159], v165 offset:416
    s_waitcnt vmcnt(6)
    ds_read_b64_tr_b16 v[144:145], v160 offset:24576
    ds_read_b64_tr_b16 v[146:147], v160 offset:25088
    ds_read_b64_tr_b16 v[148:149], v161 offset:24576
    ds_read_b64_tr_b16 v[150:151], v161 offset:25088
    v_mfma_f32_32x32x16_bf16 v[224:239], v[132:135], v[136:139], v[224:239]
    v_mfma_f32_32x32x16_bf16 v[240:255], v[132:135], v[140:143], v[240:255]
    s_waitcnt lgkmcnt(6)
    s_add_u32 m0, s87, 16384
    s_add_u32 s72, s72, 16384
    s_cmp_eq_u32 s72, s74
    s_cselect_b32 s72, s73, s72
    buffer_load_dwordx4 v6, s[32:35], s72 offen lds
    buffer_load_dwordx4 v5, s[32:35], s72 offen offset:1024 lds
    s_waitcnt vmcnt(6)
    ds_read_b64_tr_b16 v[40:41], v2 offset:0
    ds_read_b64_tr_b16 v[42:43], v2 offset:1024
    ds_read_b64_tr_b16 v[44:45], v3 offset:0
    ds_read_b64_tr_b16 v[46:47], v3 offset:1024
    s_waitcnt lgkmcnt(4)
    v_mfma_f32_32x32x16_bf16 v[192:207], v[144:147], v[152:155], v[192:207]
    v_mfma_f32_32x32x16_bf16 v[208:223], v[144:147], v[156:159], v[208:223]
    s_add_u32 m0, s87, 24576
    s_add_u32 s78, s78, 57344
    buffer_load_dwordx4 v162, s[24:27], s78 offen lds
    buffer_load_dwordx4 v163, s[24:27], s78 offen offset:1024 lds
    ds_read_b128 v[136:139], v164 offset:448
    ds_read_b128 v[140:143], v165 offset:448
    s_waitcnt vmcnt(6)
    ds_read_b64_tr_b16 v[128:129], v160 offset:8192
    ds_read_b64_tr_b16 v[130:131], v160 offset:8704
    ds_read_b64_tr_b16 v[132:133], v161 offset:8192
    ds_read_b64_tr_b16 v[134:135], v161 offset:8704
    v_mfma_f32_32x32x16_bf16 v[224:239], v[148:151], v[152:155], v[224:239]
    v_mfma_f32_32x32x16_bf16 v[240:255], v[148:151], v[156:159], v[240:255]
    s_waitcnt lgkmcnt(6)
    s_add_u32 m0, s87, 0
    s_add_u32 s72, s72, 16384
    buffer_load_dwordx4 v6, s[32:35], s72 offen lds
    buffer_load_dwordx4 v5, s[32:35], s72 offen offset:1024 lds
    s_waitcnt lgkmcnt(0)
    v_mfma_f32_32x32x16_bf16 v[192:207], v[128:131], v[136:139], v[192:207]
    v_mfma_f32_32x32x16_bf16 v[208:223], v[128:131], v[140:143], v[208:223]
    ds_read_b128 v[152:155], v164 offset:480
    ds_read_b128 v[156:159], v165 offset:480
    s_waitcnt vmcnt(6)
    ds_read_b64_tr_b16 v[144:145], v160 offset:32768
    ds_read_b64_tr_b16 v[146:147], v160 offset:33280
    ds_read_b64_tr_b16 v[148:149], v161 offset:32768
    ds_read_b64_tr_b16 v[150:151], v161 offset:33280
    v_mfma_f32_32x32x16_bf16 v[224:239], v[132:135], v[136:139], v[224:239]
    v_mfma_f32_32x32x16_bf16 v[240:255], v[132:135], v[140:143], v[240:255]
    s_add_u32 m0, s87, 8192
    s_add_u32 s78, s78, 57344
    buffer_load_dwordx4 v162, s[24:27], s78 offen lds
    buffer_load_dwordx4 v163, s[24:27], s78 offen offset:1024 lds
    s_add_u32 m0, s86, 66560
    s_add_u32 s79, s79, 32768
    s_and_b32 s79, s79, 0x7ffff
    buffer_load_dwordx4 v14, s[20:23], s79 offen lds
    s_waitcnt vmcnt(7)
    ds_read_b64_tr_b16 v[48:49], v2 offset:16384
    ds_read_b64_tr_b16 v[50:51], v2 offset:17408
    ds_read_b64_tr_b16 v[52:53], v3 offset:16384
    ds_read_b64_tr_b16 v[54:55], v3 offset:17408
    s_waitcnt lgkmcnt(4)
    v_mfma_f32_32x32x16_bf16 v[192:207], v[144:147], v[152:155], v[192:207]
    v_mfma_f32_32x32x16_bf16 v[208:223], v[144:147], v[156:159], v[208:223]
    s_add_u32 m0, s87, 32768
    s_add_u32 s78, s78, 57344
    buffer_load_dwordx4 v162, s[24:27], s78 offen lds
    buffer_load_dwordx4 v163, s[24:27], s78 offen offset:1024 lds
    ds_read_b128 v[136:139], v164 offset:512
    ds_read_b128 v[140:143], v165 offset:512
    s_waitcnt vmcnt(7)
    ds_read_b64_tr_b16 v[128:129], v160 offset:24576
    ds_read_b64_tr_b16 v[130:131], v160 offset:25088
    ds_read_b64_tr_b16 v[132:133], v161 offset:24576
    ds_read_b64_tr_b16 v[134:135], v161 offset:25088
    v_mfma_f32_32x32x16_bf16 v[224:239], v[148:151], v[152:155], v[224:239]
    v_mfma_f32_32x32x16_bf16 v[240:255], v[148:151], v[156:159], v[240:255]
    s_waitcnt lgkmcnt(6)
    s_add_u32 m0, s87, 16384
    s_add_u32 s72, s72, 16384
    buffer_load_dwordx4 v6, s[32:35], s72 offen lds
    buffer_load_dwordx4 v5, s[32:35], s72 offen offset:1024 lds
    s_waitcnt vmcnt(8)
    s_add_u32 m0, s86, 70656
    s_add_u32 s79, s79, 32768
    s_and_b32 s79, s79, 0x7ffff
    buffer_load_dwordx4 v14, s[20:23], s79 offen lds
    s_waitcnt vmcnt(8)
    ds_read_b64_tr_b16 v[56:57], v2 offset:0
    ds_read_b64_tr_b16 v[58:59], v2 offset:1024
    ds_read_b64_tr_b16 v[60:61], v3 offset:0
    ds_read_b64_tr_b16 v[62:63], v3 offset:1024
    s_waitcnt lgkmcnt(4)
    v_mfma_f32_32x32x16_bf16 v[192:207], v[128:131], v[136:139], v[192:207]
    v_mfma_f32_32x32x16_bf16 v[208:223], v[128:131], v[140:143], v[208:223]
    s_add_u32 m0, s87, 24576
    s_add_u32 s78, s78, 57344
    buffer_load_dwordx4 v162, s[24:27], s78 offen lds
    buffer_load_dwordx4 v163, s[24:27], s78 offen offset:1024 lds
    ds_read_b128 v[152:155], v164 offset:544
    ds_read_b128 v[156:159], v165 offset:544
    s_waitcnt vmcnt(8)
    ds_read_b64_tr_b16 v[144:145], v160 offset:8192
    ds_read_b64_tr_b16 v[146:147], v160 offset:8704
    ds_read_b64_tr_b16 v[148:149], v161 offset:8192
    ds_read_b64_tr_b16 v[150:151], v161 offset:8704
    v_mfma_f32_32x32x16_bf16 v[224:239], v[132:135], v[136:139], v[224:239]
    v_mfma_f32_32x32x16_bf16 v[240:255], v[132:135], v[140:143], v[240:255]
    s_waitcnt lgkmcnt(6)
    s_add_u32 m0, s87, 0
    s_add_u32 s78, s78, 57344
    buffer_load_dwordx4 v162, s[24:27], s78 offen lds
    buffer_load_dwordx4 v163, s[24:27], s78 offen offset:1024 lds
    s_waitcnt vmcnt(8)
    s_add_u32 m0, s86, 74752
    s_add_u32 s79, s79, 32768
    s_and_b32 s79, s79, 0x7ffff
    buffer_load_dwordx4 v14, s[20:23], s79 offen lds
    s_waitcnt lgkmcnt(0)
    v_mfma_f32_32x32x16_bf16 v[192:207], v[144:147], v[152:155], v[192:207]
    v_mfma_f32_32x32x16_bf16 v[208:223], v[144:147], v[156:159], v[208:223]
    ds_read_b128 v[136:139], v164 offset:576
    ds_read_b128 v[140:143], v165 offset:576
    s_waitcnt vmcnt(8)
    ds_read_b64_tr_b16 v[128:129], v160 offset:32768
    ds_read_b64_tr_b16 v[130:131], v160 offset:33280
    ds_read_b64_tr_b16 v[132:133], v161 offset:32768
    ds_read_b64_tr_b16 v[134:135], v161 offset:33280
    v_mfma_f32_32x32x16_bf16 v[224:239], v[148:151], v[152:155], v[224:239]
    v_mfma_f32_32x32x16_bf16 v[240:255], v[148:151], v[156:159], v[240:255]
    s_add_u32 m0, s87, 8192
    s_add_u32 s72, s72, 16384
    buffer_load_dwordx4 v6, s[32:35], s72 offen lds
    buffer_load_dwordx4 v5, s[32:35], s72 offen offset:1024 lds
    s_waitcnt vmcnt(8)
    ds_read_b64_tr_b16 v[64:65], v2 offset:16384
    ds_read_b64_tr_b16 v[66:67], v2 offset:17408
    ds_read_b64_tr_b16 v[68:69], v3 offset:16384
    ds_read_b64_tr_b16 v[70:71], v3 offset:17408
    s_waitcnt lgkmcnt(4)
    v_mfma_f32_32x32x16_bf16 v[192:207], v[128:131], v[136:139], v[192:207]
    v_mfma_f32_32x32x16_bf16 v[208:223], v[128:131], v[140:143], v[208:223]
    s_add_u32 m0, s87, 32768
    s_add_u32 s78, s78, 57344
    buffer_load_dwordx4 v162, s[24:27], s78 offen lds
    buffer_load_dwordx4 v163, s[24:27], s78 offen offset:1024 lds
    ds_read_b128 v[152:155], v164 offset:608
    ds_read_b128 v[156:159], v165 offset:608
    s_waitcnt vmcnt(7)
    ds_read_b64_tr_b16 v[144:145], v160 offset:24576
    ds_read_b64_tr_b16 v[146:147], v160 offset:25088
    ds_read_b64_tr_b16 v[148:149], v161 offset:24576
    ds_read_b64_tr_b16 v[150:151], v161 offset:25088
    v_mfma_f32_32x32x16_bf16 v[224:239], v[132:135], v[136:139], v[224:239]
    v_mfma_f32_32x32x16_bf16 v[240:255], v[132:135], v[140:143], v[240:255]
    s_waitcnt lgkmcnt(6)
    s_add_u32 m0, s87, 16384
    s_add_u32 s72, s72, 16384
    s_cmp_eq_u32 s72, s74
    s_cselect_b32 s72, s73, s72
    buffer_load_dwordx4 v6, s[32:35], s72 offen lds
    buffer_load_dwordx4 v5, s[32:35], s72 offen offset:1024 lds
    s_waitcnt vmcnt(8)
    s_add_u32 m0, s86, 78848
    s_add_u32 s79, s79, 32768
    s_and_b32 s79, s79, 0x7ffff
    buffer_load_dwordx4 v14, s[20:23], s79 offen lds
    s_waitcnt lgkmcnt(0)
    v_mfma_f32_32x32x16_bf16 v[192:207], v[144:147], v[152:155], v[192:207]
    v_mfma_f32_32x32x16_bf16 v[208:223], v[144:147], v[156:159], v[208:223]
    ds_read_b128 v[136:139], v164 offset:640
    ds_read_b128 v[140:143], v165 offset:640
    s_waitcnt vmcnt(8)
    ds_read_b64_tr_b16 v[128:129], v160 offset:0
    ds_read_b64_tr_b16 v[130:131], v160 offset:512
    ds_read_b64_tr_b16 v[132:133], v161 offset:0
    ds_read_b64_tr_b16 v[134:135], v161 offset:512
    v_mfma_f32_32x32x16_bf16 v[224:239], v[148:151], v[152:155], v[224:239]
    v_mfma_f32_32x32x16_bf16 v[240:255], v[148:151], v[156:159], v[240:255]
    s_add_u32 m0, s87, 24576
    s_add_u32 s78, s78, 57344
    buffer_load_dwordx4 v162, s[24:27], s78 offen lds
    buffer_load_dwordx4 v163, s[24:27], s78 offen offset:1024 lds
    s_waitcnt vmcnt(8)
    s_add_u32 m0, s86, 82944
    s_add_u32 s79, s79, 32768
    s_and_b32 s79, s79, 0x7ffff
    buffer_load_dwordx4 v14, s[20:23], s79 offen lds
    s_waitcnt vmcnt(8)
    ds_read_b64_tr_b16 v[72:73], v2 offset:8192
    ds_read_b64_tr_b16 v[74:75], v2 offset:9216
    ds_read_b64_tr_b16 v[76:77], v3 offset:8192
    ds_read_b64_tr_b16 v[78:79], v3 offset:9216
    s_waitcnt lgkmcnt(4)
    v_mfma_f32_32x32x16_bf16 v[192:207], v[128:131], v[136:139], v[192:207]
    v_mfma_f32_32x32x16_bf16 v[208:223], v[128:131], v[140:143], v[208:223]
    s_add_u32 m0, s87, 0
    s_add_u32 s78, s78, 57344
    buffer_load_dwordx4 v162, s[24:27], s78 offen lds
    buffer_load_dwordx4 v163, s[24:27], s78 offen offset:1024 lds
    ds_read_b128 v[152:155], v164 offset:672
    ds_read_b128 v[156:159], v165 offset:672
    s_waitcnt vmcnt(8)
    ds_read_b64_tr_b16 v[144:145], v160 offset:32768
    ds_read_b64_tr_b16 v[146:147], v160 offset:33280
    ds_read_b64_tr_b16 v[148:149], v161 offset:32768
    ds_read_b64_tr_b16 v[150:151], v161 offset:33280
    v_mfma_f32_32x32x16_bf16 v[224:239], v[132:135], v[136:139], v[224:239]
    v_mfma_f32_32x32x16_bf16 v[240:255], v[132:135], v[140:143], v[240:255]
    s_waitcnt lgkmcnt(6)
    s_add_u32 m0, s87, 8192
    s_add_u32 s72, s72, 16384
    buffer_load_dwordx4 v6, s[32:35], s72 offen lds
    buffer_load_dwordx4 v5, s[32:35], s72 offen offset:1024 lds
    s_waitcnt vmcnt(8)
    ds_read_b64_tr_b16 v[80:81], v2 offset:16384
    ds_read_b64_tr_b16 v[82:83], v2 offset:17408
    ds_read_b64_tr_b16 v[84:85], v3 offset:16384
    ds_read_b64_tr_b16 v[86:87], v3 offset:17408
    s_waitcnt lgkmcnt(4)
    v_mfma_f32_32x32x16_bf16 v[192:207], v[144:147], v[152:155], v[192:207]
    v_mfma_f32_32x32x16_bf16 v[208:223], v[144:147], v[156:159], v[208:223]
    s_add_u32 m0, s87, 32768
    s_add_u32 s78, s78, 57344
    buffer_load_dwordx4 v162, s[24:27], s78 offen lds
    buffer_load_dwordx4 v163, s[24:27], s78 offen offset:1024 lds
    ds_read_b128 v[136:139], v164 offset:704
    ds_read_b128 v[140:143], v165 offset:704
    s_waitcnt vmcnt(7)
    ds_read_b64_tr_b16 v[128:129], v160 offset:24576
    ds_read_b64_tr_b16 v[130:131], v160 offset:25088
    ds_read_b64_tr_b16 v[132:133], v161 offset:24576
    ds_read_b64_tr_b16 v[134:135], v161 offset:25088
    v_mfma_f32_32x32x16_bf16 v[224:239], v[148:151], v[152:155], v[224:239]
    v_mfma_f32_32x32x16_bf16 v[240:255], v[148:151], v[156:159], v[240:255]
    s_waitcnt lgkmcnt(6)
    s_add_u32 m0, s87, 16384
    s_add_u32 s72, s72, 16384
    buffer_load_dwordx4 v6, s[32:35], s72 offen lds
    buffer_load_dwordx4 v5, s[32:35], s72 offen offset:1024 lds
    s_waitcnt vmcnt(8)
    s_add_u32 m0, s86, 87040
    s_add_u32 s79, s79, 32768
    s_and_b32 s79, s79, 0x7ffff
    buffer_load_dwordx4 v14, s[20:23], s79 offen lds
    s_waitcnt lgkmcnt(0)
    v_mfma_f32_32x32x16_bf16 v[192:207], v[128:131], v[136:139], v[192:207]
    v_mfma_f32_32x32x16_bf16 v[208:223], v[128:131], v[140:143], v[208:223]
    ds_read_b128 v[152:155], v164 offset:736
    ds_read_b128 v[156:159], v165 offset:736
    s_waitcnt vmcnt(7)
    ds_read_b64_tr_b16 v[144:145], v160 offset:0
    ds_read_b64_tr_b16 v[146:147], v160 offset:512
    ds_read_b64_tr_b16 v[148:149], v161 offset:0
    ds_read_b64_tr_b16 v[150:151], v161 offset:512
    v_mfma_f32_32x32x16_bf16 v[224:239], v[132:135], v[136:139], v[224:239]
    v_mfma_f32_32x32x16_bf16 v[240:255], v[132:135], v[140:143], v[240:255]
    s_add_u32 m0, s87, 24576
    s_add_u32 s78, s78, 57344
    buffer_load_dwordx4 v162, s[24:27], s78 offen lds
    buffer_load_dwordx4 v163, s[24:27], s78 offen offset:1024 lds
    s_waitcnt vmcnt(8)
    s_add_u32 m0, s86, 91136
    s_add_u32 s79, s79, 32768
    s_and_b32 s79, s79, 0x7ffff
    buffer_load_dwordx4 v14, s[20:23], s79 offen lds
    s_waitcnt vmcnt(8)
    ds_read_b64_tr_b16 v[88:89], v2 offset:8192
    ds_read_b64_tr_b16 v[90:91], v2 offset:9216
    ds_read_b64_tr_b16 v[92:93], v3 offset:8192
    ds_read_b64_tr_b16 v[94:95], v3 offset:9216
    s_waitcnt lgkmcnt(4)
    v_mfma_f32_32x32x16_bf16 v[192:207], v[144:147], v[152:155], v[192:207]
    v_mfma_f32_32x32x16_bf16 v[208:223], v[144:147], v[156:159], v[208:223]
    s_add_u32 m0, s87, 0
    s_add_u32 s78, s78, 57344
    buffer_load_dwordx4 v162, s[24:27], s78 offen lds
    buffer_load_dwordx4 v163, s[24:27], s78 offen offset:1024 lds
    ds_read_b128 v[136:139], v164 offset:768
    ds_read_b128 v[140:143], v165 offset:768
    s_waitcnt vmcnt(8)
    ds_read_b64_tr_b16 v[128:129], v160 offset:32768
    ds_read_b64_tr_b16 v[130:131], v160 offset:33280
    ds_read_b64_tr_b16 v[132:133], v161 offset:32768
    ds_read_b64_tr_b16 v[134:135], v161 offset:33280
    v_mfma_f32_32x32x16_bf16 v[224:239], v[148:151], v[152:155], v[224:239]
    v_mfma_f32_32x32x16_bf16 v[240:255], v[148:151], v[156:159], v[240:255]
    s_waitcnt lgkmcnt(6)
    s_add_u32 m0, s87, 8192
    s_add_u32 s72, s72, 16384
    buffer_load_dwordx4 v6, s[32:35], s72 offen lds
    buffer_load_dwordx4 v5, s[32:35], s72 offen offset:1024 lds
    s_waitcnt vmcnt(8)
    s_add_u32 m0, s86, 95232
    s_add_u32 s79, s79, 32768
    s_and_b32 s79, s79, 0x7ffff
    buffer_load_dwordx4 v14, s[20:23], s79 offen lds
    ds_read_b64_tr_b16 v[96:97], v2 offset:16384
    ds_read_b64_tr_b16 v[98:99], v2 offset:17408
    ds_read_b64_tr_b16 v[100:101], v3 offset:16384
    ds_read_b64_tr_b16 v[102:103], v3 offset:17408
    s_waitcnt lgkmcnt(4)
    v_mfma_f32_32x32x16_bf16 v[192:207], v[128:131], v[136:139], v[192:207]
    v_mfma_f32_32x32x16_bf16 v[208:223], v[128:131], v[140:143], v[208:223]
    s_waitcnt vmcnt(8)
    s_add_u32 m0, s87, 32768
    s_add_u32 s78, s78, 57344
    buffer_load_dwordx4 v162, s[24:27], s78 offen lds
    buffer_load_dwordx4 v163, s[24:27], s78 offen offset:1024 lds
    ds_read_b128 v[152:155], v164 offset:800
    ds_read_b128 v[156:159], v165 offset:800
    s_waitcnt vmcnt(8)
    ds_read_b64_tr_b16 v[144:145], v160 offset:24576
    ds_read_b64_tr_b16 v[146:147], v160 offset:25088
    ds_read_b64_tr_b16 v[148:149], v161 offset:24576
    ds_read_b64_tr_b16 v[150:151], v161 offset:25088
    v_mfma_f32_32x32x16_bf16 v[224:239], v[132:135], v[136:139], v[224:239]
    v_mfma_f32_32x32x16_bf16 v[240:255], v[132:135], v[140:143], v[240:255]
    s_waitcnt lgkmcnt(6)
    s_add_u32 m0, s87, 16384
    s_add_u32 s72, s72, 16384
    s_cmp_eq_u32 s72, s74
    s_cselect_b32 s72, s73, s72
    buffer_load_dwordx4 v6, s[32:35], s72 offen lds
    buffer_load_dwordx4 v5, s[32:35], s72 offen offset:1024 lds
    s_waitcnt lgkmcnt(0)
    v_mfma_f32_32x32x16_bf16 v[192:207], v[144:147], v[152:155], v[192:207]
    v_mfma_f32_32x32x16_bf16 v[208:223], v[144:147], v[156:159], v[208:223]
    ds_read_b128 v[136:139], v164 offset:832
    ds_read_b128 v[140:143], v165 offset:832
    s_waitcnt vmcnt(7)
    ds_read_b64_tr_b16 v[128:129], v160 offset:0
    ds_read_b64_tr_b16 v[130:131], v160 offset:512
    ds_read_b64_tr_b16 v[132:133], v161 offset:0
    ds_read_b64_tr_b16 v[134:135], v161 offset:512
    v_mfma_f32_32x32x16_bf16 v[224:239], v[148:151], v[152:155], v[224:239]
    v_mfma_f32_32x32x16_bf16 v[240:255], v[148:151], v[156:159], v[240:255]
    s_add_u32 m0, s87, 24576
    s_add_u32 s78, s78, 57344
    buffer_load_dwordx4 v162, s[24:27], s78 offen lds
    buffer_load_dwordx4 v163, s[24:27], s78 offen offset:1024 lds
    s_waitcnt vmcnt(8)
    s_add_u32 m0, s86, 99328
    s_add_u32 s79, s79, 32768
    s_and_b32 s79, s79, 0x7ffff
    buffer_load_dwordx4 v14, s[20:23], s79 offen lds
    s_waitcnt vmcnt(8)
    ds_read_b64_tr_b16 v[104:105], v2 offset:8192
    ds_read_b64_tr_b16 v[106:107], v2 offset:9216
    ds_read_b64_tr_b16 v[108:109], v3 offset:8192
    ds_read_b64_tr_b16 v[110:111], v3 offset:9216
    s_waitcnt lgkmcnt(4)
    v_mfma_f32_32x32x16_bf16 v[192:207], v[128:131], v[136:139], v[192:207]
    v_mfma_f32_32x32x16_bf16 v[208:223], v[128:131], v[140:143], v[208:223]
    s_add_u32 m0, s87, 0
    s_add_u32 s78, s78, 57344
    buffer_load_dwordx4 v162, s[24:27], s78 offen lds
    buffer_load_dwordx4 v163, s[24:27], s78 offen offset:1024 lds
    ds_read_b128 v[152:155], v164 offset:864
    ds_read_b128 v[156:159], v165 offset:864
    s_waitcnt vmcnt(7)
    ds_read_b64_tr_b16 v[144:145], v160 offset:32768
    ds_read_b64_tr_b16 v[146:147], v160 offset:33280
    ds_read_b64_tr_b16 v[148:149], v161 offset:32768
    ds_read_b64_tr_b16 v[150:151], v161 offset:33280
    v_mfma_f32_32x32x16_bf16 v[224:239], v[132:135], v[136:139], v[224:239]
    v_mfma_f32_32x32x16_bf16 v[240:255], v[132:135], v[140:143], v[240:255]
    s_waitcnt lgkmcnt(6)
    s_add_u32 m0, s87, 8192
    s_add_u32 s72, s72, 16384
    buffer_load_dwordx4 v6, s[32:35], s72 offen lds
    buffer_load_dwordx4 v5, s[32:35], s72 offen offset:1024 lds
    s_waitcnt vmcnt(8)
    s_add_u32 m0, s86, 103424
    s_add_u32 s79, s79, 32768
    s_and_b32 s79, s79, 0x7ffff
    buffer_load_dwordx4 v14, s[20:23], s79 offen lds
    s_waitcnt vmcnt(8)
    ds_read_b64_tr_b16 v[112:113], v2 offset:16384
    ds_read_b64_tr_b16 v[114:115], v2 offset:17408
    ds_read_b64_tr_b16 v[116:117], v3 offset:16384
    ds_read_b64_tr_b16 v[118:119], v3 offset:17408
    s_waitcnt lgkmcnt(4)
    v_mfma_f32_32x32x16_bf16 v[192:207], v[144:147], v[152:155], v[192:207]
    v_mfma_f32_32x32x16_bf16 v[208:223], v[144:147], v[156:159], v[208:223]
    s_add_u32 m0, s87, 32768
    s_add_u32 s78, s78, 57344
    buffer_load_dwordx4 v162, s[24:27], s78 offen lds
    buffer_load_dwordx4 v163, s[24:27], s78 offen offset:1024 lds
    ds_read_b128 v[136:139], v164 offset:896
    ds_read_b128 v[140:143], v165 offset:896
    s_waitcnt vmcnt(8)
    ds_read_b64_tr_b16 v[128:129], v160 offset:24576
    ds_read_b64_tr_b16 v[130:131], v160 offset:25088
    ds_read_b64_tr_b16 v[132:133], v161 offset:24576
    ds_read_b64_tr_b16 v[134:135], v161 offset:25088
    v_mfma_f32_32x32x16_bf16 v[224:239], v[148:151], v[152:155], v[224:239]
    v_mfma_f32_32x32x16_bf16 v[240:255], v[148:151], v[156:159], v[240:255]
    s_waitcnt lgkmcnt(6)
    s_add_u32 m0, s87, 16384
    s_add_u32 s78, s78, 57344
    buffer_load_dwordx4 v162, s[24:27], s78 offen lds
    buffer_load_dwordx4 v163, s[24:27], s78 offen offset:1024 lds
    s_waitcnt lgkmcnt(0)
    v_mfma_f32_32x32x16_bf16 v[192:207], v[128:131], v[136:139], v[192:207]
    v_mfma_f32_32x32x16_bf16 v[208:223], v[128:131], v[140:143], v[208:223]
    ds_read_b128 v[152:155], v164 offset:928
    ds_read_b128 v[156:159], v165 offset:928
    s_waitcnt vmcnt(7)
    ds_read_b64_tr_b16 v[144:145], v160 offset:0
    ds_read_b64_tr_b16 v[146:147], v160 offset:512
    ds_read_b64_tr_b16 v[148:149], v161 offset:0
    ds_read_b64_tr_b16 v[150:151], v161 offset:512
    v_mfma_f32_32x32x16_bf16 v[224:239], v[132:135], v[136:139], v[224:239]
    v_mfma_f32_32x32x16_bf16 v[240:255], v[132:135], v[140:143], v[240:255]
    s_add_u32 m0, s87, 24576
    s_add_u32 s72, s72, 16384
    buffer_load_dwordx4 v6, s[32:35], s72 offen lds
    buffer_load_dwordx4 v5, s[32:35], s72 offen offset:1024 lds
    s_waitcnt vmcnt(8)
    s_add_u32 m0, s86, 107520
    s_add_u32 s79, s79, 32768
    s_and_b32 s79, s79, 0x7ffff
    buffer_load_dwordx4 v14, s[20:23], s79 offen lds
    s_waitcnt vmcnt(8)
    ds_read_b64_tr_b16 v[120:121], v2 offset:8192
    ds_read_b64_tr_b16 v[122:123], v2 offset:9216
    ds_read_b64_tr_b16 v[124:125], v3 offset:8192
    ds_read_b64_tr_b16 v[126:127], v3 offset:9216
    s_waitcnt lgkmcnt(4)
    v_mfma_f32_32x32x16_bf16 v[192:207], v[144:147], v[152:155], v[192:207]
    v_mfma_f32_32x32x16_bf16 v[208:223], v[144:147], v[156:159], v[208:223]
    s_add_u32 m0, s87, 0
    s_add_u32 s72, s72, 16384
    buffer_load_dwordx4 v6, s[32:35], s72 offen lds
    buffer_load_dwordx4 v5, s[32:35], s72 offen offset:1024 lds
    ds_read_b128 v[136:139], v164 offset:960
    ds_read_b128 v[140:143], v165 offset:960
    s_waitcnt vmcnt(7)
    ds_read_b64_tr_b16 v[128:129], v160 offset:32768
    ds_read_b64_tr_b16 v[130:131], v160 offset:33280
    ds_read_b64_tr_b16 v[132:133], v161 offset:32768
    ds_read_b64_tr_b16 v[134:135], v161 offset:33280
    v_mfma_f32_32x32x16_bf16 v[224:239], v[148:151], v[152:155], v[224:239]
    v_mfma_f32_32x32x16_bf16 v[240:255], v[148:151], v[156:159], v[240:255]
    s_waitcnt lgkmcnt(6)
    s_add_u32 m0, s87, 8192
    s_add_u32 s72, s72, 16384
    s_cmp_eq_u32 s72, s74
    s_cselect_b32 s72, s73, s72
    buffer_load_dwordx4 v6, s[32:35], s72 offen lds
    buffer_load_dwordx4 v5, s[32:35], s72 offen offset:1024 lds
    s_waitcnt vmcnt(8)
    s_add_u32 m0, s86, 111616
    s_add_u32 s79, s79, 32768
    s_and_b32 s79, s79, 0x7ffff
    buffer_load_dwordx4 v14, s[20:23], s79 offen lds
    s_waitcnt lgkmcnt(0)
    v_mfma_f32_32x32x16_bf16 v[192:207], v[128:131], v[136:139], v[192:207]
    v_mfma_f32_32x32x16_bf16 v[208:223], v[128:131], v[140:143], v[208:223]
    ds_read_b128 v[152:155], v164 offset:992
    ds_read_b128 v[156:159], v165 offset:992
    s_waitcnt vmcnt(8)
    ds_read_b64_tr_b16 v[144:145], v160 offset:16384
    ds_read_b64_tr_b16 v[146:147], v160 offset:16896
    ds_read_b64_tr_b16 v[148:149], v161 offset:16384
    ds_read_b64_tr_b16 v[150:151], v161 offset:16896
    v_mfma_f32_32x32x16_bf16 v[224:239], v[132:135], v[136:139], v[224:239]
    v_mfma_f32_32x32x16_bf16 v[240:255], v[132:135], v[140:143], v[240:255]
    s_add_u32 m0, s87, 32768
    s_add_u32 s72, s72, 16384
    buffer_load_dwordx4 v6, s[32:35], s72 offen lds
    buffer_load_dwordx4 v5, s[32:35], s72 offen offset:1024 lds
    s_waitcnt lgkmcnt(0)
    v_mfma_f32_32x32x16_bf16 v[192:207], v[144:147], v[152:155], v[192:207]
    v_mfma_f32_32x32x16_bf16 v[208:223], v[144:147], v[156:159], v[208:223]
    v_mfma_f32_32x32x16_bf16 v[224:239], v[148:151], v[152:155], v[224:239]
    v_mfma_f32_32x32x16_bf16 v[240:255], v[148:151], v[156:159], v[240:255]
    v_mfma_f32_32x32x16_bf16 v[192:207], v[176:179], v[184:187], v[192:207]
    v_mfma_f32_32x32x16_bf16 v[208:223], v[176:179], v[188:191], v[208:223]
    v_mfma_f32_32x32x16_bf16 v[224:239], v[180:183], v[184:187], v[224:239]
    v_mfma_f32_32x32x16_bf16 v[240:255], v[180:183], v[188:191], v[240:255]
    s_mov_b64 exec, 1
    ds_add_u32 v11, v12 offset:8
    s_mov_b64 exec, -1
    s_waitcnt vmcnt(8)
    s_add_u32 m0, s87, 16384
    s_add_u32 s72, s72, 16384
    buffer_load_dwordx4 v6, s[32:35], s72 offen lds
    buffer_load_dwordx4 v5, s[32:35], s72 offen offset:1024 lds
    s_add_u32 s62, s55, 4096
    s_nop 7
    s_setprio 2
    v_lshl_or_b32 v176, v166, 16, v166
    v_mov_b32 v184, v171
    v_mul_f32 v192, v192, |v192|
    v_mul_f32 v193, v193, |v193|
    v_mul_f32 v194, v194, |v194|
    v_mul_f32 v195, v195, |v195|
    v_mul_f32 v196, v196, |v196|
    v_mul_f32 v197, v197, |v197|
    v_mul_f32 v198, v198, |v198|
    v_mul_f32 v199, v199, |v199|
    v_cvt_pk_bf16_f32 v128, v192, v193
    v_cvt_pk_bf16_f32 v129, v194, v195
    v_cvt_pk_bf16_f32 v130, v196, v197
    v_cvt_pk_bf16_f32 v131, v198, v199
    v_pk_max_i16 v128, v128, 0
    v_pk_max_i16 v129, v129, 0
    v_pk_max_i16 v130, v130, 0
    v_pk_max_i16 v131, v131, 0
    buffer_store_dwordx4 v[128:131], v4, s[16:19], s55 offen offset:0 sc1
    v_mul_f32 v208, v208, |v208|
    v_mul_f32 v209, v209, |v209|
    v_mul_f32 v210, v210, |v210|
    v_mul_f32 v211, v211, |v211|
    v_mul_f32 v212, v212, |v212|
    v_mul_f32 v213, v213, |v213|
    v_mul_f32 v214, v214, |v214|
    v_mul_f32 v215, v215, |v215|
    v_cvt_pk_bf16_f32 v132, v208, v209
    v_cvt_pk_bf16_f32 v133, v210, v211
    v_cvt_pk_bf16_f32 v134, v212, v213
    v_cvt_pk_bf16_f32 v135, v214, v215
    v_pk_max_i16 v132, v132, 0
    v_pk_max_i16 v133, v133, 0
    v_pk_max_i16 v134, v134, 0
    v_pk_max_i16 v135, v135, 0
    buffer_store_dwordx4 v[132:135], v8, s[16:19], s55 offen offset:0 sc1
    v_mul_f32 v200, v200, |v200|
    v_mul_f32 v201, v201, |v201|
    v_mul_f32 v202, v202, |v202|
    v_mul_f32 v203, v203, |v203|
    v_mul_f32 v204, v204, |v204|
    v_mul_f32 v205, v205, |v205|
    v_mul_f32 v206, v206, |v206|
    v_mul_f32 v207, v207, |v207|
    v_cvt_pk_bf16_f32 v136, v200, v201
    v_cvt_pk_bf16_f32 v137, v202, v203
    v_cvt_pk_bf16_f32 v138, v204, v205
    v_cvt_pk_bf16_f32 v139, v206, v207
    v_pk_max_i16 v136, v136, 0
    v_pk_max_i16 v137, v137, 0
    v_pk_max_i16 v138, v138, 0
    v_pk_max_i16 v139, v139, 0
    buffer_store_dwordx4 v[136:139], v4, s[16:19], s55 offen offset:2048 sc1
    v_mul_f32 v216, v216, |v216|
    v_mul_f32 v217, v217, |v217|
    v_mul_f32 v218, v218, |v218|
    v_mul_f32 v219, v219, |v219|
    v_mul_f32 v220, v220, |v220|
    v_mul_f32 v221, v221, |v221|
    v_mul_f32 v222, v222, |v222|
    v_mul_f32 v223, v223, |v223|
    v_cvt_pk_bf16_f32 v140, v216, v217
    v_cvt_pk_bf16_f32 v141, v218, v219
    v_cvt_pk_bf16_f32 v142, v220, v221
    v_cvt_pk_bf16_f32 v143, v222, v223
    v_pk_max_i16 v140, v140, 0
    v_pk_max_i16 v141, v141, 0
    v_pk_max_i16 v142, v142, 0
    v_pk_max_i16 v143, v143, 0
    buffer_store_dwordx4 v[140:143], v8, s[16:19], s55 offen offset:2048 sc1
    v_mul_f32 v224, v224, |v224|
    v_mul_f32 v225, v225, |v225|
    v_mul_f32 v226, v226, |v226|
    v_mul_f32 v227, v227, |v227|
    v_mul_f32 v228, v228, |v228|
    v_mul_f32 v229, v229, |v229|
    v_mul_f32 v230, v230, |v230|
    v_mul_f32 v231, v231, |v231|
    v_cvt_pk_bf16_f32 v144, v224, v225
    v_cvt_pk_bf16_f32 v145, v226, v227
    v_cvt_pk_bf16_f32 v146, v228, v229
    v_cvt_pk_bf16_f32 v147, v230, v231
    v_pk_max_i16 v144, v144, 0
    v_pk_max_i16 v145, v145, 0
    v_pk_max_i16 v146, v146, 0
    v_pk_max_i16 v147, v147, 0
    buffer_store_dwordx4 v[144:147], v4, s[16:19], s62 offen offset:0 sc1
    v_mul_f32 v240, v240, |v240|
    v_mul_f32 v241, v241, |v241|
    v_mul_f32 v242, v242, |v242|
    v_mul_f32 v243, v243, |v243|
    v_mul_f32 v244, v244, |v244|
    v_mul_f32 v245, v245, |v245|
    v_mul_f32 v246, v246, |v246|
    v_mul_f32 v247, v247, |v247|
    v_cvt_pk_bf16_f32 v148, v240, v241
    v_cvt_pk_bf16_f32 v149, v242, v243
    v_cvt_pk_bf16_f32 v150, v244, v245
    v_cvt_pk_bf16_f32 v151, v246, v247
    v_pk_max_i16 v148, v148, 0
    v_pk_max_i16 v149, v149, 0
    v_pk_max_i16 v150, v150, 0
    v_pk_max_i16 v151, v151, 0
    buffer_store_dwordx4 v[148:151], v8, s[16:19], s62 offen offset:0 sc1
    v_mul_f32 v232, v232, |v232|
    v_mul_f32 v233, v233, |v233|
    v_mul_f32 v234, v234, |v234|
    v_mul_f32 v235, v235, |v235|
    v_mul_f32 v236, v236, |v236|
    v_mul_f32 v237, v237, |v237|
    v_mul_f32 v238, v238, |v238|
    v_mul_f32 v239, v239, |v239|
    v_cvt_pk_bf16_f32 v152, v232, v233
    v_cvt_pk_bf16_f32 v153, v234, v235
    v_cvt_pk_bf16_f32 v154, v236, v237
    v_cvt_pk_bf16_f32 v155, v238, v239
    v_pk_max_i16 v152, v152, 0
    v_pk_max_i16 v153, v153, 0
    v_pk_max_i16 v154, v154, 0
    v_pk_max_i16 v155, v155, 0
    buffer_store_dwordx4 v[152:155], v4, s[16:19], s62 offen offset:2048 sc1
    v_mul_f32 v248, v248, |v248|
    v_mul_f32 v249, v249, |v249|
    v_mul_f32 v250, v250, |v250|
    v_mul_f32 v251, v251, |v251|
    v_mul_f32 v252, v252, |v252|
    v_mul_f32 v253, v253, |v253|
    v_mul_f32 v254, v254, |v254|
    v_mul_f32 v255, v255, |v255|
    v_cvt_pk_bf16_f32 v156, v248, v249
    v_cvt_pk_bf16_f32 v157, v250, v251
    v_cvt_pk_bf16_f32 v158, v252, v253
    v_cvt_pk_bf16_f32 v159, v254, v255
    v_pk_max_i16 v156, v156, 0
    v_pk_max_i16 v157, v157, 0
    v_pk_max_i16 v158, v158, 0
    v_pk_max_i16 v159, v159, 0
    buffer_store_dwordx4 v[156:159], v8, s[16:19], s62 offen offset:2048 sc1
    s_setprio 0
    v_mfma_f32_32x32x16_bf16 v[192:207], v[176:179], v[184:187], 0
    v_mfma_f32_32x32x16_bf16 v[192:207], v[16:19], v[128:131], v[192:207]
    v_mfma_f32_32x32x16_bf16 v[208:223], v[16:19], v[132:135], 0
    v_mfma_f32_32x32x16_bf16 v[224:239], v[20:23], v[128:131], 0
    v_mfma_f32_32x32x16_bf16 v[240:255], v[20:23], v[132:135], 0
    ds_read_b64_tr_b16 v[160:161], v2 offset:24576
    ds_read_b64_tr_b16 v[162:163], v2 offset:25600
    ds_read_b64_tr_b16 v[164:165], v3 offset:24576
    ds_read_b64_tr_b16 v[166:167], v3 offset:25600
    v_mfma_f32_32x32x16_bf16 v[192:207], v[24:27], v[136:139], v[192:207]
    v_mfma_f32_32x32x16_bf16 v[208:223], v[24:27], v[140:143], v[208:223]
    s_waitcnt lgkmcnt(0)
    s_waitcnt vmcnt(14)
    s_add_u32 m0, s87, 24576
    s_add_u32 s72, s72, 16384
    buffer_load_dwordx4 v6, s[32:35], s72 offen lds
    buffer_load_dwordx4 v5, s[32:35], s72 offen offset:1024 lds
    v_mfma_f32_32x32x16_bf16 v[224:239], v[28:31], v[136:139], v[224:239]
    v_mfma_f32_32x32x16_bf16 v[240:255], v[28:31], v[140:143], v[240:255]
    ds_read_b64_tr_b16 v[168:169], v2 offset:0
    ds_read_b64_tr_b16 v[170:171], v2 offset:1024
    ds_read_b64_tr_b16 v[172:173], v3 offset:0
    ds_read_b64_tr_b16 v[174:175], v3 offset:1024
    v_mfma_f32_32x32x16_bf16 v[192:207], v[32:35], v[144:147], v[192:207]
    v_mfma_f32_32x32x16_bf16 v[208:223], v[32:35], v[148:151], v[208:223]
    s_waitcnt vmcnt(2)
    s_mov_b64 exec, 1
    s_cmp_lg_u32 s49, 0
    s_cbranch_scc0 L_g0
    buffer_store_dword v9, v13, s[16:19], s98 offen
L_b0:
    s_mov_b64 exec, -1
    buffer_load_dword v10, v0, s[44:47], 0 offen sc1
    s_waitcnt lgkmcnt(0)
    s_add_u32 m0, s87, 0
    s_add_u32 s72, s72, 16384
    s_cmp_eq_u32 s72, s74
    s_cselect_b32 s72, s73, s72
    buffer_load_dwordx4 v6, s[32:35], s72 offen lds
    buffer_load_dwordx4 v5, s[32:35], s72 offen offset:1024 lds
    v_mfma_f32_32x32x16_bf16 v[224:239], v[36:39], v[144:147], v[224:239]
    v_mfma_f32_32x32x16_bf16 v[240:255], v[36:39], v[148:151], v[240:255]
    s_waitcnt vmcnt(2)
    s_mov_b64 exec, 1
    s_setprio 2
    v_cmp_ne_u32 vcc, s7, v10
    s_cbranch_vccz L_done_hf1
    s_mov_b32 s84, 400000
L_poll_hf1:
    buffer_load_dword v10, v0, s[44:47], 0 offen sc1
    s_waitcnt vmcnt(0)
    v_cmp_ne_u32 vcc, s7, v10
    s_cbranch_vccz L_done_hf1
    s_sleep 2
    s_sub_u32 s84, s84, 1
    s_cmp_lg_u32 s84, 0
    s_cbranch_scc1 L_poll_hf1
L_done_hf1:
    s_setprio 0
    s_mov_b64 exec, -1
    ds_read_b64_tr_b16 v[176:177], v2 offset:8192
    ds_read_b64_tr_b16 v[178:179], v2 offset:9216
    ds_read_b64_tr_b16 v[180:181], v3 offset:8192
    ds_read_b64_tr_b16 v[182:183], v3 offset:9216
    s_add_u32 s75, s75, 2048
    s_cmp_eq_u32 s75, s77
    s_cselect_b32 s75, s76, s75
    buffer_load_dwordx4 v[184:187], v4, s[44:47], s75 offen sc1
    buffer_load_dwordx4 v[188:191], v8, s[44:47], s75 offen sc1
    s_add_u32 s75, s75, 2048
    buffer_load_dwordx4 v[16:19], v4, s[44:47], s75 offen sc1
    buffer_load_dwordx4 v[20:23], v8, s[44:47], s75 offen sc1
    s_add_u32 s75, s75, 2048
    buffer_load_dwordx4 v[128:131], v4, s[44:47], s75 offen sc1
    buffer_load_dwordx4 v[132:135], v8, s[44:47], s75 offen sc1
    s_add_u32 s75, s75, 2048
    buffer_load_dwordx4 v[24:27], v4, s[44:47], s75 offen sc1
    buffer_load_dwordx4 v[28:31], v8, s[44:47], s75 offen sc1
    v_mfma_f32_32x32x16_bf16 v[192:207], v[40:43], v[152:155], v[192:207]
    v_mfma_f32_32x32x16_bf16 v[208:223], v[40:43], v[156:159], v[208:223]
    s_waitcnt lgkmcnt(0)
    s_waitcnt vmcnt(8)
    s_add_u32 m0, s87, 8192
    s_add_u32 s72, s72, 16384
    buffer_load_dwordx4 v6, s[32:35], s72 offen lds
    buffer_load_dwordx4 v5, s[32:35], s72 offen offset:1024 lds
    v_mfma_f32_32x32x16_bf16 v[224:239], v[44:47], v[152:155], v[224:239]
    v_mfma_f32_32x32x16_bf16 v[240:255], v[44:47], v[156:159], v[240:255]
    ds_read_b64_tr_b16 v[136:137], v2 offset:32768
    ds_read_b64_tr_b16 v[138:139], v2 offset:33792
    ds_read_b64_tr_b16 v[140:141], v3 offset:32768
    ds_read_b64_tr_b16 v[142:143], v3 offset:33792
    s_waitcnt vmcnt(8)
    v_mfma_f32_32x32x16_bf16 v[192:207], v[48:51], v[184:187], v[192:207]
    v_mfma_f32_32x32x16_bf16 v[208:223], v[48:51], v[188:191], v[208:223]
    buffer_load_dword v10, v0, s[44:47], 0 offen sc1
    s_waitcnt lgkmcnt(0)
    s_waitcnt vmcnt(8)
    s_add_u32 m0, s87, 32768
    s_add_u32 s72, s72, 16384
    buffer_load_dwordx4 v6, s[32:35], s72 offen lds
    buffer_load_dwordx4 v5, s[32:35], s72 offen offset:1024 lds
    v_mfma_f32_32x32x16_bf16 v[224:239], v[52:55], v[184:187], v[224:239]
    v_mfma_f32_32x32x16_bf16 v[240:255], v[52:55], v[188:191], v[240:255]
    ds_read_b64_tr_b16 v[32:33], v2 offset:16384
    ds_read_b64_tr_b16 v[34:35], v2 offset:17408
    ds_read_b64_tr_b16 v[36:37], v3 offset:16384
    ds_read_b64_tr_b16 v[38:39], v3 offset:17408
    s_waitcnt vmcnt(9)
    v_mfma_f32_32x32x16_bf16 v[192:207], v[56:59], v[16:19], v[192:207]
    v_mfma_f32_32x32x16_bf16 v[208:223], v[56:59], v[20:23], v[208:223]
    s_waitcnt lgkmcnt(0)
    s_waitcnt vmcnt(8)
    s_add_u32 m0, s87, 16384
    s_add_u32 s72, s72, 16384
    buffer_load_dwordx4 v6, s[32:35], s72 offen lds
    buffer_load_dwordx4 v5, s[32:35], s72 offen offset:1024 lds
    v_mfma_f32_32x32x16_bf16 v[224:239], v[60:63], v[16:19], v[224:239]
    v_mfma_f32_32x32x16_bf16 v[240:255], v[60:63], v[20:23], v[240:255]
    s_waitcnt vmcnt(4)
    s_mov_b64 exec, 7
    s_setprio 2
    v_cmp_ne_u32 vcc, s7, v10
    s_cbranch_vccz L_done_hf3
    s_mov_b32 s84, 400000
L_poll_hf3:
    buffer_load_dword v10, v0, s[44:47], 0 offen sc1
    s_waitcnt vmcnt(0)
    v_cmp_ne_u32 vcc, s7, v10
    s_cbranch_vccz L_done_hf3
    s_sleep 2
    s_sub_u32 s84, s84, 1
    s_cmp_lg_u32 s84, 0
    s_cbranch_scc1 L_poll_hf3
L_done_hf3:
    s_setprio 0
    s_mov_b64 exec, -1
    ds_read_b64_tr_b16 v[144:145], v2 offset:24576
    ds_read_b64_tr_b16 v[146:147], v2 offset:25600
    ds_read_b64_tr_b16 v[148:149], v3 offset:24576
    ds_read_b64_tr_b16 v[150:151], v3 offset:25600
    s_add_u32 s75, s75, 2048
    s_cmp_eq_u32 s75, s77
    s_cselect_b32 s75, s76, s75
    buffer_load_dwordx4 v[40:43], v4, s[44:47], s75 offen sc1
    buffer_load_dwordx4 v[44:47], v8, s[44:47], s75 offen sc1
    s_add_u32 s75, s75, 2048
    buffer_load_dwordx4 v[152:155], v4, s[44:47], s75 offen sc1
    buffer_load_dwordx4 v[156:159], v8, s[44:47], s75 offen sc1
    v_mfma_f32_32x32x16_bf16 v[192:207], v[64:67], v[128:131], v[192:207]
    v_mfma_f32_32x32x16_bf16 v[208:223], v[64:67], v[132:135], v[208:223]
    s_setprio 2
    s_mov_b32 s84, 1600000
L_spin_xn:
    ds_read_b32 v10, v11 offset:8
    s_waitcnt lgkmcnt(0)
    v_cmp_ne_u32 vcc, 4, v10
    s_cbranch_vccz L_spun_xn
    s_sub_u32 s84, s84, 1
    s_cmp_lg_u32 s84, 0
    s_cbranch_scc1 L_spin_xn
L_spun_xn:
    s_setprio 0
    s_add_u32 m0, s87, 24576
    s_add_u32 s72, s72, 16384
    s_cmp_eq_u32 s72, s74
    s_cselect_b32 s72, s73, s72
    buffer_load_dwordx4 v6, s[32:35], s72 offen lds
    buffer_load_dwordx4 v5, s[32:35], s72 offen offset:1024 lds
    v_mfma_f32_32x32x16_bf16 v[224:239], v[68:71], v[128:131], v[224:239]
    v_mfma_f32_32x32x16_bf16 v[240:255], v[68:71], v[132:135], v[240:255]
    ds_read_b64_tr_b16 v[48:49], v2 offset:0
    ds_read_b64_tr_b16 v[50:51], v2 offset:1024
    ds_read_b64_tr_b16 v[52:53], v3 offset:0
    ds_read_b64_tr_b16 v[54:55], v3 offset:1024
    s_waitcnt vmcnt(8)
    s_add_u32 s75, s75, 2048
    buffer_load_dwordx4 v[184:187], v4, s[44:47], s75 offen sc1
    buffer_load_dwordx4 v[188:191], v8, s[44:47], s75 offen sc1
    s_waitcnt vmcnt(8)
    s_add_u32 m0, s86, 50176
    s_add_u32 s79, s79, 32768
    s_and_b32 s79, s79, 0x7ffff
    buffer_load_dwordx4 v14, s[20:23], s79 offen lds
    v_mfma_f32_32x32x16_bf16 v[192:207], v[72:75], v[24:27], v[192:207]
    v_mfma_f32_32x32x16_bf16 v[208:223], v[72:75], v[28:31], v[208:223]
    buffer_load_dword v10, v0, s[44:47], 0 offen sc1
    s_waitcnt lgkmcnt(0)
    s_waitcnt vmcnt(8)
    s_add_u32 m0, s87, 0
    s_add_u32 s72, s72, 16384
    buffer_load_dwordx4 v6, s[32:35], s72 offen lds
    buffer_load_dwordx4 v5, s[32:35], s72 offen offset:1024 lds
    v_mfma_f32_32x32x16_bf16 v[224:239], v[76:79], v[24:27], v[224:239]
    v_mfma_f32_32x32x16_bf16 v[240:255], v[76:79], v[28:31], v[240:255]
    ds_read_b64_tr_b16 v[56:57], v2 offset:8192
    ds_read_b64_tr_b16 v[58:59], v2 offset:9216
    ds_read_b64_tr_b16 v[60:61], v3 offset:8192
    ds_read_b64_tr_b16 v[62:63], v3 offset:9216
    s_waitcnt vmcnt(8)
    s_add_u32 s75, s75, 2048
    buffer_load_dwordx4 v[16:19], v4, s[44:47], s75 offen sc1
    buffer_load_dwordx4 v[20:23], v8, s[44:47], s75 offen sc1
    s_waitcnt vmcnt(8)
    s_add_u32 m0, s86, 54272
    s_add_u32 s79, s79, 32768
    s_and_b32 s79, s79, 0x7ffff
    buffer_load_dwordx4 v14, s[20:23], s79 offen lds
    v_mfma_f32_32x32x16_bf16 v[192:207], v[80:83], v[40:43], v[192:207]
    v_mfma_f32_32x32x16_bf16 v[208:223], v[80:83], v[44:47], v[208:223]
    s_waitcnt lgkmcnt(0)
    s_waitcnt vmcnt(8)
    s_add_u32 m0, s87, 8192
    s_add_u32 s72, s72, 16384
    buffer_load_dwordx4 v6, s[32:35], s72 offen lds
    buffer_load_dwordx4 v5, s[32:35], s72 offen offset:1024 lds
    v_mfma_f32_32x32x16_bf16 v[224:239], v[84:87], v[40:43], v[224:239]
    v_mfma_f32_32x32x16_bf16 v[240:255], v[84:87], v[44:47], v[240:255]
    s_waitcnt vmcnt(7)
    s_mov_b64 exec, 63
    s_setprio 2
    v_cmp_ne_u32 vcc, s7, v10
    s_cbranch_vccz L_done_hf6
    s_mov_b32 s84, 400000
L_poll_hf6:
    buffer_load_dword v10, v0, s[44:47], 0 offen sc1
    s_waitcnt vmcnt(0)
    v_cmp_ne_u32 vcc, s7, v10
    s_cbranch_vccz L_done_hf6
    s_sleep 2
    s_sub_u32 s84, s84, 1
    s_cmp_lg_u32 s84, 0
    s_cbranch_scc1 L_poll_hf6
L_done_hf6:
    s_setprio 0
    s_mov_b64 exec, -1
    ds_read_b64_tr_b16 v[64:65], v2 offset:32768
    ds_read_b64_tr_b16 v[66:67], v2 offset:33792
    ds_read_b64_tr_b16 v[68:69], v3 offset:32768
    ds_read_b64_tr_b16 v[70:71], v3 offset:33792
    s_add_u32 s75, s75, 2048
    s_cmp_eq_u32 s75, s77
    s_cselect_b32 s75, s76, s75
    buffer_load_dwordx4 v[128:131], v4, s[44:47], s75 offen sc1
    buffer_load_dwordx4 v[132:135], v8, s[44:47], s75 offen sc1
    s_waitcnt vmcnt(8)
    s_add_u32 s75, s75, 2048
    buffer_load_dwordx4 v[72:75], v4, s[44:47], s75 offen sc1
    buffer_load_dwordx4 v[76:79], v8, s[44:47], s75 offen sc1
    s_waitcnt vmcnt(8)
    s_add_u32 m0, s86, 58368
    s_add_u32 s79, s79, 32768
    s_and_b32 s79, s79, 0x7ffff
    buffer_load_dwordx4 v14, s[20:23], s79 offen lds
    v_mfma_f32_32x32x16_bf16 v[192:207], v[88:91], v[152:155], v[192:207]
    v_mfma_f32_32x32x16_bf16 v[208:223], v[88:91], v[156:159], v[208:223]
    s_waitcnt lgkmcnt(0)
    s_waitcnt vmcnt(8)
    s_add_u32 m0, s87, 32768
    s_add_u32 s72, s72, 16384
    buffer_load_dwordx4 v6, s[32:35], s72 offen lds
    buffer_load_dwordx4 v5, s[32:35], s72 offen offset:1024 lds
    v_mfma_f32_32x32x16_bf16 v[224:239], v[92:95], v[152:155], v[224:239]
    v_mfma_f32_32x32x16_bf16 v[240:255], v[92:95], v[156:159], v[240:255]
    ds_read_b64_tr_b16 v[24:25], v2 offset:16384
    ds_read_b64_tr_b16 v[26:27], v2 offset:17408
    ds_read_b64_tr_b16 v[28:29], v3 offset:16384
    ds_read_b64_tr_b16 v[30:31], v3 offset:17408
    s_waitcnt vmcnt(8)
    s_add_u32 s75, s75, 2048
    buffer_load_dwordx4 v[80:83], v4, s[44:47], s75 offen sc1
    buffer_load_dwordx4 v[84:87], v8, s[44:47], s75 offen sc1
    s_waitcnt vmcnt(8)
    s_add_u32 m0, s86, 62464
    s_add_u32 s79, s79, 32768
    s_and_b32 s79, s79, 0x7ffff
    buffer_load_dwordx4 v14, s[20:23], s79 offen lds
    v_mfma_f32_32x32x16_bf16 v[192:207], v[96:99], v[184:187], v[192:207]
    v_mfma_f32_32x32x16_bf16 v[208:223], v[96:99], v[188:191], v[208:223]
    s_waitcnt vmcnt(8)
    s_add_u32 s75, s75, 2048
    buffer_load_dwordx4 v[40:43], v4, s[44:47], s75 offen sc1
    buffer_load_dwordx4 v[44:47], v8, s[44:47], s75 offen sc1
    v_mfma_f32_32x32x16_bf16 v[224:239], v[100:103], v[184:187], v[224:239]
    v_mfma_f32_32x32x16_bf16 v[240:255], v[100:103], v[188:191], v[240:255]
    ds_read_b64_tr_b16 v[88:89], v2 offset:24576
    ds_read_b64_tr_b16 v[90:91], v2 offset:25600
    ds_read_b64_tr_b16 v[92:93], v3 offset:24576
    ds_read_b64_tr_b16 v[94:95], v3 offset:25600
    s_waitcnt vmcnt(8)
    s_add_u32 s75, s75, 2048
    s_cmp_eq_u32 s75, s77
    s_cselect_b32 s75, s76, s75
    buffer_load_dwordx4 v[152:155], v4, s[44:47], s75 offen sc1
    buffer_load_dwordx4 v[156:159], v8, s[44:47], s75 offen sc1
    v_mfma_f32_32x32x16_bf16 v[192:207], v[104:107], v[16:19], v[192:207]
    v_mfma_f32_32x32x16_bf16 v[208:223], v[104:107], v[20:23], v[208:223]
    s_waitcnt vmcnt(8)
    s_add_u32 s75, s75, 2048
    buffer_load_dwordx4 v[96:99], v4, s[44:47], s75 offen sc1
    buffer_load_dwordx4 v[100:103], v8, s[44:47], s75 offen sc1
    v_mfma_f32_32x32x16_bf16 v[224:239], v[108:111], v[16:19], v[224:239]
    v_mfma_f32_32x32x16_bf16 v[240:255], v[108:111], v[20:23], v[240:255]
    ds_read_b64_tr_b16 v[184:185], v2 offset:0
    ds_read_b64_tr_b16 v[186:187], v2 offset:1024
    ds_read_b64_tr_b16 v[188:189], v3 offset:0
    ds_read_b64_tr_b16 v[190:191], v3 offset:1024
    s_waitcnt vmcnt(8)
    s_add_u32 s75, s75, 2048
    buffer_load_dwordx4 v[104:107], v4, s[44:47], s75 offen sc1
    buffer_load_dwordx4 v[108:111], v8, s[44:47], s75 offen sc1
    v_mfma_f32_32x32x16_bf16 v[192:207], v[112:115], v[128:131], v[192:207]
    v_mfma_f32_32x32x16_bf16 v[208:223], v[112:115], v[132:135], v[208:223]
    s_waitcnt vmcnt(8)
    s_add_u32 s75, s75, 2048
    buffer_load_dwordx4 v[16:19], v4, s[44:47], s75 offen sc1
    buffer_load_dwordx4 v[20:23], v8, s[44:47], s75 offen sc1
    s_mov_b64 exec, 1
    ds_add_u32 v11, v12 offset:20
    s_mov_b64 exec, -1
    v_mfma_f32_32x32x16_bf16 v[224:239], v[116:119], v[128:131], v[224:239]
    v_mfma_f32_32x32x16_bf16 v[240:255], v[116:119], v[132:135], v[240:255]
    ds_read_b64_tr_b16 v[112:113], v2 offset:8192
    ds_read_b64_tr_b16 v[114:115], v2 offset:9216
    ds_read_b64_tr_b16 v[116:117], v3 offset:8192
    ds_read_b64_tr_b16 v[118:119], v3 offset:9216
    s_waitcnt vmcnt(8)
    s_add_u32 s75, s75, 2048
    s_cmp_eq_u32 s75, s77
    s_cselect_b32 s75, s76, s75
    buffer_load_dwordx4 v[128:131], v4, s[44:47], s75 offen sc1
    buffer_load_dwordx4 v[132:135], v8, s[44:47], s75 offen sc1
    v_mfma_f32_32x32x16_bf16 v[192:207], v[120:123], v[72:75], v[192:207]
    v_mfma_f32_32x32x16_bf16 v[208:223], v[120:123], v[76:79], v[208:223]
    v_mfma_f32_32x32x16_bf16 v[224:239], v[124:127], v[72:75], v[224:239]
    v_mfma_f32_32x32x16_bf16 v[240:255], v[124:127], v[76:79], v[240:255]
    ds_read_b64_tr_b16 v[120:121], v2 offset:32768
    ds_read_b64_tr_b16 v[122:123], v2 offset:33792
    ds_read_b64_tr_b16 v[124:125], v3 offset:32768
    ds_read_b64_tr_b16 v[126:127], v3 offset:33792
    s_waitcnt vmcnt(8)
    s_add_u32 s75, s75, 2048
    buffer_load_dwordx4 v[72:75], v4, s[44:47], s75 offen sc1
    buffer_load_dwordx4 v[76:79], v8, s[44:47], s75 offen sc1
    v_mfma_f32_32x32x16_bf16 v[192:207], v[160:163], v[80:83], v[192:207]
    v_mfma_f32_32x32x16_bf16 v[208:223], v[160:163], v[84:87], v[208:223]
    v_mfma_f32_32x32x16_bf16 v[224:239], v[164:167], v[80:83], v[224:239]
    v_mfma_f32_32x32x16_bf16 v[240:255], v[164:167], v[84:87], v[240:255]
    s_waitcnt vmcnt(8)
    s_add_u32 s75, s75, 2048
    buffer_load_dwordx4 v[160:163], v4, s[44:47], s75 offen sc1
    buffer_load_dwordx4 v[164:167], v8, s[44:47], s75 offen sc1
    s_and_b32 s60, s6, 1
    s_mul_i32 s61, s60, 8704
    s_lshr_b32 s62, s6, 1
    s_lshl_b32 s62, s62, 7
    s_add_u32 s61, s61, s62
    s_add_u32 s61, s61, 115712
    s_lshl_b32 s60, s60, 7
    s_add_u32 s60, s60, 162880
    s_mul_i32 s62, s6, 12288
    s_xor_b32 s63, s6, 1
    s_mul_i32 s63, s63, 12288
    s_add_u32 s63, s63, 0
    s_xor_b32 s64, s6, 2
    s_mul_i32 s64, s64, 12288
    s_add_u32 s64, s64, 4096
    s_xor_b32 s65, s6, 3
    s_mul_i32 s65, s65, 12288
    s_add_u32 s65, s65, 8192
    s_setprio 2
    v_add_u32 v5, s63, v7
    v_add_u32 v6, s64, v7
    v_add_u32 v14, s65, v7
    v_add_u32 v9, s62, v7
    v_and_b32 v7, 31, v1
    v_lshl_add_u32 v0, v7, 2, s60
    v_mul_u32_u24 v7, 272, v7
    v_and_b32 v13, 32, v1
    v_lshrrev_b32 v13, 1, v13
    v_add3_u32 v7, v7, v13, s61
    s_setprio 0
    ds_read_b32 v0, v0
    v_mfma_f32_32x32x16_bf16 v[192:207], v[168:171], v[40:43], v[192:207]
    v_mfma_f32_32x32x16_bf16 v[208:223], v[168:171], v[44:47], v[208:223]
    s_waitcnt vmcnt(8)
    s_add_u32 s75, s75, 2048
    buffer_load_dwordx4 v[80:83], v4, s[44:47], s75 offen sc1
    buffer_load_dwordx4 v[84:87], v8, s[44:47], s75 offen sc1
    v_mfma_f32_32x32x16_bf16 v[224:239], v[172:175], v[40:43], v[224:239]
    v_mfma_f32_32x32x16_bf16 v[240:255], v[172:175], v[44:47], v[240:255]
    s_waitcnt vmcnt(8)
    s_add_u32 s75, s75, 2048
    s_cmp_eq_u32 s75, s77
    s_cselect_b32 s75, s76, s75
    buffer_load_dwordx4 v[168:171], v4, s[44:47], s75 offen sc1
    buffer_load_dwordx4 v[172:175], v8, s[44:47], s75 offen sc1
    s_waitcnt lgkmcnt(0)
    s_setprio 2
    v_mul_f32 v0, v0, v0
    v_rcp_f32 v13, v0
    s_nop 0
    v_mul_f32 v13, 0xbfb8aa3b, v13
    s_setprio 0
    v_mfma_f32_32x32x16_bf16 v[192:207], v[176:179], v[152:155], v[192:207]
    v_mfma_f32_32x32x16_bf16 v[208:223], v[176:179], v[156:159], v[208:223]
    s_waitcnt vmcnt(8)
    s_add_u32 s75, s75, 2048
    buffer_load_dwordx4 v[40:43], v4, s[44:47], s75 offen sc1
    buffer_load_dwordx4 v[44:47], v8, s[44:47], s75 offen sc1
    v_mfma_f32_32x32x16_bf16 v[224:239], v[180:183], v[152:155], v[224:239]
    v_mfma_f32_32x32x16_bf16 v[240:255], v[180:183], v[156:159], v[240:255]
    s_waitcnt vmcnt(8)
    s_add_u32 s75, s75, 2048
    buffer_load_dwordx4 v[176:179], v4, s[44:47], s75 offen sc1
    buffer_load_dwordx4 v[180:183], v8, s[44:47], s75 offen sc1
    v_mfma_f32_32x32x16_bf16 v[192:207], v[136:139], v[96:99], v[192:207]
    v_mfma_f32_32x32x16_bf16 v[208:223], v[136:139], v[100:103], v[208:223]
    s_waitcnt vmcnt(8)
    s_add_u32 s75, s75, 2048
    buffer_load_dwordx4 v[152:155], v4, s[44:47], s75 offen sc1
    buffer_load_dwordx4 v[156:159], v8, s[44:47], s75 offen sc1
    v_mfma_f32_32x32x16_bf16 v[224:239], v[140:143], v[96:99], v[224:239]
    v_mfma_f32_32x32x16_bf16 v[240:255], v[140:143], v[100:103], v[240:255]
L_join7:
    s_setprio 0
    s_mov_b32 s84, 1600000
L_spin_ah:
    ds_read_b32 v10, v11 offset:16
    s_waitcnt lgkmcnt(0)
    v_cmp_ne_u32 vcc, 4, v10
    s_cbranch_vccz L_spun_ah
    s_sleep 1
    s_sub_u32 s84, s84, 1
    s_cmp_lg_u32 s84, 0
    s_cbranch_scc1 L_spin_ah
L_spun_ah:
    v_mfma_f32_32x32x16_bf16 v[208:223], v[32:35], v[108:111], v[208:223]
    v_mfma_f32_32x32x16_bf16 v[208:223], v[144:147], v[20:23], v[208:223]
    v_mfma_f32_32x32x16_bf16 v[208:223], v[48:51], v[132:135], v[208:223]
    v_mfma_f32_32x32x16_bf16 v[208:223], v[56:59], v[76:79], v[208:223]
    v_mfma_f32_32x32x16_bf16 v[208:223], v[64:67], v[164:167], v[208:223]
    s_waitcnt vmcnt(8)
    v_mfma_f32_32x32x16_bf16 v[208:223], v[24:27], v[84:87], v[208:223]
    s_waitcnt vmcnt(6)
    v_mfma_f32_32x32x16_bf16 v[208:223], v[88:91], v[172:175], v[208:223]
    s_waitcnt vmcnt(4)
    v_mfma_f32_32x32x16_bf16 v[208:223], v[184:187], v[44:47], v[208:223]
    s_waitcnt vmcnt(2)
    v_mfma_f32_32x32x16_bf16 v[208:223], v[112:115], v[180:183], v[208:223]
    s_waitcnt vmcnt(0)
    v_mfma_f32_32x32x16_bf16 v[208:223], v[120:123], v[156:159], v[208:223]
    v_mfma_f32_32x32x16_bf16 v[224:239], v[36:39], v[104:107], v[224:239]
    v_mfma_f32_32x32x16_bf16 v[224:239], v[148:151], v[16:19], v[224:239]
    v_mfma_f32_32x32x16_bf16 v[224:239], v[52:55], v[128:131], v[224:239]
    v_mfma_f32_32x32x16_bf16 v[224:239], v[60:63], v[72:75], v[224:239]
    v_mfma_f32_32x32x16_bf16 v[224:239], v[68:71], v[160:163], v[224:239]
    v_mfma_f32_32x32x16_bf16 v[224:239], v[28:31], v[80:83], v[224:239]
    v_mfma_f32_32x32x16_bf16 v[224:239], v[92:95], v[168:171], v[224:239]
    v_mfma_f32_32x32x16_bf16 v[224:239], v[188:191], v[40:43], v[224:239]
    v_mfma_f32_32x32x16_bf16 v[224:239], v[116:119], v[176:179], v[224:239]
    v_mfma_f32_32x32x16_bf16 v[224:239], v[124:127], v[152:155], v[224:239]
    s_setprio 2
    s_mov_b32 s84, 1600000
L_spin_c:
    ds_read_b32 v10, v11 offset:24
    s_waitcnt lgkmcnt(0)
    v_cmp_ne_u32 vcc, 4, v10
    s_cbranch_vccz L_spun_c
    s_sub_u32 s84, s84, 1
    s_cmp_lg_u32 s84, 0
    s_cbranch_scc1 L_spin_c
L_spun_c:
    v_mfma_f32_32x32x16_bf16 v[240:255], v[36:39], v[108:111], v[240:255]
    ds_write_b128 v5, v[208:211] offset:0
    v_mfma_f32_32x32x16_bf16 v[240:255], v[148:151], v[20:23], v[240:255]
    ds_write_b128 v5, v[212:215] offset:1024
    v_mfma_f32_32x32x16_bf16 v[240:255], v[52:55], v[132:135], v[240:255]
    ds_write_b128 v5, v[216:219] offset:2048
    ds_write_b128 v5, v[220:223] offset:3072
    v_mfma_f32_32x32x16_bf16 v[240:255], v[60:63], v[76:79], v[240:255]
    ds_write_b128 v6, v[224:227] offset:0
    v_mfma_f32_32x32x16_bf16 v[240:255], v[68:71], v[164:167], v[240:255]
    ds_write_b128 v6, v[228:231] offset:1024
    v_mfma_f32_32x32x16_bf16 v[240:255], v[28:31], v[84:87], v[240:255]
    ds_write_b128 v6, v[232:235] offset:2048
    v_mfma_f32_32x32x16_bf16 v[240:255], v[92:95], v[172:175], v[240:255]
    ds_write_b128 v6, v[236:239] offset:3072
    v_mfma_f32_32x32x16_bf16 v[240:255], v[188:191], v[44:47], v[240:255]
    v_mfma_f32_32x32x16_bf16 v[240:255], v[116:119], v[180:183], v[240:255]
    v_mfma_f32_32x32x16_bf16 v[240:255], v[124:127], v[156:159], v[240:255]
    v_mfma_f32_32x32x16_bf16 v[192:207], v[32:35], v[104:107], v[192:207]
    v_mfma_f32_32x32x16_bf16 v[192:207], v[144:147], v[16:19], v[192:207]
    v_mfma_f32_32x32x16_bf16 v[192:207], v[48:51], v[128:131], v[192:207]
    ds_write_b128 v14, v[240:243] offset:0
    v_mfma_f32_32x32x16_bf16 v[192:207], v[56:59], v[72:75], v[192:207]
    ds_write_b128 v14, v[244:247] offset:1024
    v_mfma_f32_32x32x16_bf16 v[192:207], v[64:67], v[160:163], v[192:207]
    ds_write_b128 v14, v[248:251] offset:2048
    v_mfma_f32_32x32x16_bf16 v[192:207], v[24:27], v[80:83], v[192:207]
    ds_write_b128 v14, v[252:255] offset:3072
    v_mfma_f32_32x32x16_bf16 v[192:207], v[88:91], v[168:171], v[192:207]
    s_mov_b64 exec, 1
    ds_add_u32 v11, v12 offset:4
    s_mov_b64 exec, -1
    v_mfma_f32_32x32x16_bf16 v[192:207], v[184:187], v[40:43], v[192:207]
    v_mfma_f32_32x32x16_bf16 v[192:207], v[112:115], v[176:179], v[192:207]
    v_mfma_f32_32x32x16_bf16 v[192:207], v[120:123], v[152:155], v[192:207]
    s_setprio 2
    s_mov_b32 s84, 1600000
L_spin_g:
    ds_read_b32 v10, v11 offset:4
    s_waitcnt lgkmcnt(0)
    v_cmp_ne_u32 vcc, 4, v10
    s_cbranch_vccz L_spun_g
    s_sub_u32 s84, s84, 1
    s_cmp_lg_u32 s84, 0
    s_cbranch_scc1 L_spin_g
L_spun_g:
    ds_read_b128 v[16:19], v9 offset:0
    ds_read_b128 v[32:35], v9 offset:4096
    ds_read_b128 v[48:51], v9 offset:8192
    ds_read_b128 v[20:23], v9 offset:1024
    ds_read_b128 v[36:39], v9 offset:5120
    ds_read_b128 v[52:55], v9 offset:9216
    ds_read_b128 v[24:27], v9 offset:2048
    ds_read_b128 v[40:43], v9 offset:6144
    ds_read_b128 v[56:59], v9 offset:10240
    ds_read_b128 v[28:31], v9 offset:3072
    ds_read_b128 v[44:47], v9 offset:7168
    ds_read_b128 v[60:63], v9 offset:11264
    s_waitcnt lgkmcnt(9)
    v_add_f32 v192, v192, v16
    v_add_f32 v193, v193, v17
    v_add_f32 v194, v194, v18
    v_add_f32 v195, v195, v19
    v_add_f32 v192, v192, v32
    v_add_f32 v193, v193, v33
    v_add_f32 v194, v194, v34
    v_add_f32 v195, v195, v35
    v_add_f32 v192, v192, v48
    v_add_f32 v193, v193, v49
    v_add_f32 v194, v194, v50
    v_add_f32 v195, v195, v51
    v_mul_f32 v64, v13, v192
    v_mul_f32 v65, v13, v193
    v_mul_f32 v66, v13, v194
    v_mul_f32 v67, v13, v195
    v_exp_f32 v64, v64
    v_exp_f32 v65, v65
    v_exp_f32 v66, v66
    v_exp_f32 v67, v67
    v_fma_f32 v64, v64, v0, v0
    v_fma_f32 v65, v65, v0, v0
    v_fma_f32 v66, v66, v0, v0
    v_fma_f32 v67, v67, v0, v0
    v_rcp_f32 v64, v64
    v_rcp_f32 v65, v65
    v_rcp_f32 v66, v66
    v_rcp_f32 v67, v67
    v_mul_f32 v64, v192, v64
    v_mul_f32 v65, v193, v65
    v_mul_f32 v66, v194, v66
    v_mul_f32 v67, v195, v67
    ds_write_b128 v7, v[64:67] offset:0
    s_waitcnt lgkmcnt(7)
    v_add_f32 v196, v196, v20
    v_add_f32 v197, v197, v21
    v_add_f32 v198, v198, v22
    v_add_f32 v199, v199, v23
    v_add_f32 v196, v196, v36
    v_add_f32 v197, v197, v37
    v_add_f32 v198, v198, v38
    v_add_f32 v199, v199, v39
    v_add_f32 v196, v196, v52
    v_add_f32 v197, v197, v53
    v_add_f32 v198, v198, v54
    v_add_f32 v199, v199, v55
    v_mul_f32 v68, v13, v196
    v_mul_f32 v69, v13, v197
    v_mul_f32 v70, v13, v198
    v_mul_f32 v71, v13, v199
    v_exp_f32 v68, v68
    v_exp_f32 v69, v69
    v_exp_f32 v70, v70
    v_exp_f32 v71, v71
    v_fma_f32 v68, v68, v0, v0
    v_fma_f32 v69, v69, v0, v0
    v_fma_f32 v70, v70, v0, v0
    v_fma_f32 v71, v71, v0, v0
    v_rcp_f32 v68, v68
    v_rcp_f32 v69, v69
    v_rcp_f32 v70, v70
    v_rcp_f32 v71, v71
    v_mul_f32 v68, v196, v68
    v_mul_f32 v69, v197, v69
    v_mul_f32 v70, v198, v70
    v_mul_f32 v71, v199, v71
    ds_write_b128 v7, v[68:71] offset:32
    s_waitcnt lgkmcnt(5)
    v_add_f32 v200, v200, v24
    v_add_f32 v201, v201, v25
    v_add_f32 v202, v202, v26
    v_add_f32 v203, v203, v27
    v_add_f32 v200, v200, v40
    v_add_f32 v201, v201, v41
    v_add_f32 v202, v202, v42
    v_add_f32 v203, v203, v43
    v_add_f32 v200, v200, v56
    v_add_f32 v201, v201, v57
    v_add_f32 v202, v202, v58
    v_add_f32 v203, v203, v59
    v_mul_f32 v72, v13, v200
    v_mul_f32 v73, v13, v201
    v_mul_f32 v74, v13, v202
    v_mul_f32 v75, v13, v203
    v_exp_f32 v72, v72
    v_exp_f32 v73, v73
    v_exp_f32 v74, v74
    v_exp_f32 v75, v75
    v_fma_f32 v72, v72, v0, v0
    v_fma_f32 v73, v73, v0, v0
    v_fma_f32 v74, v74, v0, v0
    v_fma_f32 v75, v75, v0, v0
    v_rcp_f32 v72, v72
    v_rcp_f32 v73, v73
    v_rcp_f32 v74, v74
    v_rcp_f32 v75, v75
    v_mul_f32 v72, v200, v72
    v_mul_f32 v73, v201, v73
    v_mul_f32 v74, v202, v74
    v_mul_f32 v75, v203, v75
    ds_write_b128 v7, v[72:75] offset:64
    s_waitcnt lgkmcnt(3)
    v_add_f32 v204, v204, v28
    v_add_f32 v205, v205, v29
    v_add_f32 v206, v206, v30
    v_add_f32 v207, v207, v31
    v_add_f32 v204, v204, v44
    v_add_f32 v205, v205, v45
    v_add_f32 v206, v206, v46
    v_add_f32 v207, v207, v47
    v_add_f32 v204, v204, v60
    v_add_f32 v205, v205, v61
    v_add_f32 v206, v206, v62
    v_add_f32 v207, v207, v63
    v_mul_f32 v76, v13, v204
    v_mul_f32 v77, v13, v205
    v_mul_f32 v78, v13, v206
    v_mul_f32 v79, v13, v207
    v_exp_f32 v76, v76
    v_exp_f32 v77, v77
    v_exp_f32 v78, v78
    v_exp_f32 v79, v79
    v_fma_f32 v76, v76, v0, v0
    v_fma_f32 v77, v77, v0, v0
    v_fma_f32 v78, v78, v0, v0
    v_fma_f32 v79, v79, v0, v0
    v_rcp_f32 v76, v76
    v_rcp_f32 v77, v77
    v_rcp_f32 v78, v78
    v_rcp_f32 v79, v79
    v_mul_f32 v76, v204, v76
    v_mul_f32 v77, v205, v77
    v_mul_f32 v78, v206, v78
    v_mul_f32 v79, v207, v79
    ds_write_b128 v7, v[76:79] offset:96
    s_waitcnt lgkmcnt(0)
    s_barrier
    s_endpgm
L_skip7:
    s_mov_b64 exec, 1
    ds_add_u32 v11, v12 offset:8
    s_mov_b64 exec, -1
    s_lshl_b32 s60, s6, 18
    s_lshl_b32 s61, s4, 13
    s_add_u32 s60, s60, s61
    s_setprio 2
    v_add_u32 v168, s60, v170
    v_add_u32 v169, 0x100000, v168
    s_setprio 0
    buffer_load_dword v10, v168, s[24:27], 0 offen
    s_waitcnt vmcnt(0)
    buffer_load_dword v10, v169, s[24:27], 0 offen
    s_waitcnt vmcnt(0)
    buffer_load_dword v10, v168, s[32:35], 0 offen
    s_waitcnt vmcnt(0)
    buffer_load_dword v10, v169, s[32:35], 0 offen
    s_waitcnt vmcnt(0)
    buffer_load_dword v10, v168, s[20:23], 0 offen
    s_waitcnt vmcnt(0)
    buffer_load_ushort v176, v180, s[28:31], 0 offen
    buffer_load_ushort v180, v180, s[28:31], 0 offen offset:64
    buffer_load_ushort v166, v166, s[36:39], 0 offen
    buffer_load_dword v10, v0, s[44:47], 0 offen sc1
    buffer_load_dwordx2 v[168:169], v167, s[44:47], 0 offen sc1
    s_waitcnt vmcnt(0)
    s_setprio 2
    v_cmp_ne_u32 vcc, s7, v168
    v_cmp_ne_u32 s[60:61], s48, v169
    v_lshl_or_b32 v176, v176, 16, v176
    v_lshl_or_b32 v180, v180, 16, v180
    s_or_b64 vcc, vcc, s[60:61]
    s_cselect_b32 s49, 0, 1
    v_mov_b32 v10, s49
    s_setprio 0
    s_mov_b64 exec, 1
    ds_add_u32 v11, v10 offset:12
    s_mov_b64 exec, -1
    s_setprio 2
    v_lshl_or_b32 v176, v166, 16, v166
    v_mov_b32 v184, v171
    s_mov_b64 exec, 64
    v_mov_b32 v0, s98
    s_mov_b64 exec, -1
    s_setprio 0
    v_mfma_f32_32x32x16_bf16 v[192:207], v[176:179], v[184:187], 0
    s_add_u32 s62, s55, 4096
    s_add_u32 m0, s87, 16384
    s_nop 0
    buffer_load_dwordx4 v6, s[32:35], s72 offen lds
    buffer_load_dwordx4 v5, s[32:35], s72 offen offset:1024 lds
    s_add_u32 m0, s87, 24576
    s_add_u32 s72, s72, 16384
    buffer_load_dwordx4 v6, s[32:35], s72 offen lds
    buffer_load_dwordx4 v5, s[32:35], s72 offen offset:1024 lds
    s_waitcnt vmcnt(2)
    ds_read_b64_tr_b16 v[16:17], v2 offset:16384
    ds_read_b64_tr_b16 v[18:19], v2 offset:17408
    ds_read_b64_tr_b16 v[20:21], v3 offset:16384
    ds_read_b64_tr_b16 v[22:23], v3 offset:17408
    s_add_u32 m0, s86, 66560
    s_add_u32 s79, s79, 32768
    s_and_b32 s79, s79, 0x7ffff
    buffer_load_dwordx4 v14, s[20:23], s79 offen lds
    s_add_u32 m0, s87, 0
    s_add_u32 s72, s72, 16384
    buffer_load_dwordx4 v6, s[32:35], s72 offen lds
    buffer_load_dwordx4 v5, s[32:35], s72 offen offset:1024 lds
    s_waitcnt vmcnt(3)
    ds_read_b64_tr_b16 v[24:25], v2 offset:24576
    ds_read_b64_tr_b16 v[26:27], v2 offset:25600
    ds_read_b64_tr_b16 v[28:29], v3 offset:24576
    ds_read_b64_tr_b16 v[30:31], v3 offset:25600
    s_add_u32 m0, s86, 70656
    s_add_u32 s79, s79, 32768
    s_and_b32 s79, s79, 0x7ffff
    buffer_load_dwordx4 v14, s[20:23], s79 offen lds
    s_add_u32 m0, s87, 8192
    s_add_u32 s72, s72, 16384
    buffer_load_dwordx4 v6, s[32:35], s72 offen lds
    buffer_load_dwordx4 v5, s[32:35], s72 offen offset:1024 lds
    s_waitcnt vmcnt(3)
    ds_read_b64_tr_b16 v[32:33], v2 offset:0
    ds_read_b64_tr_b16 v[34:35], v2 offset:1024
    ds_read_b64_tr_b16 v[36:37], v3 offset:0
    ds_read_b64_tr_b16 v[38:39], v3 offset:1024
    s_add_u32 m0, s86, 74752
    s_add_u32 s79, s79, 32768
    s_and_b32 s79, s79, 0x7ffff
    buffer_load_dwordx4 v14, s[20:23], s79 offen lds
    s_add_u32 m0, s87, 32768
    s_add_u32 s72, s72, 16384
    s_cmp_eq_u32 s72, s74
    s_cselect_b32 s72, s73, s72
    buffer_load_dwordx4 v6, s[32:35], s72 offen lds
    buffer_load_dwordx4 v5, s[32:35], s72 offen offset:1024 lds
    s_waitcnt vmcnt(3)
    ds_read_b64_tr_b16 v[40:41], v2 offset:8192
    ds_read_b64_tr_b16 v[42:43], v2 offset:9216
    ds_read_b64_tr_b16 v[44:45], v3 offset:8192
    ds_read_b64_tr_b16 v[46:47], v3 offset:9216
    s_add_u32 m0, s86, 78848
    s_add_u32 s79, s79, 32768
    s_and_b32 s79, s79, 0x7ffff
    buffer_load_dwordx4 v14, s[20:23], s79 offen lds
    s_waitcnt lgkmcnt(12)
    s_add_u32 m0, s87, 16384
    s_add_u32 s72, s72, 16384
    buffer_load_dwordx4 v6, s[32:35], s72 offen lds
    buffer_load_dwordx4 v5, s[32:35], s72 offen offset:1024 lds
    s_waitcnt vmcnt(3)
    ds_read_b64_tr_b16 v[48:49], v2 offset:32768
    ds_read_b64_tr_b16 v[50:51], v2 offset:33792
    ds_read_b64_tr_b16 v[52:53], v3 offset:32768
    ds_read_b64_tr_b16 v[54:55], v3 offset:33792
    s_add_u32 m0, s86, 82944
    s_add_u32 s79, s79, 32768
    s_and_b32 s79, s79, 0x7ffff
    buffer_load_dwordx4 v14, s[20:23], s79 offen lds
    s_waitcnt lgkmcnt(12)
    s_add_u32 m0, s87, 24576
    s_add_u32 s72, s72, 16384
    buffer_load_dwordx4 v6, s[32:35], s72 offen lds
    buffer_load_dwordx4 v5, s[32:35], s72 offen offset:1024 lds
    s_waitcnt vmcnt(3)
    ds_read_b64_tr_b16 v[56:57], v2 offset:16384
    ds_read_b64_tr_b16 v[58:59], v2 offset:17408
    ds_read_b64_tr_b16 v[60:61], v3 offset:16384
    ds_read_b64_tr_b16 v[62:63], v3 offset:17408
    s_add_u32 m0, s86, 87040
    s_add_u32 s79, s79, 32768
    s_and_b32 s79, s79, 0x7ffff
    buffer_load_dwordx4 v14, s[20:23], s79 offen lds
    s_waitcnt lgkmcnt(12)
    s_add_u32 m0, s87, 0
    s_add_u32 s72, s72, 16384
    buffer_load_dwordx4 v6, s[32:35], s72 offen lds
    buffer_load_dwordx4 v5, s[32:35], s72 offen offset:1024 lds
    s_waitcnt vmcnt(3)
    ds_read_b64_tr_b16 v[64:65], v2 offset:24576
    ds_read_b64_tr_b16 v[66:67], v2 offset:25600
    ds_read_b64_tr_b16 v[68:69], v3 offset:24576
    ds_read_b64_tr_b16 v[70:71], v3 offset:25600
    s_add_u32 m0, s86, 91136
    s_add_u32 s79, s79, 32768
    s_and_b32 s79, s79, 0x7ffff
    buffer_load_dwordx4 v14, s[20:23], s79 offen lds
    s_waitcnt lgkmcnt(12)
    s_add_u32 m0, s87, 8192
    s_add_u32 s72, s72, 16384
    s_cmp_eq_u32 s72, s74
    s_cselect_b32 s72, s73, s72
    buffer_load_dwordx4 v6, s[32:35], s72 offen lds
    buffer_load_dwordx4 v5, s[32:35], s72 offen offset:1024 lds
    s_waitcnt vmcnt(3)
    ds_read_b64_tr_b16 v[72:73], v2 offset:0
    ds_read_b64_tr_b16 v[74:75], v2 offset:1024
    ds_read_b64_tr_b16 v[76:77], v3 offset:0
    ds_read_b64_tr_b16 v[78:79], v3 offset:1024
    s_add_u32 m0, s86, 95232
    s_add_u32 s79, s79, 32768
    s_and_b32 s79, s79, 0x7ffff
    buffer_load_dwordx4 v14, s[20:23], s79 offen lds
    s_waitcnt lgkmcnt(12)
    s_add_u32 m0, s87, 32768
    s_add_u32 s72, s72, 16384
    buffer_load_dwordx4 v6, s[32:35], s72 offen lds
    buffer_load_dwordx4 v5, s[32:35], s72 offen offset:1024 lds
    s_waitcnt vmcnt(3)
    ds_read_b64_tr_b16 v[80:81], v2 offset:8192
    ds_read_b64_tr_b16 v[82:83], v2 offset:9216
    ds_read_b64_tr_b16 v[84:85], v3 offset:8192
    ds_read_b64_tr_b16 v[86:87], v3 offset:9216
    s_add_u32 m0, s86, 99328
    s_add_u32 s79, s79, 32768
    s_and_b32 s79, s79, 0x7ffff
    buffer_load_dwordx4 v14, s[20:23], s79 offen lds
    s_waitcnt lgkmcnt(12)
    s_add_u32 m0, s87, 16384
    s_add_u32 s72, s72, 16384
    buffer_load_dwordx4 v6, s[32:35], s72 offen lds
    buffer_load_dwordx4 v5, s[32:35], s72 offen offset:1024 lds
    s_waitcnt vmcnt(3)
    ds_read_b64_tr_b16 v[88:89], v2 offset:32768
    ds_read_b64_tr_b16 v[90:91], v2 offset:33792
    ds_read_b64_tr_b16 v[92:93], v3 offset:32768
    ds_read_b64_tr_b16 v[94:95], v3 offset:33792
    s_add_u32 m0, s86, 103424
    s_add_u32 s79, s79, 32768
    s_and_b32 s79, s79, 0x7ffff
    buffer_load_dwordx4 v14, s[20:23], s79 offen lds
    s_waitcnt lgkmcnt(12)
    s_add_u32 m0, s87, 24576
    s_add_u32 s72, s72, 16384
    buffer_load_dwordx4 v6, s[32:35], s72 offen lds
    buffer_load_dwordx4 v5, s[32:35], s72 offen offset:1024 lds
    s_waitcnt vmcnt(3)
    ds_read_b64_tr_b16 v[96:97], v2 offset:16384
    ds_read_b64_tr_b16 v[98:99], v2 offset:17408
    ds_read_b64_tr_b16 v[100:101], v3 offset:16384
    ds_read_b64_tr_b16 v[102:103], v3 offset:17408
    s_add_u32 m0, s86, 107520
    s_add_u32 s79, s79, 32768
    s_and_b32 s79, s79, 0x7ffff
    buffer_load_dwordx4 v14, s[20:23], s79 offen lds
    s_waitcnt lgkmcnt(12)
    s_add_u32 m0, s87, 0
    s_add_u32 s72, s72, 16384
    s_cmp_eq_u32 s72, s74
    s_cselect_b32 s72, s73, s72
    buffer_load_dwordx4 v6, s[32:35], s72 offen lds
    buffer_load_dwordx4 v5, s[32:35], s72 offen offset:1024 lds
    s_waitcnt vmcnt(3)
    ds_read_b64_tr_b16 v[104:105], v2 offset:24576
    ds_read_b64_tr_b16 v[106:107], v2 offset:25600
    ds_read_b64_tr_b16 v[108:109], v3 offset:24576
    ds_read_b64_tr_b16 v[110:111], v3 offset:25600
    s_add_u32 m0, s86, 111616
    s_add_u32 s79, s79, 32768
    s_and_b32 s79, s79, 0x7ffff
    buffer_load_dwordx4 v14, s[20:23], s79 offen lds
    s_waitcnt lgkmcnt(12)
    s_add_u32 m0, s87, 8192
    s_add_u32 s72, s72, 16384
    buffer_load_dwordx4 v6, s[32:35], s72 offen lds
    buffer_load_dwordx4 v5, s[32:35], s72 offen offset:1024 lds
    s_waitcnt vmcnt(3)
    ds_read_b64_tr_b16 v[112:113], v2 offset:0
    ds_read_b64_tr_b16 v[114:115], v2 offset:1024
    ds_read_b64_tr_b16 v[116:117], v3 offset:0
    ds_read_b64_tr_b16 v[118:119], v3 offset:1024
    s_add_u32 m0, s86, 50176
    s_add_u32 s79, s79, 32768
    s_and_b32 s79, s79, 0x7ffff
    buffer_load_dwordx4 v14, s[20:23], s79 offen lds
    s_waitcnt lgkmcnt(12)
    s_add_u32 m0, s87, 32768
    s_add_u32 s72, s72, 16384
    buffer_load_dwordx4 v6, s[32:35], s72 offen lds
    buffer_load_dwordx4 v5, s[32:35], s72 offen offset:1024 lds
    s_waitcnt vmcnt(3)
    ds_read_b64_tr_b16 v[120:121], v2 offset:8192
    ds_read_b64_tr_b16 v[122:123], v2 offset:9216
    ds_read_b64_tr_b16 v[124:125], v3 offset:8192
    ds_read_b64_tr_b16 v[126:127], v3 offset:9216
    s_add_u32 m0, s86, 54272
    s_add_u32 s79, s79, 32768
    s_and_b32 s79, s79, 0x7ffff
    buffer_load_dwordx4 v14, s[20:23], s79 offen lds
    s_waitcnt lgkmcnt(12)
    s_add_u32 m0, s87, 16384
    s_add_u32 s72, s72, 16384
    buffer_load_dwordx4 v6, s[32:35], s72 offen lds
    buffer_load_dwordx4 v5, s[32:35], s72 offen offset:1024 lds
    s_waitcnt vmcnt(3)
    ds_read_b64_tr_b16 v[160:161], v2 offset:32768
    ds_read_b64_tr_b16 v[162:163], v2 offset:33792
    ds_read_b64_tr_b16 v[164:165], v3 offset:32768
    ds_read_b64_tr_b16 v[166:167], v3 offset:33792
    s_add_u32 m0, s86, 58368
    s_add_u32 s79, s79, 32768
    s_and_b32 s79, s79, 0x7ffff
    buffer_load_dwordx4 v14, s[20:23], s79 offen lds
    s_waitcnt lgkmcnt(12)
    s_add_u32 m0, s87, 24576
    s_add_u32 s72, s72, 16384
    s_cmp_eq_u32 s72, s74
    s_cselect_b32 s72, s73, s72
    buffer_load_dwordx4 v6, s[32:35], s72 offen lds
    buffer_load_dwordx4 v5, s[32:35], s72 offen offset:1024 lds
    s_waitcnt vmcnt(3)
    ds_read_b64_tr_b16 v[168:169], v2 offset:16384
    ds_read_b64_tr_b16 v[170:171], v2 offset:17408
    ds_read_b64_tr_b16 v[172:173], v3 offset:16384
    ds_read_b64_tr_b16 v[174:175], v3 offset:17408
    s_add_u32 m0, s86, 62464
    s_add_u32 s79, s79, 32768
    s_and_b32 s79, s79, 0x7ffff
    buffer_load_dwordx4 v14, s[20:23], s79 offen lds
    s_waitcnt lgkmcnt(12)
    s_add_u32 m0, s87, 0
    s_add_u32 s72, s72, 16384
    buffer_load_dwordx4 v6, s[32:35], s72 offen lds
    buffer_load_dwordx4 v5, s[32:35], s72 offen offset:1024 lds
    s_waitcnt vmcnt(3)
    ds_read_b64_tr_b16 v[176:177], v2 offset:24576
    ds_read_b64_tr_b16 v[178:179], v2 offset:25600
    ds_read_b64_tr_b16 v[180:181], v3 offset:24576
    ds_read_b64_tr_b16 v[182:183], v3 offset:25600
    s_waitcnt lgkmcnt(12)
    s_add_u32 m0, s87, 8192
    s_add_u32 s72, s72, 16384
    buffer_load_dwordx4 v6, s[32:35], s72 offen lds
    buffer_load_dwordx4 v5, s[32:35], s72 offen offset:1024 lds
    s_waitcnt lgkmcnt(8)
    s_add_u32 m0, s87, 32768
    s_add_u32 s72, s72, 16384
    buffer_load_dwordx4 v6, s[32:35], s72 offen lds
    buffer_load_dwordx4 v5, s[32:35], s72 offen offset:1024 lds
    s_waitcnt lgkmcnt(4)
    s_add_u32 m0, s87, 16384
    s_add_u32 s72, s72, 16384
    s_cmp_eq_u32 s72, s74
    s_cselect_b32 s72, s73, s72
    buffer_load_dwordx4 v6, s[32:35], s72 offen lds
    buffer_load_dwordx4 v5, s[32:35], s72 offen offset:1024 lds
    s_waitcnt lgkmcnt(0)
    s_add_u32 m0, s87, 24576
    s_add_u32 s72, s72, 16384
    buffer_load_dwordx4 v6, s[32:35], s72 offen lds
    buffer_load_dwordx4 v5, s[32:35], s72 offen offset:1024 lds
    s_waitcnt vmcnt(0)
    s_mov_b64 exec, 1
    ds_add_u32 v11, v12 offset:20
    s_mov_b64 exec, -1
    s_setprio 2
    s_mov_b64 exec, 0x41
    s_mov_b32 s84, 400000
L_poll_h7a:
    buffer_load_dword v10, v0, s[44:47], 0 offen sc1
    s_waitcnt vmcnt(0)
    v_cmp_ne_u32 vcc, s7, v10
    s_cbranch_vccz L_done_h7a
    s_sleep 4
    s_sub_u32 s84, s84, 1
    s_cmp_lg_u32 s84, 0
    s_cbranch_scc1 L_poll_h7a
L_done_h7a:
    s_setprio 0
    s_mov_b64 exec, -1
    buffer_load_dwordx4 v[128:131], v4, s[44:47], s55 offen offset:0 sc1
    buffer_load_dwordx4 v[132:135], v8, s[44:47], s55 offen offset:0 sc1
    buffer_load_dwordx4 v[136:139], v4, s[44:47], s55 offen offset:2048 sc1
    buffer_load_dwordx4 v[140:143], v8, s[44:47], s55 offen offset:2048 sc1
    buffer_load_dwordx4 v[144:147], v4, s[44:47], s62 offen offset:0 sc1
    buffer_load_dwordx4 v[148:151], v8, s[44:47], s62 offen offset:0 sc1
    buffer_load_dwordx4 v[152:155], v4, s[44:47], s62 offen offset:2048 sc1
    buffer_load_dwordx4 v[156:159], v8, s[44:47], s62 offen offset:2048 sc1
    buffer_load_dword v10, v0, s[44:47], 0 offen sc1
    s_waitcnt vmcnt(7)
    v_mfma_f32_32x32x16_bf16 v[192:207], v[16:19], v[128:131], v[192:207]
    v_mfma_f32_32x32x16_bf16 v[208:223], v[16:19], v[132:135], 0
    v_mfma_f32_32x32x16_bf16 v[224:239], v[20:23], v[128:131], 0
    v_mfma_f32_32x32x16_bf16 v[240:255], v[20:23], v[132:135], 0
    s_add_u32 s75, s75, 2048
    s_cmp_eq_u32 s75, s77
    s_cselect_b32 s75, s76, s75
    buffer_load_dwordx4 v[184:187], v4, s[44:47], s75 offen sc1
    buffer_load_dwordx4 v[188:191], v8, s[44:47], s75 offen sc1
    s_add_u32 s75, s75, 2048
    buffer_load_dwordx4 v[16:19], v4, s[44:47], s75 offen sc1
    buffer_load_dwordx4 v[20:23], v8, s[44:47], s75 offen sc1
    s_waitcnt vmcnt(10)
    s_add_u32 s75, s75, 2048
    buffer_load_dwordx4 v[128:131], v4, s[44:47], s75 offen sc1
    buffer_load_dwordx4 v[132:135], v8, s[44:47], s75 offen sc1
    s_waitcnt vmcnt(11)
    v_mfma_f32_32x32x16_bf16 v[192:207], v[24:27], v[136:139], v[192:207]
    v_mfma_f32_32x32x16_bf16 v[208:223], v[24:27], v[140:143], v[208:223]
    v_mfma_f32_32x32x16_bf16 v[224:239], v[28:31], v[136:139], v[224:239]
    v_mfma_f32_32x32x16_bf16 v[240:255], v[28:31], v[140:143], v[240:255]
    s_waitcnt vmcnt(10)
    s_add_u32 s75, s75, 2048
    buffer_load_dwordx4 v[24:27], v4, s[44:47], s75 offen sc1
    buffer_load_dwordx4 v[28:31], v8, s[44:47], s75 offen sc1
    ds_read_b64_tr_b16 v[136:137], v2 offset:0
    ds_read_b64_tr_b16 v[138:139], v2 offset:1024
    ds_read_b64_tr_b16 v[140:141], v3 offset:0
    ds_read_b64_tr_b16 v[142:143], v3 offset:1024
    s_waitcnt vmcnt(11)
    v_mfma_f32_32x32x16_bf16 v[192:207], v[32:35], v[144:147], v[192:207]
    v_mfma_f32_32x32x16_bf16 v[208:223], v[32:35], v[148:151], v[208:223]
    v_mfma_f32_32x32x16_bf16 v[224:239], v[36:39], v[144:147], v[224:239]
    v_mfma_f32_32x32x16_bf16 v[240:255], v[36:39], v[148:151], v[240:255]
    s_waitcnt lgkmcnt(0)
    s_waitcnt vmcnt(10)
    s_add_u32 m0, s87, 0
    s_add_u32 s72, s72, 16384
    buffer_load_dwordx4 v6, s[32:35], s72 offen lds
    buffer_load_dwordx4 v5, s[32:35], s72 offen offset:1024 lds
    ds_read_b64_tr_b16 v[32:33], v2 offset:8192
    ds_read_b64_tr_b16 v[34:35], v2 offset:9216
    ds_read_b64_tr_b16 v[36:37], v3 offset:8192
    ds_read_b64_tr_b16 v[38:39], v3 offset:9216
    s_waitcnt vmcnt(11)
    v_mfma_f32_32x32x16_bf16 v[192:207], v[40:43], v[152:155], v[192:207]
    v_mfma_f32_32x32x16_bf16 v[208:223], v[40:43], v[156:159], v[208:223]
    v_mfma_f32_32x32x16_bf16 v[224:239], v[44:47], v[152:155], v[224:239]
    v_mfma_f32_32x32x16_bf16 v[240:255], v[44:47], v[156:159], v[240:255]
    s_waitcnt vmcnt(10)
    s_setprio 2
    v_cmp_ne_u32 vcc, s7, v10
    s_cbranch_vccz L_done_h7b
    s_mov_b32 s84, 400000
L_poll_h7b:
    buffer_load_dword v10, v0, s[44:47], 0 offen sc1
    s_waitcnt vmcnt(0)
    v_cmp_ne_u32 vcc, s7, v10
    s_cbranch_vccz L_done_h7b
    s_sleep 2
    s_sub_u32 s84, s84, 1
    s_cmp_lg_u32 s84, 0
    s_cbranch_scc1 L_poll_h7b
L_done_h7b:
    s_setprio 0
    s_waitcnt lgkmcnt(0)
    s_add_u32 m0, s87, 8192
    s_add_u32 s72, s72, 16384
    buffer_load_dwordx4 v6, s[32:35], s72 offen lds
    buffer_load_dwordx4 v5, s[32:35], s72 offen offset:1024 lds
    s_waitcnt vmcnt(10)
    s_add_u32 s75, s75, 2048
    s_cmp_eq_u32 s75, s77
    s_cselect_b32 s75, s76, s75
    buffer_load_dwordx4 v[40:43], v4, s[44:47], s75 offen sc1
    buffer_load_dwordx4 v[44:47], v8, s[44:47], s75 offen sc1
    s_waitcnt vmcnt(10)
    s_add_u32 s75, s75, 2048
    buffer_load_dwordx4 v[152:155], v4, s[44:47], s75 offen sc1
    buffer_load_dwordx4 v[156:159], v8, s[44:47], s75 offen sc1
    ds_read_b64_tr_b16 v[144:145], v2 offset:32768
    ds_read_b64_tr_b16 v[146:147], v2 offset:33792
    ds_read_b64_tr_b16 v[148:149], v3 offset:32768
    ds_read_b64_tr_b16 v[150:151], v3 offset:33792
    v_mfma_f32_32x32x16_bf16 v[192:207], v[48:51], v[184:187], v[192:207]
    v_mfma_f32_32x32x16_bf16 v[208:223], v[48:51], v[188:191], v[208:223]
    v_mfma_f32_32x32x16_bf16 v[224:239], v[52:55], v[184:187], v[224:239]
    v_mfma_f32_32x32x16_bf16 v[240:255], v[52:55], v[188:191], v[240:255]
    s_waitcnt lgkmcnt(0)
    s_waitcnt vmcnt(10)
    s_add_u32 m0, s87, 32768
    s_add_u32 s72, s72, 16384
    s_cmp_eq_u32 s72, s74
    s_cselect_b32 s72, s73, s72
    buffer_load_dwordx4 v6, s[32:35], s72 offen lds
    buffer_load_dwordx4 v5, s[32:35], s72 offen offset:1024 lds
    s_waitcnt vmcnt(10)
    s_add_u32 s75, s75, 2048
    buffer_load_dwordx4 v[184:187], v4, s[44:47], s75 offen sc1
    buffer_load_dwordx4 v[188:191], v8, s[44:47], s75 offen sc1
    ds_read_b64_tr_b16 v[48:49], v2 offset:16384
    ds_read_b64_tr_b16 v[50:51], v2 offset:17408
    ds_read_b64_tr_b16 v[52:53], v3 offset:16384
    ds_read_b64_tr_b16 v[54:55], v3 offset:17408
    v_mfma_f32_32x32x16_bf16 v[192:207], v[56:59], v[16:19], v[192:207]
    v_mfma_f32_32x32x16_bf16 v[208:223], v[56:59], v[20:23], v[208:223]
    v_mfma_f32_32x32x16_bf16 v[224:239], v[60:63], v[16:19], v[224:239]
    v_mfma_f32_32x32x16_bf16 v[240:255], v[60:63], v[20:23], v[240:255]
    s_waitcnt lgkmcnt(0)
    s_waitcnt vmcnt(10)
    s_add_u32 m0, s87, 16384
    s_add_u32 s72, s72, 16384
    buffer_load_dwordx4 v6, s[32:35], s72 offen lds
    buffer_load_dwordx4 v5, s[32:35], s72 offen offset:1024 lds
    s_waitcnt vmcnt(10)
    s_add_u32 s75, s75, 2048
    buffer_load_dwordx4 v[16:19], v4, s[44:47], s75 offen sc1
    buffer_load_dwordx4 v[20:23], v8, s[44:47], s75 offen sc1
    ds_read_b64_tr_b16 v[56:57], v2 offset:24576
    ds_read_b64_tr_b16 v[58:59], v2 offset:25600
    ds_read_b64_tr_b16 v[60:61], v3 offset:24576
    ds_read_b64_tr_b16 v[62:63], v3 offset:25600
    v_mfma_f32_32x32x16_bf16 v[192:207], v[64:67], v[128:131], v[192:207]
    v_mfma_f32_32x32x16_bf16 v[208:223], v[64:67], v[132:135], v[208:223]
    v_mfma_f32_32x32x16_bf16 v[224:239], v[68:71], v[128:131], v[224:239]
    v_mfma_f32_32x32x16_bf16 v[240:255], v[68:71], v[132:135], v[240:255]
    s_waitcnt lgkmcnt(0)
    s_waitcnt vmcnt(10)
    s_add_u32 m0, s87, 24576
    s_add_u32 s72, s72, 16384
    buffer_load_dwordx4 v6, s[32:35], s72 offen lds
    buffer_load_dwordx4 v5, s[32:35], s72 offen offset:1024 lds
    s_waitcnt vmcnt(10)
    s_add_u32 s75, s75, 2048
    s_cmp_eq_u32 s75, s77
    s_cselect_b32 s75, s76, s75
    buffer_load_dwordx4 v[128:131], v4, s[44:47], s75 offen sc1
    buffer_load_dwordx4 v[132:135], v8, s[44:47], s75 offen sc1
    ds_read_b64_tr_b16 v[64:65], v2 offset:0
    ds_read_b64_tr_b16 v[66:67], v2 offset:1024
    ds_read_b64_tr_b16 v[68:69], v3 offset:0
    ds_read_b64_tr_b16 v[70:71], v3 offset:1024
    v_mfma_f32_32x32x16_bf16 v[192:207], v[72:75], v[24:27], v[192:207]
    v_mfma_f32_32x32x16_bf16 v[208:223], v[72:75], v[28:31], v[208:223]
    v_mfma_f32_32x32x16_bf16 v[224:239], v[76:79], v[24:27], v[224:239]
    v_mfma_f32_32x32x16_bf16 v[240:255], v[76:79], v[28:31], v[240:255]
    s_waitcnt lgkmcnt(0)
    s_waitcnt vmcnt(10)
    s_add_u32 m0, s87, 0
    s_add_u32 s72, s72, 16384
    buffer_load_dwordx4 v6, s[32:35], s72 offen lds
    buffer_load_dwordx4 v5, s[32:35], s72 offen offset:1024 lds
    s_waitcnt vmcnt(10)
    s_add_u32 s75, s75, 2048
    buffer_load_dwordx4 v[72:75], v4, s[44:47], s75 offen sc1
    buffer_load_dwordx4 v[76:79], v8, s[44:47], s75 offen sc1
    ds_read_b64_tr_b16 v[24:25], v2 offset:8192
    ds_read_b64_tr_b16 v[26:27], v2 offset:9216
    ds_read_b64_tr_b16 v[28:29], v3 offset:8192
    ds_read_b64_tr_b16 v[30:31], v3 offset:9216
    v_mfma_f32_32x32x16_bf16 v[192:207], v[80:83], v[40:43], v[192:207]
    v_mfma_f32_32x32x16_bf16 v[208:223], v[80:83], v[44:47], v[208:223]
    v_mfma_f32_32x32x16_bf16 v[224:239], v[84:87], v[40:43], v[224:239]
    v_mfma_f32_32x32x16_bf16 v[240:255], v[84:87], v[44:47], v[240:255]
    s_waitcnt vmcnt(10)
    s_add_u32 s75, s75, 2048
    buffer_load_dwordx4 v[80:83], v4, s[44:47], s75 offen sc1
    buffer_load_dwordx4 v[84:87], v8, s[44:47], s75 offen sc1
    s_waitcnt vmcnt(10)
    s_add_u32 s75, s75, 2048
    buffer_load_dwordx4 v[40:43], v4, s[44:47], s75 offen sc1
    buffer_load_dwordx4 v[44:47], v8, s[44:47], s75 offen sc1
    v_mfma_f32_32x32x16_bf16 v[192:207], v[88:91], v[152:155], v[192:207]
    v_mfma_f32_32x32x16_bf16 v[208:223], v[88:91], v[156:159], v[208:223]
    v_mfma_f32_32x32x16_bf16 v[224:239], v[92:95], v[152:155], v[224:239]
    v_mfma_f32_32x32x16_bf16 v[240:255], v[92:95], v[156:159], v[240:255]
    s_waitcnt vmcnt(10)
    s_add_u32 s75, s75, 2048
    s_cmp_eq_u32 s75, s77
    s_cselect_b32 s75, s76, s75
    buffer_load_dwordx4 v[152:155], v4, s[44:47], s75 offen sc1
    buffer_load_dwordx4 v[156:159], v8, s[44:47], s75 offen sc1
    ds_read_b64_tr_b16 v[88:89], v2 offset:32768
    ds_read_b64_tr_b16 v[90:91], v2 offset:33792
    ds_read_b64_tr_b16 v[92:93], v3 offset:32768
    ds_read_b64_tr_b16 v[94:95], v3 offset:33792
    v_mfma_f32_32x32x16_bf16 v[192:207], v[96:99], v[184:187], v[192:207]
    v_mfma_f32_32x32x16_bf16 v[208:223], v[96:99], v[188:191], v[208:223]
    v_mfma_f32_32x32x16_bf16 v[224:239], v[100:103], v[184:187], v[224:239]
    v_mfma_f32_32x32x16_bf16 v[240:255], v[100:103], v[188:191], v[240:255]
    s_waitcnt vmcnt(10)
    s_add_u32 s75, s75, 2048
    buffer_load_dwordx4 v[96:99], v4, s[44:47], s75 offen sc1
    buffer_load_dwordx4 v[100:103], v8, s[44:47], s75 offen sc1
    ds_read_b64_tr_b16 v[184:185], v2 offset:16384
    ds_read_b64_tr_b16 v[186:187], v2 offset:17408
    ds_read_b64_tr_b16 v[188:189], v3 offset:16384
    ds_read_b64_tr_b16 v[190:191], v3 offset:17408
    v_mfma_f32_32x32x16_bf16 v[192:207], v[104:107], v[16:19], v[192:207]
    v_mfma_f32_32x32x16_bf16 v[208:223], v[104:107], v[20:23], v[208:223]
    v_mfma_f32_32x32x16_bf16 v[224:239], v[108:111], v[16:19], v[224:239]
    v_mfma_f32_32x32x16_bf16 v[240:255], v[108:111], v[20:23], v[240:255]
    s_waitcnt vmcnt(10)
    s_add_u32 s75, s75, 2048
    buffer_load_dwordx4 v[104:107], v4, s[44:47], s75 offen sc1
    buffer_load_dwordx4 v[108:111], v8, s[44:47], s75 offen sc1
    s_waitcnt vmcnt(10)
    s_add_u32 s75, s75, 2048
    buffer_load_dwordx4 v[16:19], v4, s[44:47], s75 offen sc1
    buffer_load_dwordx4 v[20:23], v8, s[44:47], s75 offen sc1
    v_mfma_f32_32x32x16_bf16 v[192:207], v[112:115], v[128:131], v[192:207]
    v_mfma_f32_32x32x16_bf16 v[208:223], v[112:115], v[132:135], v[208:223]
    v_mfma_f32_32x32x16_bf16 v[224:239], v[116:119], v[128:131], v[224:239]
    v_mfma_f32_32x32x16_bf16 v[240:255], v[116:119], v[132:135], v[240:255]
    s_waitcnt vmcnt(10)
    s_add_u32 s75, s75, 2048
    s_cmp_eq_u32 s75, s77
    s_cselect_b32 s75, s76, s75
    buffer_load_dwordx4 v[128:131], v4, s[44:47], s75 offen sc1
    buffer_load_dwordx4 v[132:135], v8, s[44:47], s75 offen sc1
    ds_read_b64_tr_b16 v[112:113], v2 offset:24576
    ds_read_b64_tr_b16 v[114:115], v2 offset:25600
    ds_read_b64_tr_b16 v[116:117], v3 offset:24576
    ds_read_b64_tr_b16 v[118:119], v3 offset:25600
    v_mfma_f32_32x32x16_bf16 v[192:207], v[120:123], v[72:75], v[192:207]
    v_mfma_f32_32x32x16_bf16 v[208:223], v[120:123], v[76:79], v[208:223]
    v_mfma_f32_32x32x16_bf16 v[224:239], v[124:127], v[72:75], v[224:239]
    v_mfma_f32_32x32x16_bf16 v[240:255], v[124:127], v[76:79], v[240:255]
    s_waitcnt vmcnt(10)
    s_add_u32 s75, s75, 2048
    buffer_load_dwordx4 v[72:75], v4, s[44:47], s75 offen sc1
    buffer_load_dwordx4 v[76:79], v8, s[44:47], s75 offen sc1
    ds_read_b64_tr_b16 v[120:121], v2 offset:0
    ds_read_b64_tr_b16 v[122:123], v2 offset:1024
    ds_read_b64_tr_b16 v[124:125], v3 offset:0
    ds_read_b64_tr_b16 v[126:127], v3 offset:1024
    v_mfma_f32_32x32x16_bf16 v[192:207], v[160:163], v[80:83], v[192:207]
    v_mfma_f32_32x32x16_bf16 v[208:223], v[160:163], v[84:87], v[208:223]
    v_mfma_f32_32x32x16_bf16 v[224:239], v[164:167], v[80:83], v[224:239]
    v_mfma_f32_32x32x16_bf16 v[240:255], v[164:167], v[84:87], v[240:255]
    s_waitcnt vmcnt(10)
    s_add_u32 s75, s75, 2048
    buffer_load_dwordx4 v[160:163], v4, s[44:47], s75 offen sc1
    buffer_load_dwordx4 v[164:167], v8, s[44:47], s75 offen sc1
    s_waitcnt vmcnt(10)
    s_add_u32 s75, s75, 2048
    buffer_load_dwordx4 v[80:83], v4, s[44:47], s75 offen sc1
    buffer_load_dwordx4 v[84:87], v8, s[44:47], s75 offen sc1
    v_mfma_f32_32x32x16_bf16 v[192:207], v[168:171], v[40:43], v[192:207]
    v_mfma_f32_32x32x16_bf16 v[208:223], v[168:171], v[44:47], v[208:223]
    v_mfma_f32_32x32x16_bf16 v[224:239], v[172:175], v[40:43], v[224:239]
    v_mfma_f32_32x32x16_bf16 v[240:255], v[172:175], v[44:47], v[240:255]
    s_waitcnt vmcnt(10)
    s_add_u32 s75, s75, 2048
    s_cmp_eq_u32 s75, s77
    s_cselect_b32 s75, s76, s75
    buffer_load_dwordx4 v[168:171], v4, s[44:47], s75 offen sc1
    buffer_load_dwordx4 v[172:175], v8, s[44:47], s75 offen sc1
    s_waitcnt vmcnt(10)
    s_add_u32 s75, s75, 2048
    buffer_load_dwordx4 v[40:43], v4, s[44:47], s75 offen sc1
    buffer_load_dwordx4 v[44:47], v8, s[44:47], s75 offen sc1
    v_mfma_f32_32x32x16_bf16 v[192:207], v[176:179], v[152:155], v[192:207]
    v_mfma_f32_32x32x16_bf16 v[208:223], v[176:179], v[156:159], v[208:223]
    v_mfma_f32_32x32x16_bf16 v[224:239], v[180:183], v[152:155], v[224:239]
    v_mfma_f32_32x32x16_bf16 v[240:255], v[180:183], v[156:159], v[240:255]
    s_waitcnt vmcnt(10)
    s_add_u32 s75, s75, 2048
    buffer_load_dwordx4 v[176:179], v4, s[44:47], s75 offen sc1
    buffer_load_dwordx4 v[180:183], v8, s[44:47], s75 offen sc1
    s_waitcnt vmcnt(10)
    s_add_u32 s75, s75, 2048
    buffer_load_dwordx4 v[152:155], v4, s[44:47], s75 offen sc1
    buffer_load_dwordx4 v[156:159], v8, s[44:47], s75 offen sc1
    v_mfma_f32_32x32x16_bf16 v[192:207], v[136:139], v[96:99], v[192:207]
    v_mfma_f32_32x32x16_bf16 v[208:223], v[136:139], v[100:103], v[208:223]
    v_mfma_f32_32x32x16_bf16 v[224:239], v[140:143], v[96:99], v[224:239]
    v_mfma_f32_32x32x16_bf16 v[240:255], v[140:143], v[100:103], v[240:255]
    s_and_b32 s60, s6, 1
    s_mul_i32 s61, s60, 8704
    s_lshr_b32 s62, s6, 1
    s_lshl_b32 s62, s62, 7
    s_add_u32 s61, s61, s62
    s_add_u32 s61, s61, 115712
    s_lshl_b32 s60, s60, 7
    s_add_u32 s60, s60, 162880
    s_mul_i32 s62, s6, 12288
    s_xor_b32 s63, s6, 1
    s_mul_i32 s63, s63, 12288
    s_add_u32 s63, s63, 0
    s_xor_b32 s64, s6, 2
    s_mul_i32 s64, s64, 12288
    s_add_u32 s64, s64, 4096
    s_xor_b32 s65, s6, 3
    s_mul_i32 s65, s65, 12288
    s_add_u32 s65, s65, 8192
    s_setprio 2
    v_add_u32 v5, s63, v7
    v_add_u32 v6, s64, v7
    v_add_u32 v14, s65, v7
    v_add_u32 v9, s62, v7
    v_and_b32 v7, 31, v1
    v_lshl_add_u32 v0, v7, 2, s60
    v_mul_u32_u24 v7, 272, v7
    v_and_b32 v13, 32, v1
    v_lshrrev_b32 v13, 1, v13
    v_add3_u32 v7, v7, v13, s61
    s_setprio 0
    ds_read_b32 v0, v0
    s_waitcnt lgkmcnt(0)
    s_setprio 2
    v_mul_f32 v0, v0, v0
    v_rcp_f32 v13, v0
    s_nop 0
    v_mul_f32 v13, 0xbfb8aa3b, v13
    s_setprio 0
    s_waitcnt vmcnt(0)
    s_branch L_join7
L_att:
    s_load_dwordx2 s[40:41], s[0:1], 80
    s_mov_b32 s42, 2097152
    s_mov_b32 s43, 0x20000
    s_mul_i32 s60, s50, 8320
    v_mul_u32_u24 v118, 1040, v3
    v_add3_u32 v118, v118, v4, s60
    v_mov_b32 v12, 1
    v_mov_b64 v[124:125], 0
    v_mov_b32 v126, 0x3727c5ac
    s_lshl_b32 s60, s50, 5
    s_add_u32 s60, s60, 162880
    v_lshl_add_u32 v127, v3, 2, s60
    s_mov_b32 s56, 0x3f803f80
    s_mov_b32 s57, 0x00003f80
    s_mov_b32 s58, 0x3f800000
    s_mov_b32 s59, 0x3b000000
    v_and_b32 v116, 3, v1
    v_lshlrev_b32 v116, 3, v116
    v_and_b32 v3, 16, v1
    v_lshl_or_b32 v116, v3, 1, v116
    v_and_b32 v3, 8, v1
    v_lshl_or_b32 v116, v3, 3, v116
    v_and_b32 v3, 12, v1
    v_lshl_or_b32 v116, v3, 5, v116
    s_lshr_b32 s60, s6, 1
    s_and_b32 s61, s6, 1
    s_lshl_b32 s62, s60, 6
    v_and_b32 v3, 32, v1
    v_lshl_or_b32 v116, v3, 5, v116
    v_xor_b32 v116, s62, v116
    v_add_u32 v116, 66560, v116
    s_mul_i32 s63, s61, 33280
    s_lshl_b32 s65, s6, 16
    s_add_u32 s65, s65, 262144
    s_add_u32 s66, s65, 1024
    s_add_u32 s67, s65, 2048
    v_add_u32 v9, s65, v7
    v_and_b32 v4, 31, v1
    v_mul_u32_u24 v4, 1040, v4
    v_lshrrev_b32 v3, 1, v3
    v_add3_u32 v117, v4, v3, s63
    s_lshl_b32 s64, s60, 2
    s_add_u32 s64, s64, s61
    s_lshl_b32 s64, s64, 10
    s_add_u32 s64, s64, 148480
    v_add_u32 v119, s64, v7
    v_and_b32 v24, 15, v1
    v_lshlrev_b32 v24, 4, v24
    v_and_b32 v3, 32, v1
    v_lshl_or_b32 v24, v3, 3, v24
    v_add_u32 v24, s66, v24
    v_add_u32 v25, 512, v24
    s_mov_b32 exec_lo, 0xffff0000
    s_mov_b32 exec_hi, 0xffff0000
    v_mov_b32 v24, 1073741824
    v_mov_b32 v25, 1073741824
    s_mov_b32 exec_lo, 0x00110000
    s_mov_b32 exec_hi, 0x00110000
    v_mov_b32 v24, s67
    v_mov_b32 v25, s67
    s_mov_b64 exec, -1
    s_add_u32 s60, s6, 1
    s_and_b32 s60, s60, 3
    s_lshl_b32 s61, s60, 11
    s_add_u32 s61, s61, 148480
    v_add_u32 v120, s61, v7
    s_mul_i32 s62, s60, 12288
    s_add_u32 s62, s62, 0
    v_add_u32 v16, s62, v7
    s_mul_i32 s62, s60, 1536
    s_add_u32 s62, s62, 156672
    v_lshl_add_u32 v19, v1, 2, s62
    s_add_u32 s60, s6, 2
    s_and_b32 s60, s60, 3
    s_lshl_b32 s61, s60, 11
    s_add_u32 s61, s61, 148480
    v_add_u32 v121, s61, v7
    s_mul_i32 s62, s60, 12288
    s_add_u32 s62, s62, 4096
    v_add_u32 v17, s62, v7
    s_mul_i32 s62, s60, 1536
    s_add_u32 s62, s62, 157184
    v_lshl_add_u32 v20, v1, 2, s62
    s_add_u32 s60, s6, 3
    s_and_b32 s60, s60, 3
    s_lshl_b32 s61, s60, 11
    s_add_u32 s61, s61, 148480
    v_add_u32 v122, s61, v7
    s_mul_i32 s62, s60, 12288
    s_add_u32 s62, s62, 8192
    v_add_u32 v18, s62, v7
    s_mul_i32 s62, s60, 1536
    s_add_u32 s62, s62, 157696
    v_lshl_add_u32 v21, v1, 2, s62
    s_add_u32 s60, s6, 4
    s_and_b32 s60, s60, 3
    s_lshl_b32 s61, s60, 11
    s_add_u32 s61, s61, 148480
    v_add_u32 v123, s61, v7
    s_mul_i32 s62, s6, 12288
    s_add_u32 s62, s62, 0
    v_add_u32 v22, s62, v7
    s_mul_i32 s62, s6, 1536
    s_add_u32 s62, s62, 156672
    v_lshl_add_u32 v23, v1, 2, s62
    s_lshl_b32 s60, s6, 12
    s_add_u32 s60, s60, 4096
    v_lshl_add_u32 v3, v1, 6, s60
    s_lshl_b32 s61, s52, 9
    s_add_u32 s82, s61, s60
    s_lshl_b32 s85, s52, 13
    s_lshl_b32 s82, s82, 1
    s_add_u32 s82, s82, 24576
    s_add_u32 s85, s85, 262144
    s_mov_b32 s73, 0x3eb8aa3b
    s_lshl_b32 s60, s5, 2
    s_add_u32 s60, s60, s6
    s_lshl_b32 s61, s4, 5
    s_add_u32 s60, s60, s61
    s_lshl_b32 s72, s60, 11
    s_add_u32 s72, s72, 1048576
    s_lshl_b32 s83, s60, 6
    s_add_u32 s83, s83, 196608
    s_lshl_b32 s86, s4, 16
    s_add_u32 s86, s86, s53
    v_and_b32 v60, 15, v1
    v_lshrrev_b32 v61, 4, v1
    v_and_b32 v62, 16, v1
    v_and_b32 v63, 32, v1
    s_lshl_b32 s60, s6, 4
    v_add_u32 v14, s60, v60
    v_lshlrev_b32 v8, 10, v14
    v_lshl_or_b32 v2, v61, 3, v8
    v_lshl_or_b32 v8, v62, 1, v8
    v_lshrrev_b32 v64, 1, v63
    v_or_b32 v8, v8, v64
    v_mul_u32_u24 v14, 272, v14
    v_lshl_add_u32 v14, v61, 4, v14
    v_add_u32 v14, 115712, v14
    v_and_b32 v0, 3, v1
    v_lshlrev_b32 v0, 3, v0
    v_and_b32 v64, 28, v1
    v_lshl_or_b32 v0, v64, 5, v0
    v_lshl_or_b32 v0, v63, 6, v0
    v_and_b32 v64, 24, v1
    v_lshl_or_b32 v0, v64, 2, v0
    v_add_u32 v0, 50176, v0
    s_lshr_b32 s60, s6, 1
    s_lshl_b32 s60, s60, 10
    s_and_b32 s61, s6, 1
    s_lshl_b32 s61, s61, 8
    s_add_u32 s60, s60, s61
    s_lshl_b32 s61, s4, 16
    s_add_u32 s60, s60, s61
    s_add_u32 s60, s60, 1048576
    v_lshlrev_b32 v4, 6, v63
    v_lshl_or_b32 v4, v60, 4, v4
    v_lshl_or_b32 v4, v62, 5, v4
    v_add_u32 v4, s60, v4
    s_lshl_b32 s60, s4, 11
    s_add_u32 s60, s60, 196608
    v_and_b32 v10, 31, v1
    v_lshl_add_u32 v10, v10, 6, s60
    s_add_u32 s74, s5, 0
    s_and_b32 s74, s74, 7
    s_lshl_b32 s74, s74, 13
    s_add_u32 s75, s5, 1
    s_and_b32 s75, s75, 7
    s_lshl_b32 s75, s75, 13
    s_add_u32 s76, s5, 2
    s_and_b32 s76, s76, 7
    s_lshl_b32 s76, s76, 13
    s_add_u32 s77, s5, 3
    s_and_b32 s77, s77, 7
    s_lshl_b32 s77, s77, 13
    s_add_u32 s78, s5, 4
    s_and_b32 s78, s78, 7
    s_lshl_b32 s78, s78, 13
    s_add_u32 s79, s5, 5
    s_and_b32 s79, s79, 7
    s_lshl_b32 s79, s79, 13
    s_add_u32 s80, s5, 6
    s_and_b32 s80, s80, 7
    s_lshl_b32 s80, s80, 13
    s_add_u32 s81, s5, 7
    s_and_b32 s81, s81, 7
    s_lshl_b32 s81, s81, 13
    s_add_u32 s60, s52, 1
    s_and_b32 s60, s60, 7
    s_lshl_b32 s60, s60, 3
    s_mov_b64 s[36:37], 0xff
    s_lshl_b64 s[36:37], s[36:37], s60
    s_add_u32 s22, s85, 8192
    s_and_b32 s22, s22, 0xffff
    s_add_u32 s23, s85, 12288
    s_and_b32 s23, s23, 0xffff
    s_add_u32 s24, s85, 16384
    s_and_b32 s24, s24, 0xffff
    s_add_u32 s25, s85, 20480
    s_and_b32 s25, s25, 0xffff
    s_add_u32 s26, s85, 24576
    s_and_b32 s26, s26, 0xffff
    s_add_u32 s27, s85, 28672
    s_and_b32 s27, s27, 0xffff
    s_add_u32 s28, s85, 32768
    s_and_b32 s28, s28, 0xffff
    s_add_u32 s29, s85, 36864
    s_and_b32 s29, s29, 0xffff
    s_add_u32 s30, s85, 40960
    s_and_b32 s30, s30, 0xffff
    s_add_u32 s31, s85, 45056
    s_and_b32 s31, s31, 0xffff
    s_add_u32 s32, s85, 49152
    s_and_b32 s32, s32, 0xffff
    s_add_u32 s33, s85, 53248
    s_and_b32 s33, s33, 0xffff
    s_add_u32 s34, s85, 57344
    s_and_b32 s34, s34, 0xffff
    s_add_u32 s35, s85, 61440
    s_and_b32 s35, s35, 0xffff
    v_mov_b64 v[128:129], 0
    v_mov_b64 v[130:131], 0
    v_mov_b64 v[132:133], 0
    v_mov_b64 v[134:135], 0
    v_mov_b64 v[136:137], 0
    v_mov_b64 v[138:139], 0
    v_mov_b64 v[140:141], 0
    v_mov_b64 v[142:143], 0
    v_mov_b64 v[144:145], 0
    v_mov_b64 v[146:147], 0
    v_mov_b64 v[148:149], 0
    v_mov_b64 v[150:151], 0
    v_mov_b64 v[152:153], 0
    v_mov_b64 v[154:155], 0
    v_mov_b64 v[156:157], 0
    v_mov_b64 v[158:159], 0
    v_mov_b64 v[160:161], 0
    v_mov_b64 v[162:163], 0
    v_mov_b64 v[164:165], 0
    v_mov_b64 v[166:167], 0
    v_mov_b64 v[168:169], 0
    v_mov_b64 v[170:171], 0
    v_mov_b64 v[172:173], 0
    v_mov_b64 v[174:175], 0
    v_mov_b64 v[176:177], 0
    v_mov_b64 v[178:179], 0
    v_mov_b64 v[180:181], 0
    v_mov_b64 v[182:183], 0
    v_mov_b64 v[184:185], 0
    v_mov_b64 v[186:187], 0
    v_mov_b64 v[188:189], 0
    v_mov_b64 v[190:191], 0
    v_mov_b64 v[192:193], 0
    v_mov_b64 v[194:195], 0
    v_mov_b64 v[196:197], 0
    v_mov_b64 v[198:199], 0
    v_mov_b64 v[200:201], 0
    v_mov_b64 v[202:203], 0
    v_mov_b64 v[204:205], 0
    v_mov_b64 v[206:207], 0
    v_mov_b64 v[208:209], 0
    v_mov_b64 v[210:211], 0
    v_mov_b64 v[212:213], 0
    v_mov_b64 v[214:215], 0
    v_mov_b64 v[216:217], 0
    v_mov_b64 v[218:219], 0
    v_mov_b64 v[220:221], 0
    v_mov_b64 v[222:223], 0
    v_mov_b64 v[224:225], 0
    v_mov_b64 v[226:227], 0
    v_mov_b64 v[228:229], 0
    v_mov_b64 v[230:231], 0
    v_mov_b64 v[232:233], 0
    v_mov_b64 v[234:235], 0
    v_mov_b64 v[236:237], 0
    v_mov_b64 v[238:239], 0
    v_mov_b64 v[240:241], 0
    v_mov_b64 v[242:243], 0
    v_mov_b64 v[244:245], 0
    v_mov_b64 v[246:247], 0
    v_mov_b64 v[248:249], 0
    v_mov_b64 v[250:251], 0
    v_mov_b64 v[252:253], 0
    v_mov_b64 v[254:255], 0
    s_waitcnt lgkmcnt(0)
    s_barrier
    buffer_load_dwordx4 v[28:31], v5, s[8:11], s54 offen offset:0
    buffer_load_dwordx4 v[32:35], v5, s[8:11], s54 offen offset:128
    buffer_load_dwordx4 v[36:39], v5, s[8:11], s54 offen offset:256
    buffer_load_dwordx4 v[40:43], v5, s[8:11], s54 offen offset:384
    buffer_load_dwordx4 v[44:47], v5, s[8:11], s54 offen offset:512
    buffer_load_dwordx4 v[48:51], v5, s[8:11], s54 offen offset:640
    buffer_load_dwordx4 v[52:55], v5, s[8:11], s54 offen offset:768
    buffer_load_dwordx4 v[56:59], v5, s[8:11], s54 offen offset:896
    s_lshl_b32 s62, s6, 12
    s_add_u32 m0, s62, 132096
    s_lshl_b32 s60, s51, 2
    buffer_load_dwordx4 v7, s[16:19], s62 offen offset:0 lds
    buffer_load_dwordx4 v7, s[16:19], s62 offen offset:1024 lds
    buffer_load_dwordx4 v7, s[16:19], s62 offen offset:2048 lds
    buffer_load_dwordx4 v7, s[16:19], s62 offen offset:3072 lds
    s_add_u32 s60, s60, s6
    s_lshl_b32 s61, s60, 12
    s_lshl_b32 s60, s60, 15
    buffer_load_dwordx4 v[80:83], v6, s[12:15], s60 offen
    s_add_u32 s60, s60, 8192
    buffer_load_dwordx4 v[84:87], v6, s[12:15], s60 offen
    s_add_u32 s60, s60, 8192
    buffer_load_dwordx4 v[88:91], v6, s[12:15], s60 offen
    s_add_u32 s60, s60, 8192
    buffer_load_dwordx4 v[92:95], v6, s[12:15], s60 offen
    s_waitcnt vmcnt(15)
    v_dot2c_f32_bf16 v124, s56, v28
    v_dot2c_f32_bf16 v124, s56, v29
    v_dot2c_f32_bf16 v124, s56, v30
    v_dot2c_f32_bf16 v124, s56, v31
    s_waitcnt vmcnt(14)
    v_dot2c_f32_bf16 v124, s56, v32
    v_dot2c_f32_bf16 v124, s56, v33
    v_dot2c_f32_bf16 v124, s56, v34
    v_dot2c_f32_bf16 v124, s56, v35
    s_waitcnt vmcnt(13)
    v_dot2c_f32_bf16 v124, s56, v36
    v_dot2c_f32_bf16 v124, s56, v37
    v_dot2c_f32_bf16 v124, s56, v38
    v_dot2c_f32_bf16 v124, s56, v39
    s_waitcnt vmcnt(12)
    v_dot2c_f32_bf16 v124, s56, v40
    v_dot2c_f32_bf16 v124, s56, v41
    v_dot2c_f32_bf16 v124, s56, v42
    v_dot2c_f32_bf16 v124, s56, v43
    s_waitcnt vmcnt(11)
    v_dot2c_f32_bf16 v124, s56, v44
    v_dot2c_f32_bf16 v124, s56, v45
    v_dot2c_f32_bf16 v124, s56, v46
    v_dot2c_f32_bf16 v124, s56, v47
    s_waitcnt vmcnt(10)
    v_dot2c_f32_bf16 v124, s56, v48
    v_dot2c_f32_bf16 v124, s56, v49
    v_dot2c_f32_bf16 v124, s56, v50
    v_dot2c_f32_bf16 v124, s56, v51
    s_waitcnt vmcnt(9)
    v_dot2c_f32_bf16 v124, s56, v52
    v_dot2c_f32_bf16 v124, s56, v53
    v_dot2c_f32_bf16 v124, s56, v54
    v_dot2c_f32_bf16 v124, s56, v55
    s_waitcnt vmcnt(8)
    v_dot2c_f32_bf16 v124, s56, v56
    v_dot2c_f32_bf16 v124, s56, v57
    v_dot2c_f32_bf16 v124, s56, v58
    v_dot2c_f32_bf16 v124, s56, v59
    s_waitcnt vmcnt(4)
    s_mov_b64 exec, 1
    ds_add_u32 v11, v12 offset:0
    s_mov_b64 exec, -1
    v_add_f32_dpp v124, v124, v124 quad_perm:[1,0,3,2] row_mask:0xf bank_mask:0xf
    s_nop 1
    v_add_f32_dpp v124, v124, v124 quad_perm:[2,3,0,1] row_mask:0xf bank_mask:0xf
    s_nop 1
    v_add_f32_dpp v124, v124, v124 row_half_mirror row_mask:0xf bank_mask:0xf
    v_mul_f32 v124, 0xbb000000, v124
    v_dot2_f32_bf16 v60, v28, s57, v124
    v_dot2_f32_bf16 v61, v28, s58, v124
    v_dot2_f32_bf16 v62, v29, s57, v124
    v_dot2_f32_bf16 v63, v29, s58, v124
    v_dot2_f32_bf16 v64, v30, s57, v124
    v_dot2_f32_bf16 v65, v30, s58, v124
    v_dot2_f32_bf16 v66, v31, s57, v124
    v_dot2_f32_bf16 v67, v31, s58, v124
    v_dot2_f32_bf16 v68, v32, s57, v124
    v_dot2_f32_bf16 v69, v32, s58, v124
    v_dot2_f32_bf16 v70, v33, s57, v124
    v_dot2_f32_bf16 v71, v33, s58, v124
    v_dot2_f32_bf16 v72, v34, s57, v124
    v_dot2_f32_bf16 v73, v34, s58, v124
    v_dot2_f32_bf16 v74, v35, s57, v124
    v_dot2_f32_bf16 v75, v35, s58, v124
    v_cvt_pk_bf16_f32 v28, v60, v61
    v_cvt_pk_bf16_f32 v29, v62, v63
    v_cvt_pk_bf16_f32 v30, v64, v65
    v_cvt_pk_bf16_f32 v31, v66, v67
    ds_write_b128 v118, v[28:31] offset:0
    v_dot2c_f32_bf16 v125, v28, v28
    v_dot2c_f32_bf16 v125, v29, v29
    v_dot2c_f32_bf16 v125, v30, v30
    v_dot2c_f32_bf16 v125, v31, v31
    v_dot2_f32_bf16 v60, v36, s57, v124
    v_dot2_f32_bf16 v61, v36, s58, v124
    v_dot2_f32_bf16 v62, v37, s57, v124
    v_dot2_f32_bf16 v63, v37, s58, v124
    v_dot2_f32_bf16 v64, v38, s57, v124
    v_dot2_f32_bf16 v65, v38, s58, v124
    v_dot2_f32_bf16 v66, v39, s57, v124
    v_dot2_f32_bf16 v67, v39, s58, v124
    v_cvt_pk_bf16_f32 v32, v68, v69
    v_cvt_pk_bf16_f32 v33, v70, v71
    v_cvt_pk_bf16_f32 v34, v72, v73
    v_cvt_pk_bf16_f32 v35, v74, v75
    ds_write_b128 v118, v[32:35] offset:128
    v_dot2c_f32_bf16 v125, v32, v32
    v_dot2c_f32_bf16 v125, v33, v33
    v_dot2c_f32_bf16 v125, v34, v34
    v_dot2c_f32_bf16 v125, v35, v35
    v_dot2_f32_bf16 v68, v40, s57, v124
    v_dot2_f32_bf16 v69, v40, s58, v124
    v_dot2_f32_bf16 v70, v41, s57, v124
    v_dot2_f32_bf16 v71, v41, s58, v124
    v_dot2_f32_bf16 v72, v42, s57, v124
    v_dot2_f32_bf16 v73, v42, s58, v124
    v_dot2_f32_bf16 v74, v43, s57, v124
    v_dot2_f32_bf16 v75, v43, s58, v124
    v_cvt_pk_bf16_f32 v36, v60, v61
    v_cvt_pk_bf16_f32 v37, v62, v63
    v_cvt_pk_bf16_f32 v38, v64, v65
    v_cvt_pk_bf16_f32 v39, v66, v67
    ds_write_b128 v118, v[36:39] offset:256
    v_dot2c_f32_bf16 v125, v36, v36
    v_dot2c_f32_bf16 v125, v37, v37
    v_dot2c_f32_bf16 v125, v38, v38
    v_dot2c_f32_bf16 v125, v39, v39
    v_dot2_f32_bf16 v60, v44, s57, v124
    v_dot2_f32_bf16 v61, v44, s58, v124
    v_dot2_f32_bf16 v62, v45, s57, v124
    v_dot2_f32_bf16 v63, v45, s58, v124
    v_dot2_f32_bf16 v64, v46, s57, v124
    v_dot2_f32_bf16 v65, v46, s58, v124
    v_dot2_f32_bf16 v66, v47, s57, v124
    v_dot2_f32_bf16 v67, v47, s58, v124
    v_cvt_pk_bf16_f32 v40, v68, v69
    v_cvt_pk_bf16_f32 v41, v70, v71
    v_cvt_pk_bf16_f32 v42, v72, v73
    v_cvt_pk_bf16_f32 v43, v74, v75
    ds_write_b128 v118, v[40:43] offset:384
    v_dot2c_f32_bf16 v125, v40, v40
    v_dot2c_f32_bf16 v125, v41, v41
    v_dot2c_f32_bf16 v125, v42, v42
    v_dot2c_f32_bf16 v125, v43, v43
    v_dot2_f32_bf16 v68, v48, s57, v124
    v_dot2_f32_bf16 v69, v48, s58, v124
    v_dot2_f32_bf16 v70, v49, s57, v124
    v_dot2_f32_bf16 v71, v49, s58, v124
    v_dot2_f32_bf16 v72, v50, s57, v124
    v_dot2_f32_bf16 v73, v50, s58, v124
    v_dot2_f32_bf16 v74, v51, s57, v124
    v_dot2_f32_bf16 v75, v51, s58, v124
    v_cvt_pk_bf16_f32 v44, v60, v61
    v_cvt_pk_bf16_f32 v45, v62, v63
    v_cvt_pk_bf16_f32 v46, v64, v65
    v_cvt_pk_bf16_f32 v47, v66, v67
    ds_write_b128 v118, v[44:47] offset:512
    v_dot2c_f32_bf16 v125, v44, v44
    v_dot2c_f32_bf16 v125, v45, v45
    v_dot2c_f32_bf16 v125, v46, v46
    v_dot2c_f32_bf16 v125, v47, v47
    v_dot2_f32_bf16 v60, v52, s57, v124
    v_dot2_f32_bf16 v61, v52, s58, v124
    v_dot2_f32_bf16 v62, v53, s57, v124
    v_dot2_f32_bf16 v63, v53, s58, v124
    v_dot2_f32_bf16 v64, v54, s57, v124
    v_dot2_f32_bf16 v65, v54, s58, v124
    v_dot2_f32_bf16 v66, v55, s57, v124
    v_dot2_f32_bf16 v67, v55, s58, v124
    v_cvt_pk_bf16_f32 v48, v68, v69
    v_cvt_pk_bf16_f32 v49, v70, v71
    v_cvt_pk_bf16_f32 v50, v72, v73
    v_cvt_pk_bf16_f32 v51, v74, v75
    ds_write_b128 v118, v[48:51] offset:640
    v_dot2c_f32_bf16 v125, v48, v48
    v_dot2c_f32_bf16 v125, v49, v49
    v_dot2c_f32_bf16 v125, v50, v50
    v_dot2c_f32_bf16 v125, v51, v51
    v_dot2_f32_bf16 v68, v56, s57, v124
    v_dot2_f32_bf16 v69, v56, s58, v124
    v_dot2_f32_bf16 v70, v57, s57, v124
    v_dot2_f32_bf16 v71, v57, s58, v124
    v_dot2_f32_bf16 v72, v58, s57, v124
    v_dot2_f32_bf16 v73, v58, s58, v124
    v_dot2_f32_bf16 v74, v59, s57, v124
    v_dot2_f32_bf16 v75, v59, s58, v124
    v_cvt_pk_bf16_f32 v52, v60, v61
    v_cvt_pk_bf16_f32 v53, v62, v63
    v_cvt_pk_bf16_f32 v54, v64, v65
    v_cvt_pk_bf16_f32 v55, v66, v67
    ds_write_b128 v118, v[52:55] offset:768
    v_dot2c_f32_bf16 v125, v52, v52
    v_dot2c_f32_bf16 v125, v53, v53
    v_dot2c_f32_bf16 v125, v54, v54
    v_dot2c_f32_bf16 v125, v55, v55
    s_nop 1
    v_cvt_pk_bf16_f32 v56, v68, v69
    v_cvt_pk_bf16_f32 v57, v70, v71
    v_cvt_pk_bf16_f32 v58, v72, v73
    v_cvt_pk_bf16_f32 v59, v74, v75
    ds_write_b128 v118, v[56:59] offset:896
    v_dot2c_f32_bf16 v125, v56, v56
    v_dot2c_f32_bf16 v125, v57, v57
    v_dot2c_f32_bf16 v125, v58, v58
    v_dot2c_f32_bf16 v125, v59, v59
    s_nop 2
    v_add_f32_dpp v125, v125, v125 quad_perm:[1,0,3,2] row_mask:0xf bank_mask:0xf
    s_nop 1
    v_add_f32_dpp v125, v125, v125 quad_perm:[2,3,0,1] row_mask:0xf bank_mask:0xf
    s_nop 1
    v_add_f32_dpp v125, v125, v125 row_half_mirror row_mask:0xf bank_mask:0xf
    v_fma_f32 v125, v125, s59, v126
    v_sqrt_f32 v125, v125
    s_mov_b32 exec_lo, 0x01010101
    s_mov_b32 exec_hi, 0x01010101
    ds_write_b32 v127, v125
    s_mov_b64 exec, -1
    s_add_u32 s61, s61, 66560
    v_add_u32 v76, s61, v7
    s_waitcnt vmcnt(3)
    ds_write_b128 v76, v[80:83] offset:0
    s_waitcnt vmcnt(2)
    ds_write_b128 v76, v[84:87] offset:1024
    s_waitcnt vmcnt(1)
    ds_write_b128 v76, v[88:91] offset:2048
    s_waitcnt vmcnt(0)
    ds_write_b128 v76, v[92:95] offset:3072
    s_waitcnt vmcnt(0)
    s_mov_b64 exec, 1
    ds_add_u32 v11, v12 offset:32
    s_mov_b64 exec, -1
    v_and_b32 v125, 7, v1
    v_lshl_add_u32 v125, v125, 7, s82
    v_mov_b32 v6, 0xdddddddd
    s_and_b32 s60, s6, 1
    s_lshl_b32 s60, s60, 7
    s_add_u32 s60, s60, 162880
    v_and_b32 v124, 31, v1
    v_lshl_add_u32 v124, v124, 2, s60
    s_mov_b32 s84, 1600000
L_spin_x:
    ds_read_b32 v5, v11 offset:32
    s_waitcnt lgkmcnt(0)
    v_cmp_ne_u32 vcc, 8, v5
    s_cbranch_vccz L_spun_x
    s_sub_u32 s84, s84, 1
    s_cmp_lg_u32 s84, 0
    s_cbranch_scc1 L_spin_x
L_spun_x:
    s_setprio 1
    ds_read_b64_tr_b16 v[52:53], v116 offset:0
    ds_read_b64_tr_b16 v[54:55], v116 offset:512
    ds_read_b128 v[56:59], v117 offset:0
    ds_read_b64_tr_b16 v[60:61], v116 offset:2048
    ds_read_b64_tr_b16 v[62:63], v116 offset:2560
    ds_read_b128 v[64:67], v117 offset:32
    ds_read_b32 v27, v11 offset:36
    ds_read_b32 v124, v124
    ds_read_b64_tr_b16 v[68:69], v116 offset:4096
    ds_read_b64_tr_b16 v[70:71], v116 offset:4608
    ds_read_b128 v[72:75], v117 offset:64
    ds_read_b64_tr_b16 v[76:77], v116 offset:6144
    ds_read_b64_tr_b16 v[78:79], v116 offset:6656
    ds_read_b128 v[80:83], v117 offset:96
    s_waitcnt lgkmcnt(8)
    v_mfma_f32_32x32x16_bf16 v[100:115], v[52:55], v[56:59], 0
    ds_read_b64_tr_b16 v[84:85], v116 offset:8192
    ds_read_b64_tr_b16 v[86:87], v116 offset:8704
    ds_read_b128 v[88:91], v117 offset:128
    v_mfma_f32_32x32x16_bf16 v[100:115], v[60:63], v[64:67], v[100:115]
    ds_read_b64_tr_b16 v[92:93], v116 offset:10240
    ds_read_b64_tr_b16 v[94:95], v116 offset:10752
    ds_read_b128 v[96:99], v117 offset:160
    s_waitcnt lgkmcnt(6)
    v_mfma_f32_32x32x16_bf16 v[100:115], v[68:71], v[72:75], v[100:115]
    ds_read_b64_tr_b16 v[52:53], v116 offset:12288
    ds_read_b64_tr_b16 v[54:55], v116 offset:12800
    ds_read_b128 v[56:59], v117 offset:192
    v_mfma_f32_32x32x16_bf16 v[100:115], v[76:79], v[80:83], v[100:115]
    ds_read_b64_tr_b16 v[60:61], v116 offset:14336
    ds_read_b64_tr_b16 v[62:63], v116 offset:14848
    ds_read_b128 v[64:67], v117 offset:224
    v_readfirstlane_b32 s7, v27
    s_mov_b32 s55, 0
    s_waitcnt lgkmcnt(6)
    v_mfma_f32_32x32x16_bf16 v[100:115], v[84:87], v[88:91], v[100:115]
    ds_read_b64_tr_b16 v[68:69], v116 offset:16384
    ds_read_b64_tr_b16 v[70:71], v116 offset:16896
    ds_read_b128 v[72:75], v117 offset:256
    v_mfma_f32_32x32x16_bf16 v[100:115], v[92:95], v[96:99], v[100:115]
    ds_read_b64_tr_b16 v[76:77], v116 offset:18432
    ds_read_b64_tr_b16 v[78:79], v116 offset:18944
    ds_read_b128 v[80:83], v117 offset:288
    s_add_u32 s87, s7, s48
    s_add_u32 s87, s87, 1
    s_waitcnt lgkmcnt(6)
    v_mfma_f32_32x32x16_bf16 v[100:115], v[52:55], v[56:59], v[100:115]
    ds_read_b64_tr_b16 v[84:85], v116 offset:20480
    ds_read_b64_tr_b16 v[86:87], v116 offset:20992
    ds_read_b128 v[88:91], v117 offset:320
    v_mfma_f32_32x32x16_bf16 v[100:115], v[60:63], v[64:67], v[100:115]
    ds_read_b64_tr_b16 v[92:93], v116 offset:22528
    ds_read_b64_tr_b16 v[94:95], v116 offset:23040
    ds_read_b128 v[96:99], v117 offset:352
    v_rcp_f32 v124, v124
    s_waitcnt lgkmcnt(6)
    v_mfma_f32_32x32x16_bf16 v[100:115], v[68:71], v[72:75], v[100:115]
    ds_read_b64_tr_b16 v[52:53], v116 offset:24576
    ds_read_b64_tr_b16 v[54:55], v116 offset:25088
    ds_read_b128 v[56:59], v117 offset:384
    v_mfma_f32_32x32x16_bf16 v[100:115], v[76:79], v[80:83], v[100:115]
    ds_read_b64_tr_b16 v[60:61], v116 offset:26624
    ds_read_b64_tr_b16 v[62:63], v116 offset:27136
    ds_read_b128 v[64:67], v117 offset:416
    v_mul_f32 v124, s73, v124
    s_waitcnt lgkmcnt(6)
    v_mfma_f32_32x32x16_bf16 v[100:115], v[84:87], v[88:91], v[100:115]
    ds_read_b64_tr_b16 v[68:69], v116 offset:28672
    ds_read_b64_tr_b16 v[70:71], v116 offset:29184
    ds_read_b128 v[72:75], v117 offset:448
    v_mfma_f32_32x32x16_bf16 v[100:115], v[92:95], v[96:99], v[100:115]
    ds_read_b64_tr_b16 v[76:77], v116 offset:30720
    ds_read_b64_tr_b16 v[78:79], v116 offset:31232
    ds_read_b128 v[80:83], v117 offset:480
    s_waitcnt lgkmcnt(6)
    v_mfma_f32_32x32x16_bf16 v[100:115], v[52:55], v[56:59], v[100:115]
    ds_read_b64_tr_b16 v[84:85], v116 offset:32768
    ds_read_b64_tr_b16 v[86:87], v116 offset:33280
    ds_read_b128 v[88:91], v117 offset:512
    v_mfma_f32_32x32x16_bf16 v[100:115], v[60:63], v[64:67], v[100:115]
    ds_read_b64_tr_b16 v[92:93], v116 offset:34816
    ds_read_b64_tr_b16 v[94:95], v116 offset:35328
    ds_read_b128 v[96:99], v117 offset:544
    s_waitcnt lgkmcnt(6)
    v_mfma_f32_32x32x16_bf16 v[100:115], v[68:71], v[72:75], v[100:115]
    ds_read_b64_tr_b16 v[52:53], v116 offset:36864
    ds_read_b64_tr_b16 v[54:55], v116 offset:37376
    ds_read_b128 v[56:59], v117 offset:576
    v_mfma_f32_32x32x16_bf16 v[100:115], v[76:79], v[80:83], v[100:115]
    ds_read_b64_tr_b16 v[60:61], v116 offset:38912
    ds_read_b64_tr_b16 v[62:63], v116 offset:39424
    ds_read_b128 v[64:67], v117 offset:608
    s_waitcnt lgkmcnt(6)
    v_mfma_f32_32x32x16_bf16 v[100:115], v[84:87], v[88:91], v[100:115]
    ds_read_b64_tr_b16 v[68:69], v116 offset:40960
    ds_read_b64_tr_b16 v[70:71], v116 offset:41472
    ds_read_b128 v[72:75], v117 offset:640
    v_mfma_f32_32x32x16_bf16 v[100:115], v[92:95], v[96:99], v[100:115]
    ds_read_b64_tr_b16 v[76:77], v116 offset:43008
    ds_read_b64_tr_b16 v[78:79], v116 offset:43520
    ds_read_b128 v[80:83], v117 offset:672
    s_waitcnt lgkmcnt(6)
    v_mfma_f32_32x32x16_bf16 v[100:115], v[52:55], v[56:59], v[100:115]
    ds_read_b64_tr_b16 v[84:85], v116 offset:45056
    ds_read_b64_tr_b16 v[86:87], v116 offset:45568
    ds_read_b128 v[88:91], v117 offset:704
    v_mfma_f32_32x32x16_bf16 v[100:115], v[60:63], v[64:67], v[100:115]
    ds_read_b64_tr_b16 v[92:93], v116 offset:47104
    ds_read_b64_tr_b16 v[94:95], v116 offset:47616
    ds_read_b128 v[96:99], v117 offset:736
    buffer_load_dword v5, v125, s[44:47], 0 offen sc1
    s_waitcnt lgkmcnt(6)
    v_mfma_f32_32x32x16_bf16 v[100:115], v[68:71], v[72:75], v[100:115]
    ds_read_b64_tr_b16 v[52:53], v116 offset:49152
    ds_read_b64_tr_b16 v[54:55], v116 offset:49664
    ds_read_b128 v[56:59], v117 offset:768
    v_mfma_f32_32x32x16_bf16 v[100:115], v[76:79], v[80:83], v[100:115]
    ds_read_b64_tr_b16 v[60:61], v116 offset:51200
    ds_read_b64_tr_b16 v[62:63], v116 offset:51712
    ds_read_b128 v[64:67], v117 offset:800
    s_waitcnt lgkmcnt(6)
    v_mfma_f32_32x32x16_bf16 v[100:115], v[84:87], v[88:91], v[100:115]
    ds_read_b64_tr_b16 v[68:69], v116 offset:53248
    ds_read_b64_tr_b16 v[70:71], v116 offset:53760
    ds_read_b128 v[72:75], v117 offset:832
    v_mfma_f32_32x32x16_bf16 v[100:115], v[92:95], v[96:99], v[100:115]
    ds_read_b64_tr_b16 v[76:77], v116 offset:55296
    ds_read_b64_tr_b16 v[78:79], v116 offset:55808
    ds_read_b128 v[80:83], v117 offset:864
    s_waitcnt lgkmcnt(6)
    v_mfma_f32_32x32x16_bf16 v[100:115], v[52:55], v[56:59], v[100:115]
    ds_read_b64_tr_b16 v[84:85], v116 offset:57344
    ds_read_b64_tr_b16 v[86:87], v116 offset:57856
    ds_read_b128 v[88:91], v117 offset:896
    v_mfma_f32_32x32x16_bf16 v[100:115], v[60:63], v[64:67], v[100:115]
    ds_read_b64_tr_b16 v[92:93], v116 offset:59392
    ds_read_b64_tr_b16 v[94:95], v116 offset:59904
    ds_read_b128 v[96:99], v117 offset:928
    s_waitcnt lgkmcnt(6)
    v_mfma_f32_32x32x16_bf16 v[100:115], v[68:71], v[72:75], v[100:115]
    ds_read_b64_tr_b16 v[52:53], v116 offset:61440
    ds_read_b64_tr_b16 v[54:55], v116 offset:61952
    ds_read_b128 v[56:59], v117 offset:960
    v_mfma_f32_32x32x16_bf16 v[100:115], v[76:79], v[80:83], v[100:115]
    ds_read_b64_tr_b16 v[60:61], v116 offset:63488
    ds_read_b64_tr_b16 v[62:63], v116 offset:64000
    ds_read_b128 v[64:67], v117 offset:992
    s_waitcnt lgkmcnt(6)
    v_mfma_f32_32x32x16_bf16 v[100:115], v[84:87], v[88:91], v[100:115]
    s_waitcnt vmcnt(0)
    v_cmp_ne_u32 vcc, s87, v5
    s_cbranch_vccnz L_notyet
    buffer_load_dwordx4 v[28:31], v9, s[44:47], s85 offen sc1
    buffer_load_dwordx4 v[32:35], v24, s[44:47], s85 offen sc1
    buffer_load_dwordx4 v[36:39], v25, s[44:47], s85 offen sc1
    s_add_u32 s85, s85, 4096
    buffer_load_dwordx4 v[40:43], v9, s[44:47], s85 offen sc1
    buffer_load_dwordx4 v[44:47], v24, s[44:47], s85 offen sc1
    buffer_load_dwordx4 v[48:51], v25, s[44:47], s85 offen sc1
    s_add_u32 s85, s85, 4096
    s_and_b32 s85, s85, 0xffff
    s_mov_b32 s55, 1
L_notyet:
    v_mfma_f32_32x32x16_bf16 v[100:115], v[92:95], v[96:99], v[100:115]
    s_waitcnt lgkmcnt(0)
    v_mfma_f32_32x32x16_bf16 v[100:115], v[52:55], v[56:59], v[100:115]
    v_mfma_f32_32x32x16_bf16 v[100:115], v[60:63], v[64:67], v[100:115]
    s_mov_b32 s89, 1
    s_nop 10
    v_mul_f32 v100, v124, v100
    v_mul_f32 v101, v124, v101
    v_mul_f32 v102, v124, v102
    v_mul_f32 v103, v124, v103
    v_mul_f32 v104, v124, v104
    v_mul_f32 v105, v124, v105
    v_mul_f32 v106, v124, v106
    v_mul_f32 v107, v124, v107
    v_cvt_pk_bf16_f32 v100, v100, v101
    v_cvt_pk_bf16_f32 v101, v102, v103
    v_cvt_pk_bf16_f32 v102, v104, v105
    v_cvt_pk_bf16_f32 v103, v106, v107
    ds_write_b128 v119, v[100:103] offset:0
    v_mul_f32 v108, v124, v108
    v_mul_f32 v109, v124, v109
    v_mul_f32 v110, v124, v110
    v_mul_f32 v111, v124, v111
    v_mul_f32 v112, v124, v112
    v_mul_f32 v113, v124, v113
    v_mul_f32 v114, v124, v114
    v_mul_f32 v115, v124, v115
    v_cvt_pk_bf16_f32 v108, v108, v109
    v_cvt_pk_bf16_f32 v109, v110, v111
    v_cvt_pk_bf16_f32 v110, v112, v113
    v_cvt_pk_bf16_f32 v111, v114, v115
    ds_write_b128 v119, v[108:111] offset:2048
    s_cmp_lg_u32 s55, 0
    s_cbranch_scc1 L_got
    s_mov_b32 s84, 48
L_poll_kvl:
    buffer_load_dword v5, v125, s[44:47], 0 offen sc1
    s_waitcnt vmcnt(0)
    v_cmp_ne_u32 vcc, s87, v5
    s_cbranch_vccz L_done_kvl
    s_sleep 1
    s_sub_u32 s84, s84, 1
    s_cmp_lg_u32 s84, 0
    s_cbranch_scc1 L_poll_kvl
    s_and_b32 s85, s85, 0xffff
    s_mov_b32 s84, 400000
L_poll_kv0:
    buffer_load_dword v5, v3, s[44:47], 0 offen sc1
    s_waitcnt vmcnt(0)
    v_cmp_ne_u32 vcc, s7, v5
    s_cbranch_vccz L_done_kv0
    s_sleep 4
    s_sub_u32 s84, s84, 1
    s_cmp_lg_u32 s84, 0
    s_cbranch_scc1 L_poll_kv0
L_done_kv0:
L_done_kvl:
    buffer_load_dwordx4 v[28:31], v9, s[44:47], s85 offen sc1
    buffer_load_dwordx4 v[32:35], v24, s[44:47], s85 offen sc1
    buffer_load_dwordx4 v[36:39], v25, s[44:47], s85 offen sc1
    s_add_u32 s85, s85, 4096
    buffer_load_dwordx4 v[40:43], v9, s[44:47], s85 offen sc1
    buffer_load_dwordx4 v[44:47], v24, s[44:47], s85 offen sc1
    buffer_load_dwordx4 v[48:51], v25, s[44:47], s85 offen sc1
    s_add_u32 s85, s85, 4096
    s_and_b32 s85, s85, 0xffff
L_got:
    s_waitcnt lgkmcnt(0)
    s_barrier
    ds_read_b128 v[96:99], v120 offset:0
    ds_read_b128 v[100:103], v120 offset:1024
    ds_read_b128 v[104:107], v121 offset:0
    ds_read_b128 v[108:111], v121 offset:1024
    ds_read_b128 v[112:115], v122 offset:0
    ds_read_b128 v[124:127], v123 offset:1024
    ds_read_b128 v[116:119], v122 offset:1024
    ds_read_b128 v[120:123], v123 offset:0
    s_waitcnt vmcnt(5) lgkmcnt(7)
    v_mfma_f32_32x32x16_bf16 v[64:79], v[28:31], v[96:99], 0
    s_mov_b64 exec, s[36:37]
    buffer_load_dword v5, v3, s[44:47], 0 offen sc1
    s_mov_b64 exec, -1
    s_nop 5
    s_waitcnt lgkmcnt(0)
    s_nop 0
    s_waitcnt vmcnt(4)
    v_exp_f32 v64, v64
    v_exp_f32 v65, v65
    v_exp_f32 v66, v66
    v_exp_f32 v67, v67
    v_exp_f32 v68, v68
    v_exp_f32 v69, v69
    v_mfma_f32_32x32x16_bf16 v[80:95], v[28:31], v[100:103], 0
    v_exp_f32 v70, v70
    v_exp_f32 v71, v71
    v_exp_f32 v72, v72
    v_exp_f32 v73, v73
    v_exp_f32 v74, v74
    v_exp_f32 v75, v75
    v_exp_f32 v76, v76
    v_exp_f32 v77, v77
    v_exp_f32 v78, v78
    v_exp_f32 v79, v79
    v_smfmac_f32_32x32x32_bf16 v[128:143], v[32:35], v[64:71], v6
    v_exp_f32 v80, v80
    v_exp_f32 v81, v81
    v_exp_f32 v82, v82
    v_smfmac_f32_32x32x32_bf16 v[128:143], v[36:39], v[72:79], v6
    v_exp_f32 v83, v83
    v_exp_f32 v84, v84
    v_exp_f32 v85, v85
    v_mfma_f32_32x32x16_bf16 v[64:79], v[28:31], v[104:107], 0
    v_exp_f32 v86, v86
    v_exp_f32 v87, v87
    v_exp_f32 v88, v88
    v_exp_f32 v89, v89
    v_exp_f32 v90, v90
    v_exp_f32 v91, v91
    v_exp_f32 v92, v92
    v_exp_f32 v93, v93
    v_exp_f32 v94, v94
    v_exp_f32 v95, v95
    v_smfmac_f32_32x32x32_bf16 v[144:159], v[32:35], v[80:87], v6
    s_waitcnt vmcnt(0)
    v_cmp_ne_u32 vcc, s7, v5
    v_exp_f32 v64, v64
    v_exp_f32 v65, v65
    v_exp_f32 v66, v66
    v_smfmac_f32_32x32x32_bf16 v[144:159], v[36:39], v[88:95], v6
    s_and_b64 vcc, vcc, s[36:37]
    s_cbranch_scc1 L_kva
L_kva_ok:
    v_exp_f32 v67, v67
    v_exp_f32 v68, v68
    v_exp_f32 v69, v69
    v_mfma_f32_32x32x16_bf16 v[80:95], v[28:31], v[108:111], 0
    buffer_load_dwordx4 v[52:55], v9, s[44:47], s22 offen sc1
    buffer_load_dwordx4 v[56:59], v24, s[44:47], s22 offen sc1
    buffer_load_dwordx4 v[60:63], v25, s[44:47], s22 offen sc1
    v_exp_f32 v70, v70
    v_exp_f32 v71, v71
    v_exp_f32 v72, v72
    v_exp_f32 v73, v73
    v_exp_f32 v74, v74
    v_exp_f32 v75, v75
    v_exp_f32 v76, v76
    v_exp_f32 v77, v77
    v_exp_f32 v78, v78
    v_exp_f32 v79, v79
    v_smfmac_f32_32x32x32_bf16 v[160:175], v[32:35], v[64:71], v6
    s_barrier
    v_exp_f32 v80, v80
    v_exp_f32 v81, v81
    v_exp_f32 v82, v82
    v_smfmac_f32_32x32x32_bf16 v[160:175], v[36:39], v[72:79], v6
    v_exp_f32 v83, v83
    v_exp_f32 v84, v84
    v_exp_f32 v85, v85
    v_mfma_f32_32x32x16_bf16 v[64:79], v[28:31], v[112:115], 0
    v_exp_f32 v86, v86
    v_exp_f32 v87, v87
    v_exp_f32 v88, v88
    v_exp_f32 v89, v89
    v_exp_f32 v90, v90
    v_exp_f32 v91, v91
    v_exp_f32 v92, v92
    v_exp_f32 v93, v93
    v_exp_f32 v94, v94
    v_exp_f32 v95, v95
    v_smfmac_f32_32x32x32_bf16 v[176:191], v[32:35], v[80:87], v6
    v_exp_f32 v64, v64
    v_exp_f32 v65, v65
    v_exp_f32 v66, v66
    v_smfmac_f32_32x32x32_bf16 v[176:191], v[36:39], v[88:95], v6
    v_exp_f32 v67, v67
    v_exp_f32 v68, v68
    v_exp_f32 v69, v69
    v_mfma_f32_32x32x16_bf16 v[80:95], v[28:31], v[116:119], 0
    v_exp_f32 v70, v70
    v_exp_f32 v71, v71
    v_exp_f32 v72, v72
    v_exp_f32 v73, v73
    v_exp_f32 v74, v74
    v_exp_f32 v75, v75
    v_exp_f32 v76, v76
    v_exp_f32 v77, v77
    v_exp_f32 v78, v78
    v_exp_f32 v79, v79
    v_smfmac_f32_32x32x32_bf16 v[192:207], v[32:35], v[64:71], v6
    v_exp_f32 v80, v80
    v_exp_f32 v81, v81
    v_exp_f32 v82, v82
    v_smfmac_f32_32x32x32_bf16 v[192:207], v[36:39], v[72:79], v6
    v_exp_f32 v83, v83
    v_exp_f32 v84, v84
    v_exp_f32 v85, v85
    v_mfma_f32_32x32x16_bf16 v[64:79], v[28:31], v[120:123], 0
    v_exp_f32 v86, v86
    v_exp_f32 v87, v87
    v_exp_f32 v88, v88
    v_exp_f32 v89, v89
    v_exp_f32 v90, v90
    v_exp_f32 v91, v91
    v_exp_f32 v92, v92
    v_exp_f32 v93, v93
    v_exp_f32 v94, v94
    v_exp_f32 v95, v95
    v_smfmac_f32_32x32x32_bf16 v[208:223], v[32:35], v[80:87], v6
    v_exp_f32 v64, v64
    v_exp_f32 v65, v65
    v_exp_f32 v66, v66
    v_smfmac_f32_32x32x32_bf16 v[208:223], v[36:39], v[88:95], v6
    v_exp_f32 v67, v67
    v_exp_f32 v68, v68
    v_exp_f32 v69, v69
    v_mfma_f32_32x32x16_bf16 v[80:95], v[28:31], v[124:127], 0
    buffer_load_dword v5, v3, s[44:47], 0 offen sc1
    v_exp_f32 v70, v70
    v_exp_f32 v71, v71
    v_exp_f32 v72, v72
    v_exp_f32 v73, v73
    v_exp_f32 v74, v74
    v_exp_f32 v75, v75
    v_exp_f32 v76, v76
    v_exp_f32 v77, v77
    v_exp_f32 v78, v78
    v_exp_f32 v79, v79
    v_smfmac_f32_32x32x32_bf16 v[224:239], v[32:35], v[64:71], v6
    v_exp_f32 v80, v80
    v_exp_f32 v81, v81
    v_exp_f32 v82, v82
    v_smfmac_f32_32x32x32_bf16 v[224:239], v[36:39], v[72:79], v6
    s_waitcnt vmcnt(4)
    v_exp_f32 v83, v83
    v_exp_f32 v84, v84
    v_exp_f32 v85, v85
    v_mfma_f32_32x32x16_bf16 v[64:79], v[40:43], v[96:99], 0
    v_exp_f32 v86, v86
    v_exp_f32 v87, v87
    v_exp_f32 v88, v88
    v_exp_f32 v89, v89
    v_exp_f32 v90, v90
    v_exp_f32 v91, v91
    v_exp_f32 v92, v92
    v_exp_f32 v93, v93
    v_exp_f32 v94, v94
    v_exp_f32 v95, v95
    v_smfmac_f32_32x32x32_bf16 v[240:255], v[32:35], v[80:87], v6
    v_exp_f32 v64, v64
    v_exp_f32 v65, v65
    v_exp_f32 v66, v66
    v_smfmac_f32_32x32x32_bf16 v[240:255], v[36:39], v[88:95], v6
    v_exp_f32 v67, v67
    v_exp_f32 v68, v68
    v_exp_f32 v69, v69
    v_mfma_f32_32x32x16_bf16 v[80:95], v[40:43], v[100:103], 0
    buffer_load_dwordx4 v[28:31], v9, s[44:47], s23 offen sc1
    buffer_load_dwordx4 v[32:35], v24, s[44:47], s23 offen sc1
    buffer_load_dwordx4 v[36:39], v25, s[44:47], s23 offen sc1
    v_exp_f32 v70, v70
    v_exp_f32 v71, v71
    v_exp_f32 v72, v72
    v_exp_f32 v73, v73
    v_exp_f32 v74, v74
    v_exp_f32 v75, v75
    v_exp_f32 v76, v76
    v_exp_f32 v77, v77
    v_exp_f32 v78, v78
    v_exp_f32 v79, v79
    v_smfmac_f32_32x32x32_bf16 v[128:143], v[44:47], v[64:71], v6
    v_exp_f32 v80, v80
    v_exp_f32 v81, v81
    v_exp_f32 v82, v82
    v_smfmac_f32_32x32x32_bf16 v[128:143], v[48:51], v[72:79], v6
    v_exp_f32 v83, v83
    v_exp_f32 v84, v84
    v_exp_f32 v85, v85
    v_mfma_f32_32x32x16_bf16 v[64:79], v[40:43], v[104:107], 0
    v_exp_f32 v86, v86
    v_exp_f32 v87, v87
    v_exp_f32 v88, v88
    v_exp_f32 v89, v89
    v_exp_f32 v90, v90
    v_exp_f32 v91, v91
    v_exp_f32 v92, v92
    v_exp_f32 v93, v93
    v_exp_f32 v94, v94
    v_exp_f32 v95, v95
    v_smfmac_f32_32x32x32_bf16 v[144:159], v[44:47], v[80:87], v6
    v_exp_f32 v64, v64
    v_exp_f32 v65, v65
    v_exp_f32 v66, v66
    v_smfmac_f32_32x32x32_bf16 v[144:159], v[48:51], v[88:95], v6
    v_exp_f32 v67, v67
    v_exp_f32 v68, v68
    v_exp_f32 v69, v69
    v_mfma_f32_32x32x16_bf16 v[80:95], v[40:43], v[108:111], 0
    v_exp_f32 v70, v70
    v_exp_f32 v71, v71
    v_exp_f32 v72, v72
    v_exp_f32 v73, v73
    v_exp_f32 v74, v74
    v_exp_f32 v75, v75
    v_exp_f32 v76, v76
    v_exp_f32 v77, v77
    v_exp_f32 v78, v78
    v_exp_f32 v79, v79
    v_smfmac_f32_32x32x32_bf16 v[160:175], v[44:47], v[64:71], v6
    v_exp_f32 v80, v80
    v_exp_f32 v81, v81
    v_exp_f32 v82, v82
    v_smfmac_f32_32x32x32_bf16 v[160:175], v[48:51], v[72:79], v6
    v_exp_f32 v83, v83
    v_exp_f32 v84, v84
    v_exp_f32 v85, v85
    v_mfma_f32_32x32x16_bf16 v[64:79], v[40:43], v[112:115], 0
    v_exp_f32 v86, v86
    v_exp_f32 v87, v87
    v_exp_f32 v88, v88
    v_exp_f32 v89, v89
    v_exp_f32 v90, v90
    v_exp_f32 v91, v91
    v_exp_f32 v92, v92
    v_exp_f32 v93, v93
    v_exp_f32 v94, v94
    v_exp_f32 v95, v95
    v_smfmac_f32_32x32x32_bf16 v[176:191], v[44:47], v[80:87], v6
    v_exp_f32 v64, v64
    v_exp_f32 v65, v65
    v_exp_f32 v66, v66
    v_smfmac_f32_32x32x32_bf16 v[176:191], v[48:51], v[88:95], v6
    v_exp_f32 v67, v67
    v_exp_f32 v68, v68
    v_exp_f32 v69, v69
    v_mfma_f32_32x32x16_bf16 v[80:95], v[40:43], v[116:119], 0
    v_exp_f32 v70, v70
    v_exp_f32 v71, v71
    v_exp_f32 v72, v72
    v_exp_f32 v73, v73
    v_exp_f32 v74, v74
    v_exp_f32 v75, v75
    v_exp_f32 v76, v76
    v_exp_f32 v77, v77
    v_exp_f32 v78, v78
    v_exp_f32 v79, v79
    v_smfmac_f32_32x32x32_bf16 v[192:207], v[44:47], v[64:71], v6
    v_exp_f32 v80, v80
    v_exp_f32 v81, v81
    v_exp_f32 v82, v82
    v_smfmac_f32_32x32x32_bf16 v[192:207], v[48:51], v[72:79], v6
    v_exp_f32 v83, v83
    v_exp_f32 v84, v84
    v_exp_f32 v85, v85
    v_mfma_f32_32x32x16_bf16 v[64:79], v[40:43], v[120:123], 0
    v_exp_f32 v86, v86
    v_exp_f32 v87, v87
    v_exp_f32 v88, v88
    v_exp_f32 v89, v89
    v_exp_f32 v90, v90
    v_exp_f32 v91, v91
    v_exp_f32 v92, v92
    v_exp_f32 v93, v93
    v_exp_f32 v94, v94
    v_exp_f32 v95, v95
    v_smfmac_f32_32x32x32_bf16 v[208:223], v[44:47], v[80:87], v6
    v_exp_f32 v64, v64
    v_exp_f32 v65, v65
    v_exp_f32 v66, v66
    v_smfmac_f32_32x32x32_bf16 v[208:223], v[48:51], v[88:95], v6
    v_exp_f32 v67, v67
    v_exp_f32 v68, v68
    v_exp_f32 v69, v69
    v_mfma_f32_32x32x16_bf16 v[80:95], v[40:43], v[124:127], 0
    v_exp_f32 v70, v70
    v_exp_f32 v71, v71
    v_exp_f32 v72, v72
    v_exp_f32 v73, v73
    v_exp_f32 v74, v74
    v_exp_f32 v75, v75
    v_exp_f32 v76, v76
    v_exp_f32 v77, v77
    v_exp_f32 v78, v78
    v_exp_f32 v79, v79
    v_smfmac_f32_32x32x32_bf16 v[224:239], v[44:47], v[64:71], v6
    v_exp_f32 v80, v80
    v_exp_f32 v81, v81
    v_exp_f32 v82, v82
    v_smfmac_f32_32x32x32_bf16 v[224:239], v[48:51], v[72:79], v6
    s_waitcnt vmcnt(4)
    v_exp_f32 v83, v83
    v_exp_f32 v84, v84
    v_exp_f32 v85, v85
    v_mfma_f32_32x32x16_bf16 v[64:79], v[52:55], v[96:99], 0
    v_exp_f32 v86, v86
    v_exp_f32 v87, v87
    v_exp_f32 v88, v88
    v_exp_f32 v89, v89
    v_exp_f32 v90, v90
    v_exp_f32 v91, v91
    v_exp_f32 v92, v92
    v_exp_f32 v93, v93
    v_exp_f32 v94, v94
    v_exp_f32 v95, v95
    v_smfmac_f32_32x32x32_bf16 v[240:255], v[44:47], v[80:87], v6
    v_exp_f32 v64, v64
    v_exp_f32 v65, v65
    v_exp_f32 v66, v66
    v_smfmac_f32_32x32x32_bf16 v[240:255], v[48:51], v[88:95], v6
    v_exp_f32 v67, v67
    v_exp_f32 v68, v68
    v_exp_f32 v69, v69
    v_mfma_f32_32x32x16_bf16 v[80:95], v[52:55], v[100:103], 0
    v_exp_f32 v70, v70
    v_exp_f32 v71, v71
    v_exp_f32 v72, v72
    v_exp_f32 v73, v73
    v_exp_f32 v74, v74
    v_exp_f32 v75, v75
    v_exp_f32 v76, v76
    v_exp_f32 v77, v77
    v_exp_f32 v78, v78
    v_exp_f32 v79, v79
    v_smfmac_f32_32x32x32_bf16 v[128:143], v[56:59], v[64:71], v6
    v_exp_f32 v80, v80
    v_exp_f32 v81, v81
    v_exp_f32 v82, v82
    v_smfmac_f32_32x32x32_bf16 v[128:143], v[60:63], v[72:79], v6
    v_exp_f32 v83, v83
    v_exp_f32 v84, v84
    v_exp_f32 v85, v85
    v_mfma_f32_32x32x16_bf16 v[64:79], v[52:55], v[104:107], 0
    v_exp_f32 v86, v86
    v_exp_f32 v87, v87
    v_exp_f32 v88, v88
    v_exp_f32 v89, v89
    v_exp_f32 v90, v90
    v_exp_f32 v91, v91
    v_exp_f32 v92, v92
    v_exp_f32 v93, v93
    v_exp_f32 v94, v94
    v_exp_f32 v95, v95
    v_smfmac_f32_32x32x32_bf16 v[144:159], v[56:59], v[80:87], v6
    s_waitcnt vmcnt(3)
    v_cmp_ne_u32 vcc, s7, v5
    v_exp_f32 v64, v64
    v_exp_f32 v65, v65
    v_exp_f32 v66, v66
    v_smfmac_f32_32x32x32_bf16 v[144:159], v[60:63], v[88:95], v6
    s_cbranch_vccnz L_kvb
L_kvb_ok:
    v_exp_f32 v67, v67
    v_exp_f32 v68, v68
    v_exp_f32 v69, v69
    v_mfma_f32_32x32x16_bf16 v[80:95], v[52:55], v[108:111], 0
    buffer_load_dwordx4 v[40:43], v9, s[44:47], s24 offen sc1
    buffer_load_dwordx4 v[44:47], v24, s[44:47], s24 offen sc1
    buffer_load_dwordx4 v[48:51], v25, s[44:47], s24 offen sc1
    v_exp_f32 v70, v70
    v_exp_f32 v71, v71
    v_exp_f32 v72, v72
    v_exp_f32 v73, v73
    v_exp_f32 v74, v74
    v_exp_f32 v75, v75
    v_exp_f32 v76, v76
    v_exp_f32 v77, v77
    v_exp_f32 v78, v78
    v_exp_f32 v79, v79
    v_smfmac_f32_32x32x32_bf16 v[160:175], v[56:59], v[64:71], v6
    v_exp_f32 v80, v80
    v_exp_f32 v81, v81
    v_exp_f32 v82, v82
    v_smfmac_f32_32x32x32_bf16 v[160:175], v[60:63], v[72:79], v6
    v_exp_f32 v83, v83
    v_exp_f32 v84, v84
    v_exp_f32 v85, v85
    v_mfma_f32_32x32x16_bf16 v[64:79], v[52:55], v[112:115], 0
    v_exp_f32 v86, v86
    v_exp_f32 v87, v87
    v_exp_f32 v88, v88
    v_exp_f32 v89, v89
    v_exp_f32 v90, v90
    v_exp_f32 v91, v91
    v_exp_f32 v92, v92
    v_exp_f32 v93, v93
    v_exp_f32 v94, v94
    v_exp_f32 v95, v95
    v_smfmac_f32_32x32x32_bf16 v[176:191], v[56:59], v[80:87], v6
    v_exp_f32 v64, v64
    v_exp_f32 v65, v65
    v_exp_f32 v66, v66
    v_smfmac_f32_32x32x32_bf16 v[176:191], v[60:63], v[88:95], v6
    v_exp_f32 v67, v67
    v_exp_f32 v68, v68
    v_exp_f32 v69, v69
    v_mfma_f32_32x32x16_bf16 v[80:95], v[52:55], v[116:119], 0
    v_exp_f32 v70, v70
    v_exp_f32 v71, v71
    v_exp_f32 v72, v72
    v_exp_f32 v73, v73
    v_exp_f32 v74, v74
    v_exp_f32 v75, v75
    v_exp_f32 v76, v76
    v_exp_f32 v77, v77
    v_exp_f32 v78, v78
    v_exp_f32 v79, v79
    v_smfmac_f32_32x32x32_bf16 v[192:207], v[56:59], v[64:71], v6
    v_exp_f32 v80, v80
    v_exp_f32 v81, v81
    v_exp_f32 v82, v82
    v_smfmac_f32_32x32x32_bf16 v[192:207], v[60:63], v[72:79], v6
    v_exp_f32 v83, v83
    v_exp_f32 v84, v84
    v_exp_f32 v85, v85
    v_mfma_f32_32x32x16_bf16 v[64:79], v[52:55], v[120:123], 0
    v_exp_f32 v86, v86
    v_exp_f32 v87, v87
    v_exp_f32 v88, v88
    v_exp_f32 v89, v89
    v_exp_f32 v90, v90
    v_exp_f32 v91, v91
    v_exp_f32 v92, v92
    v_exp_f32 v93, v93
    v_exp_f32 v94, v94
    v_exp_f32 v95, v95
    v_smfmac_f32_32x32x32_bf16 v[208:223], v[56:59], v[80:87], v6
    v_exp_f32 v64, v64
    v_exp_f32 v65, v65
    v_exp_f32 v66, v66
    v_smfmac_f32_32x32x32_bf16 v[208:223], v[60:63], v[88:95], v6
    v_exp_f32 v67, v67
    v_exp_f32 v68, v68
    v_exp_f32 v69, v69
    v_mfma_f32_32x32x16_bf16 v[80:95], v[52:55], v[124:127], 0
    v_exp_f32 v70, v70
    v_exp_f32 v71, v71
    v_exp_f32 v72, v72
    v_exp_f32 v73, v73
    v_exp_f32 v74, v74
    v_exp_f32 v75, v75
    v_exp_f32 v76, v76
    v_exp_f32 v77, v77
    v_exp_f32 v78, v78
    v_exp_f32 v79, v79
    v_smfmac_f32_32x32x32_bf16 v[224:239], v[56:59], v[64:71], v6
    v_exp_f32 v80, v80
    v_exp_f32 v81, v81
    v_exp_f32 v82, v82
    v_smfmac_f32_32x32x32_bf16 v[224:239], v[60:63], v[72:79], v6
    s_waitcnt vmcnt(3)
    v_exp_f32 v83, v83
    v_exp_f32 v84, v84
    v_exp_f32 v85, v85
    v_mfma_f32_32x32x16_bf16 v[64:79], v[28:31], v[96:99], 0
    v_exp_f32 v86, v86
    v_exp_f32 v87, v87
    v_exp_f32 v88, v88
    v_exp_f32 v89, v89
    v_exp_f32 v90, v90
    v_exp_f32 v91, v91
    v_exp_f32 v92, v92
    v_exp_f32 v93, v93
    v_exp_f32 v94, v94
    v_exp_f32 v95, v95
    v_smfmac_f32_32x32x32_bf16 v[240:255], v[56:59], v[80:87], v6
    v_exp_f32 v64, v64
    v_exp_f32 v65, v65
    v_exp_f32 v66, v66
    v_smfmac_f32_32x32x32_bf16 v[240:255], v[60:63], v[88:95], v6
    v_exp_f32 v67, v67
    v_exp_f32 v68, v68
    v_exp_f32 v69, v69
    v_mfma_f32_32x32x16_bf16 v[80:95], v[28:31], v[100:103], 0
    buffer_load_dwordx4 v[52:55], v9, s[44:47], s25 offen sc1
    buffer_load_dwordx4 v[56:59], v24, s[44:47], s25 offen sc1
    buffer_load_dwordx4 v[60:63], v25, s[44:47], s25 offen sc1
    v_exp_f32 v70, v70
    v_exp_f32 v71, v71
    v_exp_f32 v72, v72
    v_exp_f32 v73, v73
    v_exp_f32 v74, v74
    v_exp_f32 v75, v75
    v_exp_f32 v76, v76
    v_exp_f32 v77, v77
    v_exp_f32 v78, v78
    v_exp_f32 v79, v79
    v_smfmac_f32_32x32x32_bf16 v[128:143], v[32:35], v[64:71], v6
    v_exp_f32 v80, v80
    v_exp_f32 v81, v81
    v_exp_f32 v82, v82
    v_smfmac_f32_32x32x32_bf16 v[128:143], v[36:39], v[72:79], v6
    v_exp_f32 v83, v83
    v_exp_f32 v84, v84
    v_exp_f32 v85, v85
    v_mfma_f32_32x32x16_bf16 v[64:79], v[28:31], v[104:107], 0
    v_exp_f32 v86, v86
    v_exp_f32 v87, v87
    v_exp_f32 v88, v88
    v_exp_f32 v89, v89
    v_exp_f32 v90, v90
    v_exp_f32 v91, v91
    v_exp_f32 v92, v92
    v_exp_f32 v93, v93
    v_exp_f32 v94, v94
    v_exp_f32 v95, v95
    v_smfmac_f32_32x32x32_bf16 v[144:159], v[32:35], v[80:87], v6
    v_exp_f32 v64, v64
    v_exp_f32 v65, v65
    v_exp_f32 v66, v66
    v_smfmac_f32_32x32x32_bf16 v[144:159], v[36:39], v[88:95], v6
    v_exp_f32 v67, v67
    v_exp_f32 v68, v68
    v_exp_f32 v69, v69
    v_mfma_f32_32x32x16_bf16 v[80:95], v[28:31], v[108:111], 0
    v_exp_f32 v70, v70
    v_exp_f32 v71, v71
    v_exp_f32 v72, v72
    v_exp_f32 v73, v73
    v_exp_f32 v74, v74
    v_exp_f32 v75, v75
    v_exp_f32 v76, v76
    v_exp_f32 v77, v77
    v_exp_f32 v78, v78
    v_exp_f32 v79, v79
    v_smfmac_f32_32x32x32_bf16 v[160:175], v[32:35], v[64:71], v6
    v_exp_f32 v80, v80
    v_exp_f32 v81, v81
    v_exp_f32 v82, v82
    v_smfmac_f32_32x32x32_bf16 v[160:175], v[36:39], v[72:79], v6
    v_exp_f32 v83, v83
    v_exp_f32 v84, v84
    v_exp_f32 v85, v85
    v_mfma_f32_32x32x16_bf16 v[64:79], v[28:31], v[112:115], 0
    v_exp_f32 v86, v86
    v_exp_f32 v87, v87
    v_exp_f32 v88, v88
    v_exp_f32 v89, v89
    v_exp_f32 v90, v90
    v_exp_f32 v91, v91
    v_exp_f32 v92, v92
    v_exp_f32 v93, v93
    v_exp_f32 v94, v94
    v_exp_f32 v95, v95
    v_smfmac_f32_32x32x32_bf16 v[176:191], v[32:35], v[80:87], v6
    v_exp_f32 v64, v64
    v_exp_f32 v65, v65
    v_exp_f32 v66, v66
    v_smfmac_f32_32x32x32_bf16 v[176:191], v[36:39], v[88:95], v6
    v_exp_f32 v67, v67
    v_exp_f32 v68, v68
    v_exp_f32 v69, v69
    v_mfma_f32_32x32x16_bf16 v[80:95], v[28:31], v[116:119], 0
    v_exp_f32 v70, v70
    v_exp_f32 v71, v71
    v_exp_f32 v72, v72
    v_exp_f32 v73, v73
    v_exp_f32 v74, v74
    v_exp_f32 v75, v75
    v_exp_f32 v76, v76
    v_exp_f32 v77, v77
    v_exp_f32 v78, v78
    v_exp_f32 v79, v79
    v_smfmac_f32_32x32x32_bf16 v[192:207], v[32:35], v[64:71], v6
    v_exp_f32 v80, v80
    v_exp_f32 v81, v81
    v_exp_f32 v82, v82
    v_smfmac_f32_32x32x32_bf16 v[192:207], v[36:39], v[72:79], v6
    v_exp_f32 v83, v83
    v_exp_f32 v84, v84
    v_exp_f32 v85, v85
    v_mfma_f32_32x32x16_bf16 v[64:79], v[28:31], v[120:123], 0
    v_exp_f32 v86, v86
    v_exp_f32 v87, v87
    v_exp_f32 v88, v88
    v_exp_f32 v89, v89
    v_exp_f32 v90, v90
    v_exp_f32 v91, v91
    v_exp_f32 v92, v92
    v_exp_f32 v93, v93
    v_exp_f32 v94, v94
    v_exp_f32 v95, v95
    v_smfmac_f32_32x32x32_bf16 v[208:223], v[32:35], v[80:87], v6
    v_exp_f32 v64, v64
    v_exp_f32 v65, v65
    v_exp_f32 v66, v66
    v_smfmac_f32_32x32x32_bf16 v[208:223], v[36:39], v[88:95], v6
    v_exp_f32 v67, v67
    v_exp_f32 v68, v68
    v_exp_f32 v69, v69
    v_mfma_f32_32x32x16_bf16 v[80:95], v[28:31], v[124:127], 0
    v_exp_f32 v70, v70
    v_exp_f32 v71, v71
    v_exp_f32 v72, v72
    v_exp_f32 v73, v73
    v_exp_f32 v74, v74
    v_exp_f32 v75, v75
    v_exp_f32 v76, v76
    v_exp_f32 v77, v77
    v_exp_f32 v78, v78
    v_exp_f32 v79, v79
    v_smfmac_f32_32x32x32_bf16 v[224:239], v[32:35], v[64:71], v6
    v_exp_f32 v80, v80
    v_exp_f32 v81, v81
    v_exp_f32 v82, v82
    v_smfmac_f32_32x32x32_bf16 v[224:239], v[36:39], v[72:79], v6
    s_waitcnt vmcnt(3)
    v_exp_f32 v83, v83
    v_exp_f32 v84, v84
    v_exp_f32 v85, v85
    v_mfma_f32_32x32x16_bf16 v[64:79], v[40:43], v[96:99], 0
    v_exp_f32 v86, v86
    v_exp_f32 v87, v87
    v_exp_f32 v88, v88
    v_exp_f32 v89, v89
    v_exp_f32 v90, v90
    v_exp_f32 v91, v91
    v_exp_f32 v92, v92
    v_exp_f32 v93, v93
    v_exp_f32 v94, v94
    v_exp_f32 v95, v95
    v_smfmac_f32_32x32x32_bf16 v[240:255], v[32:35], v[80:87], v6
    v_exp_f32 v64, v64
    v_exp_f32 v65, v65
    v_exp_f32 v66, v66
    v_smfmac_f32_32x32x32_bf16 v[240:255], v[36:39], v[88:95], v6
    v_exp_f32 v67, v67
    v_exp_f32 v68, v68
    v_exp_f32 v69, v69
    v_mfma_f32_32x32x16_bf16 v[80:95], v[40:43], v[100:103], 0
    buffer_load_dwordx4 v[28:31], v9, s[44:47], s26 offen sc1
    buffer_load_dwordx4 v[32:35], v24, s[44:47], s26 offen sc1
    buffer_load_dwordx4 v[36:39], v25, s[44:47], s26 offen sc1
    v_exp_f32 v70, v70
    v_exp_f32 v71, v71
    v_exp_f32 v72, v72
    v_exp_f32 v73, v73
    v_exp_f32 v74, v74
    v_exp_f32 v75, v75
    v_exp_f32 v76, v76
    v_exp_f32 v77, v77
    v_exp_f32 v78, v78
    v_exp_f32 v79, v79
    v_smfmac_f32_32x32x32_bf16 v[128:143], v[44:47], v[64:71], v6
    v_exp_f32 v80, v80
    v_exp_f32 v81, v81
    v_exp_f32 v82, v82
    v_smfmac_f32_32x32x32_bf16 v[128:143], v[48:51], v[72:79], v6
    v_exp_f32 v83, v83
    v_exp_f32 v84, v84
    v_exp_f32 v85, v85
    v_mfma_f32_32x32x16_bf16 v[64:79], v[40:43], v[104:107], 0
    v_exp_f32 v86, v86
    v_exp_f32 v87, v87
    v_exp_f32 v88, v88
    v_exp_f32 v89, v89
    v_exp_f32 v90, v90
    v_exp_f32 v91, v91
    v_exp_f32 v92, v92
    v_exp_f32 v93, v93
    v_exp_f32 v94, v94
    v_exp_f32 v95, v95
    v_smfmac_f32_32x32x32_bf16 v[144:159], v[44:47], v[80:87], v6
    v_exp_f32 v64, v64
    v_exp_f32 v65, v65
    v_exp_f32 v66, v66
    v_smfmac_f32_32x32x32_bf16 v[144:159], v[48:51], v[88:95], v6
    v_exp_f32 v67, v67
    v_exp_f32 v68, v68
    v_exp_f32 v69, v69
    v_mfma_f32_32x32x16_bf16 v[80:95], v[40:43], v[108:111], 0
    v_exp_f32 v70, v70
    v_exp_f32 v71, v71
    v_exp_f32 v72, v72
    v_exp_f32 v73, v73
    v_exp_f32 v74, v74
    v_exp_f32 v75, v75
    v_exp_f32 v76, v76
    v_exp_f32 v77, v77
    v_exp_f32 v78, v78
    v_exp_f32 v79, v79
    v_smfmac_f32_32x32x32_bf16 v[160:175], v[44:47], v[64:71], v6
    v_exp_f32 v80, v80
    v_exp_f32 v81, v81
    v_exp_f32 v82, v82
    v_smfmac_f32_32x32x32_bf16 v[160:175], v[48:51], v[72:79], v6
    v_exp_f32 v83, v83
    v_exp_f32 v84, v84
    v_exp_f32 v85, v85
    v_mfma_f32_32x32x16_bf16 v[64:79], v[40:43], v[112:115], 0
    v_exp_f32 v86, v86
    v_exp_f32 v87, v87
    v_exp_f32 v88, v88
    v_exp_f32 v89, v89
    v_exp_f32 v90, v90
    v_exp_f32 v91, v91
    v_exp_f32 v92, v92
    v_exp_f32 v93, v93
    v_exp_f32 v94, v94
    v_exp_f32 v95, v95
    v_smfmac_f32_32x32x32_bf16 v[176:191], v[44:47], v[80:87], v6
    v_exp_f32 v64, v64
    v_exp_f32 v65, v65
    v_exp_f32 v66, v66
    v_smfmac_f32_32x32x32_bf16 v[176:191], v[48:51], v[88:95], v6
    v_exp_f32 v67, v67
    v_exp_f32 v68, v68
    v_exp_f32 v69, v69
    v_mfma_f32_32x32x16_bf16 v[80:95], v[40:43], v[116:119], 0
    v_exp_f32 v70, v70
    v_exp_f32 v71, v71
    v_exp_f32 v72, v72
    v_exp_f32 v73, v73
    v_exp_f32 v74, v74
    v_exp_f32 v75, v75
    v_exp_f32 v76, v76
    v_exp_f32 v77, v77
    v_exp_f32 v78, v78
    v_exp_f32 v79, v79
    v_smfmac_f32_32x32x32_bf16 v[192:207], v[44:47], v[64:71], v6
    v_exp_f32 v80, v80
    v_exp_f32 v81, v81
    v_exp_f32 v82, v82
    v_smfmac_f32_32x32x32_bf16 v[192:207], v[48:51], v[72:79], v6
    v_exp_f32 v83, v83
    v_exp_f32 v84, v84
    v_exp_f32 v85, v85
    v_mfma_f32_32x32x16_bf16 v[64:79], v[40:43], v[120:123], 0
    v_exp_f32 v86, v86
    v_exp_f32 v87, v87
    v_exp_f32 v88, v88
    v_exp_f32 v89, v89
    v_exp_f32 v90, v90
    v_exp_f32 v91, v91
    v_exp_f32 v92, v92
    v_exp_f32 v93, v93
    v_exp_f32 v94, v94
    v_exp_f32 v95, v95
    v_smfmac_f32_32x32x32_bf16 v[208:223], v[44:47], v[80:87], v6
    v_exp_f32 v64, v64
    v_exp_f32 v65, v65
    v_exp_f32 v66, v66
    v_smfmac_f32_32x32x32_bf16 v[208:223], v[48:51], v[88:95], v6
    v_exp_f32 v67, v67
    v_exp_f32 v68, v68
    v_exp_f32 v69, v69
    v_mfma_f32_32x32x16_bf16 v[80:95], v[40:43], v[124:127], 0
    v_exp_f32 v70, v70
    v_exp_f32 v71, v71
    v_exp_f32 v72, v72
    v_exp_f32 v73, v73
    v_exp_f32 v74, v74
    v_exp_f32 v75, v75
    v_exp_f32 v76, v76
    v_exp_f32 v77, v77
    v_exp_f32 v78, v78
    v_exp_f32 v79, v79
    v_smfmac_f32_32x32x32_bf16 v[224:239], v[44:47], v[64:71], v6
    v_exp_f32 v80, v80
    v_exp_f32 v81, v81
    v_exp_f32 v82, v82
    v_smfmac_f32_32x32x32_bf16 v[224:239], v[48:51], v[72:79], v6
    s_waitcnt vmcnt(3)
    v_exp_f32 v83, v83
    v_exp_f32 v84, v84
    v_exp_f32 v85, v85
    v_mfma_f32_32x32x16_bf16 v[64:79], v[52:55], v[96:99], 0
    v_exp_f32 v86, v86
    v_exp_f32 v87, v87
    v_exp_f32 v88, v88
    v_exp_f32 v89, v89
    v_exp_f32 v90, v90
    v_exp_f32 v91, v91
    v_exp_f32 v92, v92
    v_exp_f32 v93, v93
    v_exp_f32 v94, v94
    v_exp_f32 v95, v95
    v_smfmac_f32_32x32x32_bf16 v[240:255], v[44:47], v[80:87], v6
    v_exp_f32 v64, v64
    v_exp_f32 v65, v65
    v_exp_f32 v66, v66
    v_smfmac_f32_32x32x32_bf16 v[240:255], v[48:51], v[88:95], v6
    v_exp_f32 v67, v67
    v_exp_f32 v68, v68
    v_exp_f32 v69, v69
    v_mfma_f32_32x32x16_bf16 v[80:95], v[52:55], v[100:103], 0
    buffer_load_dwordx4 v[40:43], v9, s[44:47], s27 offen sc1
    buffer_load_dwordx4 v[44:47], v24, s[44:47], s27 offen sc1
    buffer_load_dwordx4 v[48:51], v25, s[44:47], s27 offen sc1
    v_exp_f32 v70, v70
    v_exp_f32 v71, v71
    v_exp_f32 v72, v72
    v_exp_f32 v73, v73
    v_exp_f32 v74, v74
    v_exp_f32 v75, v75
    v_exp_f32 v76, v76
    v_exp_f32 v77, v77
    v_exp_f32 v78, v78
    v_exp_f32 v79, v79
    v_smfmac_f32_32x32x32_bf16 v[128:143], v[56:59], v[64:71], v6
    v_exp_f32 v80, v80
    v_exp_f32 v81, v81
    v_exp_f32 v82, v82
    v_smfmac_f32_32x32x32_bf16 v[128:143], v[60:63], v[72:79], v6
    v_exp_f32 v83, v83
    v_exp_f32 v84, v84
    v_exp_f32 v85, v85
    v_mfma_f32_32x32x16_bf16 v[64:79], v[52:55], v[104:107], 0
    v_exp_f32 v86, v86
    v_exp_f32 v87, v87
    v_exp_f32 v88, v88
    v_exp_f32 v89, v89
    v_exp_f32 v90, v90
    v_exp_f32 v91, v91
    v_exp_f32 v92, v92
    v_exp_f32 v93, v93
    v_exp_f32 v94, v94
    v_exp_f32 v95, v95
    v_smfmac_f32_32x32x32_bf16 v[144:159], v[56:59], v[80:87], v6
    v_exp_f32 v64, v64
    v_exp_f32 v65, v65
    v_exp_f32 v66, v66
    v_smfmac_f32_32x32x32_bf16 v[144:159], v[60:63], v[88:95], v6
    v_exp_f32 v67, v67
    v_exp_f32 v68, v68
    v_exp_f32 v69, v69
    v_mfma_f32_32x32x16_bf16 v[80:95], v[52:55], v[108:111], 0
    v_exp_f32 v70, v70
    v_exp_f32 v71, v71
    v_exp_f32 v72, v72
    v_exp_f32 v73, v73
    v_exp_f32 v74, v74
    v_exp_f32 v75, v75
    v_exp_f32 v76, v76
    v_exp_f32 v77, v77
    v_exp_f32 v78, v78
    v_exp_f32 v79, v79
    v_smfmac_f32_32x32x32_bf16 v[160:175], v[56:59], v[64:71], v6
    v_exp_f32 v80, v80
    v_exp_f32 v81, v81
    v_exp_f32 v82, v82
    v_smfmac_f32_32x32x32_bf16 v[160:175], v[60:63], v[72:79], v6
    v_exp_f32 v83, v83
    v_exp_f32 v84, v84
    v_exp_f32 v85, v85
    v_mfma_f32_32x32x16_bf16 v[64:79], v[52:55], v[112:115], 0
    v_exp_f32 v86, v86
    v_exp_f32 v87, v87
    v_exp_f32 v88, v88
    v_exp_f32 v89, v89
    v_exp_f32 v90, v90
    v_exp_f32 v91, v91
    v_exp_f32 v92, v92
    v_exp_f32 v93, v93
    v_exp_f32 v94, v94
    v_exp_f32 v95, v95
    v_smfmac_f32_32x32x32_bf16 v[176:191], v[56:59], v[80:87], v6
    v_exp_f32 v64, v64
    v_exp_f32 v65, v65
    v_exp_f32 v66, v66
    v_smfmac_f32_32x32x32_bf16 v[176:191], v[60:63], v[88:95], v6
    v_exp_f32 v67, v67
    v_exp_f32 v68, v68
    v_exp_f32 v69, v69
    v_mfma_f32_32x32x16_bf16 v[80:95], v[52:55], v[116:119], 0
    v_exp_f32 v70, v70
    v_exp_f32 v71, v71
    v_exp_f32 v72, v72
    v_exp_f32 v73, v73
    v_exp_f32 v74, v74
    v_exp_f32 v75, v75
    v_exp_f32 v76, v76
    v_exp_f32 v77, v77
    v_exp_f32 v78, v78
    v_exp_f32 v79, v79
    v_smfmac_f32_32x32x32_bf16 v[192:207], v[56:59], v[64:71], v6
    v_exp_f32 v80, v80
    v_exp_f32 v81, v81
    v_exp_f32 v82, v82
    v_smfmac_f32_32x32x32_bf16 v[192:207], v[60:63], v[72:79], v6
    v_exp_f32 v83, v83
    v_exp_f32 v84, v84
    v_exp_f32 v85, v85
    v_mfma_f32_32x32x16_bf16 v[64:79], v[52:55], v[120:123], 0
    v_exp_f32 v86, v86
    v_exp_f32 v87, v87
    v_exp_f32 v88, v88
    v_exp_f32 v89, v89
    v_exp_f32 v90, v90
    v_exp_f32 v91, v91
    v_exp_f32 v92, v92
    v_exp_f32 v93, v93
    v_exp_f32 v94, v94
    v_exp_f32 v95, v95
    v_smfmac_f32_32x32x32_bf16 v[208:223], v[56:59], v[80:87], v6
    v_exp_f32 v64, v64
    v_exp_f32 v65, v65
    v_exp_f32 v66, v66
    v_smfmac_f32_32x32x32_bf16 v[208:223], v[60:63], v[88:95], v6
    v_exp_f32 v67, v67
    v_exp_f32 v68, v68
    v_exp_f32 v69, v69
    v_mfma_f32_32x32x16_bf16 v[80:95], v[52:55], v[124:127], 0
    v_exp_f32 v70, v70
    v_exp_f32 v71, v71
    v_exp_f32 v72, v72
    v_exp_f32 v73, v73
    v_exp_f32 v74, v74
    v_exp_f32 v75, v75
    v_exp_f32 v76, v76
    v_exp_f32 v77, v77
    v_exp_f32 v78, v78
    v_exp_f32 v79, v79
    v_smfmac_f32_32x32x32_bf16 v[224:239], v[56:59], v[64:71], v6
    v_exp_f32 v80, v80
    v_exp_f32 v81, v81
    v_exp_f32 v82, v82
    v_smfmac_f32_32x32x32_bf16 v[224:239], v[60:63], v[72:79], v6
    s_waitcnt vmcnt(3)
    v_exp_f32 v83, v83
    v_exp_f32 v84, v84
    v_exp_f32 v85, v85
    v_mfma_f32_32x32x16_bf16 v[64:79], v[28:31], v[96:99], 0
    v_exp_f32 v86, v86
    v_exp_f32 v87, v87
    v_exp_f32 v88, v88
    v_exp_f32 v89, v89
    v_exp_f32 v90, v90
    v_exp_f32 v91, v91
    v_exp_f32 v92, v92
    v_exp_f32 v93, v93
    v_exp_f32 v94, v94
    v_exp_f32 v95, v95
    v_smfmac_f32_32x32x32_bf16 v[240:255], v[56:59], v[80:87], v6
    v_exp_f32 v64, v64
    v_exp_f32 v65, v65
    v_exp_f32 v66, v66
    v_smfmac_f32_32x32x32_bf16 v[240:255], v[60:63], v[88:95], v6
    v_exp_f32 v67, v67
    v_exp_f32 v68, v68
    v_exp_f32 v69, v69
    v_mfma_f32_32x32x16_bf16 v[80:95], v[28:31], v[100:103], 0
    buffer_load_dwordx4 v[52:55], v9, s[44:47], s28 offen sc1
    buffer_load_dwordx4 v[56:59], v24, s[44:47], s28 offen sc1
    buffer_load_dwordx4 v[60:63], v25, s[44:47], s28 offen sc1
    v_exp_f32 v70, v70
    v_exp_f32 v71, v71
    v_exp_f32 v72, v72
    v_exp_f32 v73, v73
    v_exp_f32 v74, v74
    v_exp_f32 v75, v75
    v_exp_f32 v76, v76
    v_exp_f32 v77, v77
    v_exp_f32 v78, v78
    v_exp_f32 v79, v79
    v_smfmac_f32_32x32x32_bf16 v[128:143], v[32:35], v[64:71], v6
    v_exp_f32 v80, v80
    v_exp_f32 v81, v81
    v_exp_f32 v82, v82
    v_smfmac_f32_32x32x32_bf16 v[128:143], v[36:39], v[72:79], v6
    v_exp_f32 v83, v83
    v_exp_f32 v84, v84
    v_exp_f32 v85, v85
    v_mfma_f32_32x32x16_bf16 v[64:79], v[28:31], v[104:107], 0
    v_exp_f32 v86, v86
    v_exp_f32 v87, v87
    v_exp_f32 v88, v88
    v_exp_f32 v89, v89
    v_exp_f32 v90, v90
    v_exp_f32 v91, v91
    v_exp_f32 v92, v92
    v_exp_f32 v93, v93
    v_exp_f32 v94, v94
    v_exp_f32 v95, v95
    v_smfmac_f32_32x32x32_bf16 v[144:159], v[32:35], v[80:87], v6
    v_exp_f32 v64, v64
    v_exp_f32 v65, v65
    v_exp_f32 v66, v66
    v_smfmac_f32_32x32x32_bf16 v[144:159], v[36:39], v[88:95], v6
    v_exp_f32 v67, v67
    v_exp_f32 v68, v68
    v_exp_f32 v69, v69
    v_mfma_f32_32x32x16_bf16 v[80:95], v[28:31], v[108:111], 0
    v_exp_f32 v70, v70
    v_exp_f32 v71, v71
    v_exp_f32 v72, v72
    v_exp_f32 v73, v73
    v_exp_f32 v74, v74
    v_exp_f32 v75, v75
    v_exp_f32 v76, v76
    v_exp_f32 v77, v77
    v_exp_f32 v78, v78
    v_exp_f32 v79, v79
    v_smfmac_f32_32x32x32_bf16 v[160:175], v[32:35], v[64:71], v6
    v_exp_f32 v80, v80
    v_exp_f32 v81, v81
    v_exp_f32 v82, v82
    v_smfmac_f32_32x32x32_bf16 v[160:175], v[36:39], v[72:79], v6
    v_exp_f32 v83, v83
    v_exp_f32 v84, v84
    v_exp_f32 v85, v85
    v_mfma_f32_32x32x16_bf16 v[64:79], v[28:31], v[112:115], 0
    v_exp_f32 v86, v86
    v_exp_f32 v87, v87
    v_exp_f32 v88, v88
    v_exp_f32 v89, v89
    v_exp_f32 v90, v90
    v_exp_f32 v91, v91
    v_exp_f32 v92, v92
    v_exp_f32 v93, v93
    v_exp_f32 v94, v94
    v_exp_f32 v95, v95
    v_smfmac_f32_32x32x32_bf16 v[176:191], v[32:35], v[80:87], v6
    v_exp_f32 v64, v64
    v_exp_f32 v65, v65
    v_exp_f32 v66, v66
    v_smfmac_f32_32x32x32_bf16 v[176:191], v[36:39], v[88:95], v6
    v_exp_f32 v67, v67
    v_exp_f32 v68, v68
    v_exp_f32 v69, v69
    v_mfma_f32_32x32x16_bf16 v[80:95], v[28:31], v[116:119], 0
    v_exp_f32 v70, v70
    v_exp_f32 v71, v71
    v_exp_f32 v72, v72
    v_exp_f32 v73, v73
    v_exp_f32 v74, v74
    v_exp_f32 v75, v75
    v_exp_f32 v76, v76
    v_exp_f32 v77, v77
    v_exp_f32 v78, v78
    v_exp_f32 v79, v79
    v_smfmac_f32_32x32x32_bf16 v[192:207], v[32:35], v[64:71], v6
    v_exp_f32 v80, v80
    v_exp_f32 v81, v81
    v_exp_f32 v82, v82
    v_smfmac_f32_32x32x32_bf16 v[192:207], v[36:39], v[72:79], v6
    v_exp_f32 v83, v83
    v_exp_f32 v84, v84
    v_exp_f32 v85, v85
    v_mfma_f32_32x32x16_bf16 v[64:79], v[28:31], v[120:123], 0
    v_exp_f32 v86, v86
    v_exp_f32 v87, v87
    v_exp_f32 v88, v88
    v_exp_f32 v89, v89
    v_exp_f32 v90, v90
    v_exp_f32 v91, v91
    v_exp_f32 v92, v92
    v_exp_f32 v93, v93
    v_exp_f32 v94, v94
    v_exp_f32 v95, v95
    v_smfmac_f32_32x32x32_bf16 v[208:223], v[32:35], v[80:87], v6
    v_exp_f32 v64, v64
    v_exp_f32 v65, v65
    v_exp_f32 v66, v66
    v_smfmac_f32_32x32x32_bf16 v[208:223], v[36:39], v[88:95], v6
    v_exp_f32 v67, v67
    v_exp_f32 v68, v68
    v_exp_f32 v69, v69
    v_mfma_f32_32x32x16_bf16 v[80:95], v[28:31], v[124:127], 0
    v_exp_f32 v70, v70
    v_exp_f32 v71, v71
    v_exp_f32 v72, v72
    v_exp_f32 v73, v73
    v_exp_f32 v74, v74
    v_exp_f32 v75, v75
    v_exp_f32 v76, v76
    v_exp_f32 v77, v77
    v_exp_f32 v78, v78
    v_exp_f32 v79, v79
    v_smfmac_f32_32x32x32_bf16 v[224:239], v[32:35], v[64:71], v6
    v_exp_f32 v80, v80
    v_exp_f32 v81, v81
    v_exp_f32 v82, v82
    v_smfmac_f32_32x32x32_bf16 v[224:239], v[36:39], v[72:79], v6
    s_waitcnt vmcnt(3)
    v_exp_f32 v83, v83
    v_exp_f32 v84, v84
    v_exp_f32 v85, v85
    v_mfma_f32_32x32x16_bf16 v[64:79], v[40:43], v[96:99], 0
    v_exp_f32 v86, v86
    v_exp_f32 v87, v87
    v_exp_f32 v88, v88
    v_exp_f32 v89, v89
    v_exp_f32 v90, v90
    v_exp_f32 v91, v91
    v_exp_f32 v92, v92
    v_exp_f32 v93, v93
    v_exp_f32 v94, v94
    v_exp_f32 v95, v95
    v_smfmac_f32_32x32x32_bf16 v[240:255], v[32:35], v[80:87], v6
    v_exp_f32 v64, v64
    v_exp_f32 v65, v65
    v_exp_f32 v66, v66
    v_smfmac_f32_32x32x32_bf16 v[240:255], v[36:39], v[88:95], v6
    v_exp_f32 v67, v67
    v_exp_f32 v68, v68
    v_exp_f32 v69, v69
    v_mfma_f32_32x32x16_bf16 v[80:95], v[40:43], v[100:103], 0
    buffer_load_dwordx4 v[28:31], v9, s[44:47], s29 offen sc1
    buffer_load_dwordx4 v[32:35], v24, s[44:47], s29 offen sc1
    buffer_load_dwordx4 v[36:39], v25, s[44:47], s29 offen sc1
    v_exp_f32 v70, v70
    v_exp_f32 v71, v71
    v_exp_f32 v72, v72
    v_exp_f32 v73, v73
    v_exp_f32 v74, v74
    v_exp_f32 v75, v75
    v_exp_f32 v76, v76
    v_exp_f32 v77, v77
    v_exp_f32 v78, v78
    v_exp_f32 v79, v79
    v_smfmac_f32_32x32x32_bf16 v[128:143], v[44:47], v[64:71], v6
    v_exp_f32 v80, v80
    v_exp_f32 v81, v81
    v_exp_f32 v82, v82
    v_smfmac_f32_32x32x32_bf16 v[128:143], v[48:51], v[72:79], v6
    v_exp_f32 v83, v83
    v_exp_f32 v84, v84
    v_exp_f32 v85, v85
    v_mfma_f32_32x32x16_bf16 v[64:79], v[40:43], v[104:107], 0
    v_exp_f32 v86, v86
    v_exp_f32 v87, v87
    v_exp_f32 v88, v88
    v_exp_f32 v89, v89
    v_exp_f32 v90, v90
    v_exp_f32 v91, v91
    v_exp_f32 v92, v92
    v_exp_f32 v93, v93
    v_exp_f32 v94, v94
    v_exp_f32 v95, v95
    v_smfmac_f32_32x32x32_bf16 v[144:159], v[44:47], v[80:87], v6
    v_exp_f32 v64, v64
    v_exp_f32 v65, v65
    v_exp_f32 v66, v66
    v_smfmac_f32_32x32x32_bf16 v[144:159], v[48:51], v[88:95], v6
    v_exp_f32 v67, v67
    v_exp_f32 v68, v68
    v_exp_f32 v69, v69
    v_mfma_f32_32x32x16_bf16 v[80:95], v[40:43], v[108:111], 0
    v_exp_f32 v70, v70
    v_exp_f32 v71, v71
    v_exp_f32 v72, v72
    v_exp_f32 v73, v73
    v_exp_f32 v74, v74
    v_exp_f32 v75, v75
    v_exp_f32 v76, v76
    v_exp_f32 v77, v77
    v_exp_f32 v78, v78
    v_exp_f32 v79, v79
    v_smfmac_f32_32x32x32_bf16 v[160:175], v[44:47], v[64:71], v6
    v_exp_f32 v80, v80
    v_exp_f32 v81, v81
    v_exp_f32 v82, v82
    v_smfmac_f32_32x32x32_bf16 v[160:175], v[48:51], v[72:79], v6
    v_exp_f32 v83, v83
    v_exp_f32 v84, v84
    v_exp_f32 v85, v85
    v_mfma_f32_32x32x16_bf16 v[64:79], v[40:43], v[112:115], 0
    v_exp_f32 v86, v86
    v_exp_f32 v87, v87
    v_exp_f32 v88, v88
    v_exp_f32 v89, v89
    v_exp_f32 v90, v90
    v_exp_f32 v91, v91
    v_exp_f32 v92, v92
    v_exp_f32 v93, v93
    v_exp_f32 v94, v94
    v_exp_f32 v95, v95
    v_smfmac_f32_32x32x32_bf16 v[176:191], v[44:47], v[80:87], v6
    v_exp_f32 v64, v64
    v_exp_f32 v65, v65
    v_exp_f32 v66, v66
    v_smfmac_f32_32x32x32_bf16 v[176:191], v[48:51], v[88:95], v6
    v_exp_f32 v67, v67
    v_exp_f32 v68, v68
    v_exp_f32 v69, v69
    v_mfma_f32_32x32x16_bf16 v[80:95], v[40:43], v[116:119], 0
    v_exp_f32 v70, v70
    v_exp_f32 v71, v71
    v_exp_f32 v72, v72
    v_exp_f32 v73, v73
    v_exp_f32 v74, v74
    v_exp_f32 v75, v75
    v_exp_f32 v76, v76
    v_exp_f32 v77, v77
    v_exp_f32 v78, v78
    v_exp_f32 v79, v79
    v_smfmac_f32_32x32x32_bf16 v[192:207], v[44:47], v[64:71], v6
    v_exp_f32 v80, v80
    v_exp_f32 v81, v81
    v_exp_f32 v82, v82
    v_smfmac_f32_32x32x32_bf16 v[192:207], v[48:51], v[72:79], v6
    v_exp_f32 v83, v83
    v_exp_f32 v84, v84
    v_exp_f32 v85, v85
    v_mfma_f32_32x32x16_bf16 v[64:79], v[40:43], v[120:123], 0
    v_exp_f32 v86, v86
    v_exp_f32 v87, v87
    v_exp_f32 v88, v88
    v_exp_f32 v89, v89
    v_exp_f32 v90, v90
    v_exp_f32 v91, v91
    v_exp_f32 v92, v92
    v_exp_f32 v93, v93
    v_exp_f32 v94, v94
    v_exp_f32 v95, v95
    v_smfmac_f32_32x32x32_bf16 v[208:223], v[44:47], v[80:87], v6
    v_exp_f32 v64, v64
    v_exp_f32 v65, v65
    v_exp_f32 v66, v66
    v_smfmac_f32_32x32x32_bf16 v[208:223], v[48:51], v[88:95], v6
    v_exp_f32 v67, v67
    v_exp_f32 v68, v68
    v_exp_f32 v69, v69
    v_mfma_f32_32x32x16_bf16 v[80:95], v[40:43], v[124:127], 0
    v_exp_f32 v70, v70
    v_exp_f32 v71, v71
    v_exp_f32 v72, v72
    v_exp_f32 v73, v73
    v_exp_f32 v74, v74
    v_exp_f32 v75, v75
    v_exp_f32 v76, v76
    v_exp_f32 v77, v77
    v_exp_f32 v78, v78
    v_exp_f32 v79, v79
    v_smfmac_f32_32x32x32_bf16 v[224:239], v[44:47], v[64:71], v6
    v_exp_f32 v80, v80
    v_exp_f32 v81, v81
    v_exp_f32 v82, v82
    v_smfmac_f32_32x32x32_bf16 v[224:239], v[48:51], v[72:79], v6
    s_waitcnt vmcnt(3)
    v_exp_f32 v83, v83
    v_exp_f32 v84, v84
    v_exp_f32 v85, v85
    v_mfma_f32_32x32x16_bf16 v[64:79], v[52:55], v[96:99], 0
    v_exp_f32 v86, v86
    v_exp_f32 v87, v87
    v_exp_f32 v88, v88
    v_exp_f32 v89, v89
    v_exp_f32 v90, v90
    v_exp_f32 v91, v91
    v_exp_f32 v92, v92
    v_exp_f32 v93, v93
    v_exp_f32 v94, v94
    v_exp_f32 v95, v95
    v_smfmac_f32_32x32x32_bf16 v[240:255], v[44:47], v[80:87], v6
    v_exp_f32 v64, v64
    v_exp_f32 v65, v65
    v_exp_f32 v66, v66
    v_smfmac_f32_32x32x32_bf16 v[240:255], v[48:51], v[88:95], v6
    v_exp_f32 v67, v67
    v_exp_f32 v68, v68
    v_exp_f32 v69, v69
    v_mfma_f32_32x32x16_bf16 v[80:95], v[52:55], v[100:103], 0
    buffer_load_dwordx4 v[40:43], v9, s[44:47], s30 offen sc1
    buffer_load_dwordx4 v[44:47], v24, s[44:47], s30 offen sc1
    buffer_load_dwordx4 v[48:51], v25, s[44:47], s30 offen sc1
    v_exp_f32 v70, v70
    v_exp_f32 v71, v71
    v_exp_f32 v72, v72
    v_exp_f32 v73, v73
    v_exp_f32 v74, v74
    v_exp_f32 v75, v75
    v_exp_f32 v76, v76
    v_exp_f32 v77, v77
    v_exp_f32 v78, v78
    v_exp_f32 v79, v79
    v_smfmac_f32_32x32x32_bf16 v[128:143], v[56:59], v[64:71], v6
    v_exp_f32 v80, v80
    v_exp_f32 v81, v81
    v_exp_f32 v82, v82
    v_smfmac_f32_32x32x32_bf16 v[128:143], v[60:63], v[72:79], v6
    v_exp_f32 v83, v83
    v_exp_f32 v84, v84
    v_exp_f32 v85, v85
    v_mfma_f32_32x32x16_bf16 v[64:79], v[52:55], v[104:107], 0
    v_exp_f32 v86, v86
    v_exp_f32 v87, v87
    v_exp_f32 v88, v88
    v_exp_f32 v89, v89
    v_exp_f32 v90, v90
    v_exp_f32 v91, v91
    v_exp_f32 v92, v92
    v_exp_f32 v93, v93
    v_exp_f32 v94, v94
    v_exp_f32 v95, v95
    v_smfmac_f32_32x32x32_bf16 v[144:159], v[56:59], v[80:87], v6
    v_exp_f32 v64, v64
    v_exp_f32 v65, v65
    v_exp_f32 v66, v66
    v_smfmac_f32_32x32x32_bf16 v[144:159], v[60:63], v[88:95], v6
    v_exp_f32 v67, v67
    v_exp_f32 v68, v68
    v_exp_f32 v69, v69
    v_mfma_f32_32x32x16_bf16 v[80:95], v[52:55], v[108:111], 0
    v_exp_f32 v70, v70
    v_exp_f32 v71, v71
    v_exp_f32 v72, v72
    v_exp_f32 v73, v73
    v_exp_f32 v74, v74
    v_exp_f32 v75, v75
    v_exp_f32 v76, v76
    v_exp_f32 v77, v77
    v_exp_f32 v78, v78
    v_exp_f32 v79, v79
    v_smfmac_f32_32x32x32_bf16 v[160:175], v[56:59], v[64:71], v6
    v_exp_f32 v80, v80
    v_exp_f32 v81, v81
    v_exp_f32 v82, v82
    v_smfmac_f32_32x32x32_bf16 v[160:175], v[60:63], v[72:79], v6
    v_exp_f32 v83, v83
    v_exp_f32 v84, v84
    v_exp_f32 v85, v85
    v_mfma_f32_32x32x16_bf16 v[64:79], v[52:55], v[112:115], 0
    v_exp_f32 v86, v86
    v_exp_f32 v87, v87
    v_exp_f32 v88, v88
    v_exp_f32 v89, v89
    v_exp_f32 v90, v90
    v_exp_f32 v91, v91
    v_exp_f32 v92, v92
    v_exp_f32 v93, v93
    v_exp_f32 v94, v94
    v_exp_f32 v95, v95
    v_smfmac_f32_32x32x32_bf16 v[176:191], v[56:59], v[80:87], v6
    v_exp_f32 v64, v64
    v_exp_f32 v65, v65
    v_exp_f32 v66, v66
    v_smfmac_f32_32x32x32_bf16 v[176:191], v[60:63], v[88:95], v6
    v_exp_f32 v67, v67
    v_exp_f32 v68, v68
    v_exp_f32 v69, v69
    v_mfma_f32_32x32x16_bf16 v[80:95], v[52:55], v[116:119], 0
    v_exp_f32 v70, v70
    v_exp_f32 v71, v71
    v_exp_f32 v72, v72
    v_exp_f32 v73, v73
    v_exp_f32 v74, v74
    v_exp_f32 v75, v75
    v_exp_f32 v76, v76
    v_exp_f32 v77, v77
    v_exp_f32 v78, v78
    v_exp_f32 v79, v79
    v_smfmac_f32_32x32x32_bf16 v[192:207], v[56:59], v[64:71], v6
    v_exp_f32 v80, v80
    v_exp_f32 v81, v81
    v_exp_f32 v82, v82
    v_smfmac_f32_32x32x32_bf16 v[192:207], v[60:63], v[72:79], v6
    v_exp_f32 v83, v83
    v_exp_f32 v84, v84
    v_exp_f32 v85, v85
    v_mfma_f32_32x32x16_bf16 v[64:79], v[52:55], v[120:123], 0
    v_exp_f32 v86, v86
    v_exp_f32 v87, v87
    v_exp_f32 v88, v88
    v_exp_f32 v89, v89
    v_exp_f32 v90, v90
    v_exp_f32 v91, v91
    v_exp_f32 v92, v92
    v_exp_f32 v93, v93
    v_exp_f32 v94, v94
    v_exp_f32 v95, v95
    v_smfmac_f32_32x32x32_bf16 v[208:223], v[56:59], v[80:87], v6
    v_exp_f32 v64, v64
    v_exp_f32 v65, v65
    v_exp_f32 v66, v66
    v_smfmac_f32_32x32x32_bf16 v[208:223], v[60:63], v[88:95], v6
    v_exp_f32 v67, v67
    v_exp_f32 v68, v68
    v_exp_f32 v69, v69
    v_mfma_f32_32x32x16_bf16 v[80:95], v[52:55], v[124:127], 0
    v_exp_f32 v70, v70
    v_exp_f32 v71, v71
    v_exp_f32 v72, v72
    v_exp_f32 v73, v73
    v_exp_f32 v74, v74
    v_exp_f32 v75, v75
    v_exp_f32 v76, v76
    v_exp_f32 v77, v77
    v_exp_f32 v78, v78
    v_exp_f32 v79, v79
    v_smfmac_f32_32x32x32_bf16 v[224:239], v[56:59], v[64:71], v6
    v_exp_f32 v80, v80
    v_exp_f32 v81, v81
    v_exp_f32 v82, v82
    v_smfmac_f32_32x32x32_bf16 v[224:239], v[60:63], v[72:79], v6
    s_waitcnt vmcnt(3)
    v_exp_f32 v83, v83
    v_exp_f32 v84, v84
    v_exp_f32 v85, v85
    v_mfma_f32_32x32x16_bf16 v[64:79], v[28:31], v[96:99], 0
    v_exp_f32 v86, v86
    v_exp_f32 v87, v87
    v_exp_f32 v88, v88
    v_exp_f32 v89, v89
    v_exp_f32 v90, v90
    v_exp_f32 v91, v91
    v_exp_f32 v92, v92
    v_exp_f32 v93, v93
    v_exp_f32 v94, v94
    v_exp_f32 v95, v95
    v_smfmac_f32_32x32x32_bf16 v[240:255], v[56:59], v[80:87], v6
    v_exp_f32 v64, v64
    v_exp_f32 v65, v65
    v_exp_f32 v66, v66
    v_smfmac_f32_32x32x32_bf16 v[240:255], v[60:63], v[88:95], v6
    v_exp_f32 v67, v67
    v_exp_f32 v68, v68
    v_exp_f32 v69, v69
    v_mfma_f32_32x32x16_bf16 v[80:95], v[28:31], v[100:103], 0
    buffer_load_dwordx4 v[52:55], v9, s[44:47], s31 offen sc1
    buffer_load_dwordx4 v[56:59], v24, s[44:47], s31 offen sc1
    buffer_load_dwordx4 v[60:63], v25, s[44:47], s31 offen sc1
    v_exp_f32 v70, v70
    v_exp_f32 v71, v71
    v_exp_f32 v72, v72
    v_exp_f32 v73, v73
    v_exp_f32 v74, v74
    v_exp_f32 v75, v75
    v_exp_f32 v76, v76
    v_exp_f32 v77, v77
    v_exp_f32 v78, v78
    v_exp_f32 v79, v79
    v_smfmac_f32_32x32x32_bf16 v[128:143], v[32:35], v[64:71], v6
    v_exp_f32 v80, v80
    v_exp_f32 v81, v81
    v_exp_f32 v82, v82
    v_smfmac_f32_32x32x32_bf16 v[128:143], v[36:39], v[72:79], v6
    v_exp_f32 v83, v83
    v_exp_f32 v84, v84
    v_exp_f32 v85, v85
    v_mfma_f32_32x32x16_bf16 v[64:79], v[28:31], v[104:107], 0
    v_exp_f32 v86, v86
    v_exp_f32 v87, v87
    v_exp_f32 v88, v88
    v_exp_f32 v89, v89
    v_exp_f32 v90, v90
    v_exp_f32 v91, v91
    v_exp_f32 v92, v92
    v_exp_f32 v93, v93
    v_exp_f32 v94, v94
    v_exp_f32 v95, v95
    v_smfmac_f32_32x32x32_bf16 v[144:159], v[32:35], v[80:87], v6
    v_exp_f32 v64, v64
    v_exp_f32 v65, v65
    v_exp_f32 v66, v66
    v_smfmac_f32_32x32x32_bf16 v[144:159], v[36:39], v[88:95], v6
    v_exp_f32 v67, v67
    v_exp_f32 v68, v68
    v_exp_f32 v69, v69
    v_mfma_f32_32x32x16_bf16 v[80:95], v[28:31], v[108:111], 0
    v_exp_f32 v70, v70
    v_exp_f32 v71, v71
    v_exp_f32 v72, v72
    v_exp_f32 v73, v73
    v_exp_f32 v74, v74
    v_exp_f32 v75, v75
    v_exp_f32 v76, v76
    v_exp_f32 v77, v77
    v_exp_f32 v78, v78
    v_exp_f32 v79, v79
    v_smfmac_f32_32x32x32_bf16 v[160:175], v[32:35], v[64:71], v6
    v_exp_f32 v80, v80
    v_exp_f32 v81, v81
    v_exp_f32 v82, v82
    v_smfmac_f32_32x32x32_bf16 v[160:175], v[36:39], v[72:79], v6
    v_exp_f32 v83, v83
    v_exp_f32 v84, v84
    v_exp_f32 v85, v85
    v_mfma_f32_32x32x16_bf16 v[64:79], v[28:31], v[112:115], 0
    v_exp_f32 v86, v86
    v_exp_f32 v87, v87
    v_exp_f32 v88, v88
    v_exp_f32 v89, v89
    v_exp_f32 v90, v90
    v_exp_f32 v91, v91
    v_exp_f32 v92, v92
    v_exp_f32 v93, v93
    v_exp_f32 v94, v94
    v_exp_f32 v95, v95
    v_smfmac_f32_32x32x32_bf16 v[176:191], v[32:35], v[80:87], v6
    v_exp_f32 v64, v64
    v_exp_f32 v65, v65
    v_exp_f32 v66, v66
    v_smfmac_f32_32x32x32_bf16 v[176:191], v[36:39], v[88:95], v6
    v_exp_f32 v67, v67
    v_exp_f32 v68, v68
    v_exp_f32 v69, v69
    v_mfma_f32_32x32x16_bf16 v[80:95], v[28:31], v[116:119], 0
    v_exp_f32 v70, v70
    v_exp_f32 v71, v71
    v_exp_f32 v72, v72
    v_exp_f32 v73, v73
    v_exp_f32 v74, v74
    v_exp_f32 v75, v75
    v_exp_f32 v76, v76
    v_exp_f32 v77, v77
    v_exp_f32 v78, v78
    v_exp_f32 v79, v79
    v_smfmac_f32_32x32x32_bf16 v[192:207], v[32:35], v[64:71], v6
    v_exp_f32 v80, v80
    v_exp_f32 v81, v81
    v_exp_f32 v82, v82
    v_smfmac_f32_32x32x32_bf16 v[192:207], v[36:39], v[72:79], v6
    v_exp_f32 v83, v83
    v_exp_f32 v84, v84
    v_exp_f32 v85, v85
    v_mfma_f32_32x32x16_bf16 v[64:79], v[28:31], v[120:123], 0
    v_exp_f32 v86, v86
    v_exp_f32 v87, v87
    v_exp_f32 v88, v88
    v_exp_f32 v89, v89
    v_exp_f32 v90, v90
    v_exp_f32 v91, v91
    v_exp_f32 v92, v92
    v_exp_f32 v93, v93
    v_exp_f32 v94, v94
    v_exp_f32 v95, v95
    v_smfmac_f32_32x32x32_bf16 v[208:223], v[32:35], v[80:87], v6
    v_exp_f32 v64, v64
    v_exp_f32 v65, v65
    v_exp_f32 v66, v66
    v_smfmac_f32_32x32x32_bf16 v[208:223], v[36:39], v[88:95], v6
    v_exp_f32 v67, v67
    v_exp_f32 v68, v68
    v_exp_f32 v69, v69
    v_mfma_f32_32x32x16_bf16 v[80:95], v[28:31], v[124:127], 0
    v_exp_f32 v70, v70
    v_exp_f32 v71, v71
    v_exp_f32 v72, v72
    v_exp_f32 v73, v73
    v_exp_f32 v74, v74
    v_exp_f32 v75, v75
    v_exp_f32 v76, v76
    v_exp_f32 v77, v77
    v_exp_f32 v78, v78
    v_exp_f32 v79, v79
    v_smfmac_f32_32x32x32_bf16 v[224:239], v[32:35], v[64:71], v6
    v_exp_f32 v80, v80
    v_exp_f32 v81, v81
    v_exp_f32 v82, v82
    v_smfmac_f32_32x32x32_bf16 v[224:239], v[36:39], v[72:79], v6
    s_waitcnt vmcnt(3)
    v_exp_f32 v83, v83
    v_exp_f32 v84, v84
    v_exp_f32 v85, v85
    v_mfma_f32_32x32x16_bf16 v[64:79], v[40:43], v[96:99], 0
    v_exp_f32 v86, v86
    v_exp_f32 v87, v87
    v_exp_f32 v88, v88
    v_exp_f32 v89, v89
    v_exp_f32 v90, v90
    v_exp_f32 v91, v91
    v_exp_f32 v92, v92
    v_exp_f32 v93, v93
    v_exp_f32 v94, v94
    v_exp_f32 v95, v95
    v_smfmac_f32_32x32x32_bf16 v[240:255], v[32:35], v[80:87], v6
    v_exp_f32 v64, v64
    v_exp_f32 v65, v65
    v_exp_f32 v66, v66
    v_smfmac_f32_32x32x32_bf16 v[240:255], v[36:39], v[88:95], v6
    v_exp_f32 v67, v67
    v_exp_f32 v68, v68
    v_exp_f32 v69, v69
    v_mfma_f32_32x32x16_bf16 v[80:95], v[40:43], v[100:103], 0
    buffer_load_dwordx4 v[28:31], v9, s[44:47], s32 offen sc1
    buffer_load_dwordx4 v[32:35], v24, s[44:47], s32 offen sc1
    buffer_load_dwordx4 v[36:39], v25, s[44:47], s32 offen sc1
    v_exp_f32 v70, v70
    v_exp_f32 v71, v71
    v_exp_f32 v72, v72
    v_exp_f32 v73, v73
    v_exp_f32 v74, v74
    v_exp_f32 v75, v75
    v_exp_f32 v76, v76
    v_exp_f32 v77, v77
    v_exp_f32 v78, v78
    v_exp_f32 v79, v79
    v_smfmac_f32_32x32x32_bf16 v[128:143], v[44:47], v[64:71], v6
    v_exp_f32 v80, v80
    v_exp_f32 v81, v81
    v_exp_f32 v82, v82
    v_smfmac_f32_32x32x32_bf16 v[128:143], v[48:51], v[72:79], v6
    v_exp_f32 v83, v83
    v_exp_f32 v84, v84
    v_exp_f32 v85, v85
    v_mfma_f32_32x32x16_bf16 v[64:79], v[40:43], v[104:107], 0
    v_exp_f32 v86, v86
    v_exp_f32 v87, v87
    v_exp_f32 v88, v88
    v_exp_f32 v89, v89
    v_exp_f32 v90, v90
    v_exp_f32 v91, v91
    v_exp_f32 v92, v92
    v_exp_f32 v93, v93
    v_exp_f32 v94, v94
    v_exp_f32 v95, v95
    v_smfmac_f32_32x32x32_bf16 v[144:159], v[44:47], v[80:87], v6
    v_exp_f32 v64, v64
    v_exp_f32 v65, v65
    v_exp_f32 v66, v66
    v_smfmac_f32_32x32x32_bf16 v[144:159], v[48:51], v[88:95], v6
    v_exp_f32 v67, v67
    v_exp_f32 v68, v68
    v_exp_f32 v69, v69
    v_mfma_f32_32x32x16_bf16 v[80:95], v[40:43], v[108:111], 0
    v_exp_f32 v70, v70
    v_exp_f32 v71, v71
    v_exp_f32 v72, v72
    v_exp_f32 v73, v73
    v_exp_f32 v74, v74
    v_exp_f32 v75, v75
    v_exp_f32 v76, v76
    v_exp_f32 v77, v77
    v_exp_f32 v78, v78
    v_exp_f32 v79, v79
    v_smfmac_f32_32x32x32_bf16 v[160:175], v[44:47], v[64:71], v6
    v_exp_f32 v80, v80
    v_exp_f32 v81, v81
    v_exp_f32 v82, v82
    v_smfmac_f32_32x32x32_bf16 v[160:175], v[48:51], v[72:79], v6
    v_exp_f32 v83, v83
    v_exp_f32 v84, v84
    v_exp_f32 v85, v85
    v_mfma_f32_32x32x16_bf16 v[64:79], v[40:43], v[112:115], 0
    v_exp_f32 v86, v86
    v_exp_f32 v87, v87
    v_exp_f32 v88, v88
    v_exp_f32 v89, v89
    v_exp_f32 v90, v90
    v_exp_f32 v91, v91
    v_exp_f32 v92, v92
    v_exp_f32 v93, v93
    v_exp_f32 v94, v94
    v_exp_f32 v95, v95
    v_smfmac_f32_32x32x32_bf16 v[176:191], v[44:47], v[80:87], v6
    v_exp_f32 v64, v64
    v_exp_f32 v65, v65
    v_exp_f32 v66, v66
    v_smfmac_f32_32x32x32_bf16 v[176:191], v[48:51], v[88:95], v6
    v_exp_f32 v67, v67
    v_exp_f32 v68, v68
    v_exp_f32 v69, v69
    v_mfma_f32_32x32x16_bf16 v[80:95], v[40:43], v[116:119], 0
    v_exp_f32 v70, v70
    v_exp_f32 v71, v71
    v_exp_f32 v72, v72
    v_exp_f32 v73, v73
    v_exp_f32 v74, v74
    v_exp_f32 v75, v75
    v_exp_f32 v76, v76
    v_exp_f32 v77, v77
    v_exp_f32 v78, v78
    v_exp_f32 v79, v79
    v_smfmac_f32_32x32x32_bf16 v[192:207], v[44:47], v[64:71], v6
    v_exp_f32 v80, v80
    v_exp_f32 v81, v81
    v_exp_f32 v82, v82
    v_smfmac_f32_32x32x32_bf16 v[192:207], v[48:51], v[72:79], v6
    v_exp_f32 v83, v83
    v_exp_f32 v84, v84
    v_exp_f32 v85, v85
    v_mfma_f32_32x32x16_bf16 v[64:79], v[40:43], v[120:123], 0
    v_exp_f32 v86, v86
    v_exp_f32 v87, v87
    v_exp_f32 v88, v88
    v_exp_f32 v89, v89
    v_exp_f32 v90, v90
    v_exp_f32 v91, v91
    v_exp_f32 v92, v92
    v_exp_f32 v93, v93
    v_exp_f32 v94, v94
    v_exp_f32 v95, v95
    v_smfmac_f32_32x32x32_bf16 v[208:223], v[44:47], v[80:87], v6
    v_exp_f32 v64, v64
    v_exp_f32 v65, v65
    v_exp_f32 v66, v66
    v_smfmac_f32_32x32x32_bf16 v[208:223], v[48:51], v[88:95], v6
    v_exp_f32 v67, v67
    v_exp_f32 v68, v68
    v_exp_f32 v69, v69
    v_mfma_f32_32x32x16_bf16 v[80:95], v[40:43], v[124:127], 0
    v_exp_f32 v70, v70
    v_exp_f32 v71, v71
    v_exp_f32 v72, v72
    v_exp_f32 v73, v73
    v_exp_f32 v74, v74
    v_exp_f32 v75, v75
    v_exp_f32 v76, v76
    v_exp_f32 v77, v77
    v_exp_f32 v78, v78
    v_exp_f32 v79, v79
    v_smfmac_f32_32x32x32_bf16 v[224:239], v[44:47], v[64:71], v6
    v_exp_f32 v80, v80
    v_exp_f32 v81, v81
    v_exp_f32 v82, v82
    v_smfmac_f32_32x32x32_bf16 v[224:239], v[48:51], v[72:79], v6
    s_waitcnt vmcnt(3)
    v_exp_f32 v83, v83
    v_exp_f32 v84, v84
    v_exp_f32 v85, v85
    v_mfma_f32_32x32x16_bf16 v[64:79], v[52:55], v[96:99], 0
    v_exp_f32 v86, v86
    v_exp_f32 v87, v87
    v_exp_f32 v88, v88
    v_exp_f32 v89, v89
    v_exp_f32 v90, v90
    v_exp_f32 v91, v91
    v_exp_f32 v92, v92
    v_exp_f32 v93, v93
    v_exp_f32 v94, v94
    v_exp_f32 v95, v95
    v_smfmac_f32_32x32x32_bf16 v[240:255], v[44:47], v[80:87], v6
    v_exp_f32 v64, v64
    v_exp_f32 v65, v65
    v_exp_f32 v66, v66
    v_smfmac_f32_32x32x32_bf16 v[240:255], v[48:51], v[88:95], v6
    v_exp_f32 v67, v67
    v_exp_f32 v68, v68
    v_exp_f32 v69, v69
    v_mfma_f32_32x32x16_bf16 v[80:95], v[52:55], v[100:103], 0
    buffer_load_dwordx4 v[40:43], v9, s[44:47], s33 offen sc1
    buffer_load_dwordx4 v[44:47], v24, s[44:47], s33 offen sc1
    buffer_load_dwordx4 v[48:51], v25, s[44:47], s33 offen sc1
    v_exp_f32 v70, v70
    v_exp_f32 v71, v71
    v_exp_f32 v72, v72
    v_exp_f32 v73, v73
    v_exp_f32 v74, v74
    v_exp_f32 v75, v75
    v_exp_f32 v76, v76
    v_exp_f32 v77, v77
    v_exp_f32 v78, v78
    v_exp_f32 v79, v79
    v_smfmac_f32_32x32x32_bf16 v[128:143], v[56:59], v[64:71], v6
    v_exp_f32 v80, v80
    v_exp_f32 v81, v81
    v_exp_f32 v82, v82
    v_smfmac_f32_32x32x32_bf16 v[128:143], v[60:63], v[72:79], v6
    v_exp_f32 v83, v83
    v_exp_f32 v84, v84
    v_exp_f32 v85, v85
    v_mfma_f32_32x32x16_bf16 v[64:79], v[52:55], v[104:107], 0
    v_exp_f32 v86, v86
    v_exp_f32 v87, v87
    v_exp_f32 v88, v88
    v_exp_f32 v89, v89
    v_exp_f32 v90, v90
    v_exp_f32 v91, v91
    v_exp_f32 v92, v92
    v_exp_f32 v93, v93
    v_exp_f32 v94, v94
    v_exp_f32 v95, v95
    v_smfmac_f32_32x32x32_bf16 v[144:159], v[56:59], v[80:87], v6
    v_exp_f32 v64, v64
    v_exp_f32 v65, v65
    v_exp_f32 v66, v66
    v_smfmac_f32_32x32x32_bf16 v[144:159], v[60:63], v[88:95], v6
    v_exp_f32 v67, v67
    v_exp_f32 v68, v68
    v_exp_f32 v69, v69
    v_mfma_f32_32x32x16_bf16 v[80:95], v[52:55], v[108:111], 0
    v_exp_f32 v70, v70
    v_exp_f32 v71, v71
    v_exp_f32 v72, v72
    v_exp_f32 v73, v73
    v_exp_f32 v74, v74
    v_exp_f32 v75, v75
    v_exp_f32 v76, v76
    v_exp_f32 v77, v77
    v_exp_f32 v78, v78
    v_exp_f32 v79, v79
    v_smfmac_f32_32x32x32_bf16 v[160:175], v[56:59], v[64:71], v6
    v_exp_f32 v80, v80
    v_exp_f32 v81, v81
    v_exp_f32 v82, v82
    v_smfmac_f32_32x32x32_bf16 v[160:175], v[60:63], v[72:79], v6
    v_exp_f32 v83, v83
    v_exp_f32 v84, v84
    v_exp_f32 v85, v85
    v_mfma_f32_32x32x16_bf16 v[64:79], v[52:55], v[112:115], 0
    v_exp_f32 v86, v86
    v_exp_f32 v87, v87
    v_exp_f32 v88, v88
    v_exp_f32 v89, v89
    v_exp_f32 v90, v90
    v_exp_f32 v91, v91
    v_exp_f32 v92, v92
    v_exp_f32 v93, v93
    v_exp_f32 v94, v94
    v_exp_f32 v95, v95
    v_smfmac_f32_32x32x32_bf16 v[176:191], v[56:59], v[80:87], v6
    v_exp_f32 v64, v64
    v_exp_f32 v65, v65
    v_exp_f32 v66, v66
    v_smfmac_f32_32x32x32_bf16 v[176:191], v[60:63], v[88:95], v6
    v_exp_f32 v67, v67
    v_exp_f32 v68, v68
    v_exp_f32 v69, v69
    v_mfma_f32_32x32x16_bf16 v[80:95], v[52:55], v[116:119], 0
    v_exp_f32 v70, v70
    v_exp_f32 v71, v71
    v_exp_f32 v72, v72
    v_exp_f32 v73, v73
    v_exp_f32 v74, v74
    v_exp_f32 v75, v75
    v_exp_f32 v76, v76
    v_exp_f32 v77, v77
    v_exp_f32 v78, v78
    v_exp_f32 v79, v79
    v_smfmac_f32_32x32x32_bf16 v[192:207], v[56:59], v[64:71], v6
    v_exp_f32 v80, v80
    v_exp_f32 v81, v81
    v_exp_f32 v82, v82
    v_smfmac_f32_32x32x32_bf16 v[192:207], v[60:63], v[72:79], v6
    v_exp_f32 v83, v83
    v_exp_f32 v84, v84
    v_exp_f32 v85, v85
    v_mfma_f32_32x32x16_bf16 v[64:79], v[52:55], v[120:123], 0
    v_exp_f32 v86, v86
    v_exp_f32 v87, v87
    v_exp_f32 v88, v88
    v_exp_f32 v89, v89
    v_exp_f32 v90, v90
    v_exp_f32 v91, v91
    v_exp_f32 v92, v92
    v_exp_f32 v93, v93
    v_exp_f32 v94, v94
    v_exp_f32 v95, v95
    v_smfmac_f32_32x32x32_bf16 v[208:223], v[56:59], v[80:87], v6
    v_exp_f32 v64, v64
    v_exp_f32 v65, v65
    v_exp_f32 v66, v66
    v_smfmac_f32_32x32x32_bf16 v[208:223], v[60:63], v[88:95], v6
    v_exp_f32 v67, v67
    v_exp_f32 v68, v68
    v_exp_f32 v69, v69
    v_mfma_f32_32x32x16_bf16 v[80:95], v[52:55], v[124:127], 0
    v_exp_f32 v70, v70
    v_exp_f32 v71, v71
    v_exp_f32 v72, v72
    v_exp_f32 v73, v73
    v_exp_f32 v74, v74
    v_exp_f32 v75, v75
    v_exp_f32 v76, v76
    v_exp_f32 v77, v77
    v_exp_f32 v78, v78
    v_exp_f32 v79, v79
    v_smfmac_f32_32x32x32_bf16 v[224:239], v[56:59], v[64:71], v6
    v_exp_f32 v80, v80
    v_exp_f32 v81, v81
    v_exp_f32 v82, v82
    v_smfmac_f32_32x32x32_bf16 v[224:239], v[60:63], v[72:79], v6
    s_waitcnt vmcnt(3)
    v_exp_f32 v83, v83
    v_exp_f32 v84, v84
    v_exp_f32 v85, v85
    v_mfma_f32_32x32x16_bf16 v[64:79], v[28:31], v[96:99], 0
    v_exp_f32 v86, v86
    v_exp_f32 v87, v87
    v_exp_f32 v88, v88
    v_exp_f32 v89, v89
    v_exp_f32 v90, v90
    v_exp_f32 v91, v91
    v_exp_f32 v92, v92
    v_exp_f32 v93, v93
    v_exp_f32 v94, v94
    v_exp_f32 v95, v95
    v_smfmac_f32_32x32x32_bf16 v[240:255], v[56:59], v[80:87], v6
    v_exp_f32 v64, v64
    v_exp_f32 v65, v65
    v_exp_f32 v66, v66
    v_smfmac_f32_32x32x32_bf16 v[240:255], v[60:63], v[88:95], v6
    v_exp_f32 v67, v67
    v_exp_f32 v68, v68
    v_exp_f32 v69, v69
    v_mfma_f32_32x32x16_bf16 v[80:95], v[28:31], v[100:103], 0
    buffer_load_dwordx4 v[52:55], v9, s[44:47], s34 offen sc1
    buffer_load_dwordx4 v[56:59], v24, s[44:47], s34 offen sc1
    buffer_load_dwordx4 v[60:63], v25, s[44:47], s34 offen sc1
    v_exp_f32 v70, v70
    v_exp_f32 v71, v71
    v_exp_f32 v72, v72
    v_exp_f32 v73, v73
    v_exp_f32 v74, v74
    v_exp_f32 v75, v75
    v_exp_f32 v76, v76
    v_exp_f32 v77, v77
    v_exp_f32 v78, v78
    v_exp_f32 v79, v79
    v_smfmac_f32_32x32x32_bf16 v[128:143], v[32:35], v[64:71], v6
    v_exp_f32 v80, v80
    v_exp_f32 v81, v81
    v_exp_f32 v82, v82
    v_smfmac_f32_32x32x32_bf16 v[128:143], v[36:39], v[72:79], v6
    v_exp_f32 v83, v83
    v_exp_f32 v84, v84
    v_exp_f32 v85, v85
    v_mfma_f32_32x32x16_bf16 v[64:79], v[28:31], v[104:107], 0
    v_exp_f32 v86, v86
    v_exp_f32 v87, v87
    v_exp_f32 v88, v88
    v_exp_f32 v89, v89
    v_exp_f32 v90, v90
    v_exp_f32 v91, v91
    v_exp_f32 v92, v92
    v_exp_f32 v93, v93
    v_exp_f32 v94, v94
    v_exp_f32 v95, v95
    v_smfmac_f32_32x32x32_bf16 v[144:159], v[32:35], v[80:87], v6
    v_exp_f32 v64, v64
    v_exp_f32 v65, v65
    v_exp_f32 v66, v66
    v_smfmac_f32_32x32x32_bf16 v[144:159], v[36:39], v[88:95], v6
    v_exp_f32 v67, v67
    v_exp_f32 v68, v68
    v_exp_f32 v69, v69
    v_mfma_f32_32x32x16_bf16 v[80:95], v[28:31], v[108:111], 0
    v_exp_f32 v70, v70
    v_exp_f32 v71, v71
    v_exp_f32 v72, v72
    v_exp_f32 v73, v73
    v_exp_f32 v74, v74
    v_exp_f32 v75, v75
    v_exp_f32 v76, v76
    v_exp_f32 v77, v77
    v_exp_f32 v78, v78
    v_exp_f32 v79, v79
    v_smfmac_f32_32x32x32_bf16 v[160:175], v[32:35], v[64:71], v6
    v_exp_f32 v80, v80
    v_exp_f32 v81, v81
    v_exp_f32 v82, v82
    v_smfmac_f32_32x32x32_bf16 v[160:175], v[36:39], v[72:79], v6
    v_exp_f32 v83, v83
    v_exp_f32 v84, v84
    v_exp_f32 v85, v85
    v_mfma_f32_32x32x16_bf16 v[64:79], v[28:31], v[112:115], 0
    v_exp_f32 v86, v86
    v_exp_f32 v87, v87
    v_exp_f32 v88, v88
    v_exp_f32 v89, v89
    v_exp_f32 v90, v90
    v_exp_f32 v91, v91
    v_exp_f32 v92, v92
    v_exp_f32 v93, v93
    v_exp_f32 v94, v94
    v_exp_f32 v95, v95
    v_smfmac_f32_32x32x32_bf16 v[176:191], v[32:35], v[80:87], v6
    v_exp_f32 v64, v64
    v_exp_f32 v65, v65
    v_exp_f32 v66, v66
    v_smfmac_f32_32x32x32_bf16 v[176:191], v[36:39], v[88:95], v6
    v_exp_f32 v67, v67
    v_exp_f32 v68, v68
    v_exp_f32 v69, v69
    v_mfma_f32_32x32x16_bf16 v[80:95], v[28:31], v[116:119], 0
    v_exp_f32 v70, v70
    v_exp_f32 v71, v71
    v_exp_f32 v72, v72
    v_exp_f32 v73, v73
    v_exp_f32 v74, v74
    v_exp_f32 v75, v75
    v_exp_f32 v76, v76
    v_exp_f32 v77, v77
    v_exp_f32 v78, v78
    v_exp_f32 v79, v79
    v_smfmac_f32_32x32x32_bf16 v[192:207], v[32:35], v[64:71], v6
    v_exp_f32 v80, v80
    v_exp_f32 v81, v81
    v_exp_f32 v82, v82
    v_smfmac_f32_32x32x32_bf16 v[192:207], v[36:39], v[72:79], v6
    v_exp_f32 v83, v83
    v_exp_f32 v84, v84
    v_exp_f32 v85, v85
    v_mfma_f32_32x32x16_bf16 v[64:79], v[28:31], v[120:123], 0
    v_exp_f32 v86, v86
    v_exp_f32 v87, v87
    v_exp_f32 v88, v88
    v_exp_f32 v89, v89
    v_exp_f32 v90, v90
    v_exp_f32 v91, v91
    v_exp_f32 v92, v92
    v_exp_f32 v93, v93
    v_exp_f32 v94, v94
    v_exp_f32 v95, v95
    v_smfmac_f32_32x32x32_bf16 v[208:223], v[32:35], v[80:87], v6
    v_exp_f32 v64, v64
    v_exp_f32 v65, v65
    v_exp_f32 v66, v66
    v_smfmac_f32_32x32x32_bf16 v[208:223], v[36:39], v[88:95], v6
    v_exp_f32 v67, v67
    v_exp_f32 v68, v68
    v_exp_f32 v69, v69
    v_mfma_f32_32x32x16_bf16 v[80:95], v[28:31], v[124:127], 0
    v_exp_f32 v70, v70
    v_exp_f32 v71, v71
    v_exp_f32 v72, v72
    v_exp_f32 v73, v73
    v_exp_f32 v74, v74
    v_exp_f32 v75, v75
    v_exp_f32 v76, v76
    v_exp_f32 v77, v77
    v_exp_f32 v78, v78
    v_exp_f32 v79, v79
    v_smfmac_f32_32x32x32_bf16 v[224:239], v[32:35], v[64:71], v6
    v_exp_f32 v80, v80
    v_exp_f32 v81, v81
    v_exp_f32 v82, v82
    v_smfmac_f32_32x32x32_bf16 v[224:239], v[36:39], v[72:79], v6
    s_waitcnt vmcnt(3)
    v_exp_f32 v83, v83
    v_exp_f32 v84, v84
    v_exp_f32 v85, v85
    v_mfma_f32_32x32x16_bf16 v[64:79], v[40:43], v[96:99], 0
    v_exp_f32 v86, v86
    v_exp_f32 v87, v87
    v_exp_f32 v88, v88
    v_exp_f32 v89, v89
    v_exp_f32 v90, v90
    v_exp_f32 v91, v91
    v_exp_f32 v92, v92
    v_exp_f32 v93, v93
    v_exp_f32 v94, v94
    v_exp_f32 v95, v95
    v_smfmac_f32_32x32x32_bf16 v[240:255], v[32:35], v[80:87], v6
    v_exp_f32 v64, v64
    v_exp_f32 v65, v65
    v_exp_f32 v66, v66
    v_smfmac_f32_32x32x32_bf16 v[240:255], v[36:39], v[88:95], v6
    v_exp_f32 v67, v67
    v_exp_f32 v68, v68
    v_exp_f32 v69, v69
    v_mfma_f32_32x32x16_bf16 v[80:95], v[40:43], v[100:103], 0
    buffer_load_dwordx4 v[28:31], v9, s[44:47], s35 offen sc1
    buffer_load_dwordx4 v[32:35], v24, s[44:47], s35 offen sc1
    buffer_load_dwordx4 v[36:39], v25, s[44:47], s35 offen sc1
    v_exp_f32 v70, v70
    v_exp_f32 v71, v71
    v_exp_f32 v72, v72
    v_exp_f32 v73, v73
    v_exp_f32 v74, v74
    v_exp_f32 v75, v75
    v_exp_f32 v76, v76
    v_exp_f32 v77, v77
    v_exp_f32 v78, v78
    v_exp_f32 v79, v79
    v_smfmac_f32_32x32x32_bf16 v[128:143], v[44:47], v[64:71], v6
    v_exp_f32 v80, v80
    v_exp_f32 v81, v81
    v_exp_f32 v82, v82
    v_smfmac_f32_32x32x32_bf16 v[128:143], v[48:51], v[72:79], v6
    v_exp_f32 v83, v83
    v_exp_f32 v84, v84
    v_exp_f32 v85, v85
    v_mfma_f32_32x32x16_bf16 v[64:79], v[40:43], v[104:107], 0
    v_exp_f32 v86, v86
    v_exp_f32 v87, v87
    v_exp_f32 v88, v88
    v_exp_f32 v89, v89
    v_exp_f32 v90, v90
    v_exp_f32 v91, v91
    v_exp_f32 v92, v92
    v_exp_f32 v93, v93
    v_exp_f32 v94, v94
    v_exp_f32 v95, v95
    v_smfmac_f32_32x32x32_bf16 v[144:159], v[44:47], v[80:87], v6
    v_exp_f32 v64, v64
    v_exp_f32 v65, v65
    v_exp_f32 v66, v66
    v_smfmac_f32_32x32x32_bf16 v[144:159], v[48:51], v[88:95], v6
    v_exp_f32 v67, v67
    v_exp_f32 v68, v68
    v_exp_f32 v69, v69
    v_mfma_f32_32x32x16_bf16 v[80:95], v[40:43], v[108:111], 0
    v_exp_f32 v70, v70
    v_exp_f32 v71, v71
    v_exp_f32 v72, v72
    v_exp_f32 v73, v73
    v_exp_f32 v74, v74
    v_exp_f32 v75, v75
    v_exp_f32 v76, v76
    v_exp_f32 v77, v77
    v_exp_f32 v78, v78
    v_exp_f32 v79, v79
    v_smfmac_f32_32x32x32_bf16 v[160:175], v[44:47], v[64:71], v6
    v_exp_f32 v80, v80
    v_exp_f32 v81, v81
    v_exp_f32 v82, v82
    v_smfmac_f32_32x32x32_bf16 v[160:175], v[48:51], v[72:79], v6
    v_exp_f32 v83, v83
    v_exp_f32 v84, v84
    v_exp_f32 v85, v85
    v_mfma_f32_32x32x16_bf16 v[64:79], v[40:43], v[112:115], 0
    v_exp_f32 v86, v86
    v_exp_f32 v87, v87
    v_exp_f32 v88, v88
    v_exp_f32 v89, v89
    v_exp_f32 v90, v90
    v_exp_f32 v91, v91
    v_exp_f32 v92, v92
    v_exp_f32 v93, v93
    v_exp_f32 v94, v94
    v_exp_f32 v95, v95
    v_smfmac_f32_32x32x32_bf16 v[176:191], v[44:47], v[80:87], v6
    v_exp_f32 v64, v64
    v_exp_f32 v65, v65
    v_exp_f32 v66, v66
    v_smfmac_f32_32x32x32_bf16 v[176:191], v[48:51], v[88:95], v6
    v_exp_f32 v67, v67
    v_exp_f32 v68, v68
    v_exp_f32 v69, v69
    v_mfma_f32_32x32x16_bf16 v[80:95], v[40:43], v[116:119], 0
    v_exp_f32 v70, v70
    v_exp_f32 v71, v71
    v_exp_f32 v72, v72
    v_exp_f32 v73, v73
    v_exp_f32 v74, v74
    v_exp_f32 v75, v75
    v_exp_f32 v76, v76
    v_exp_f32 v77, v77
    v_exp_f32 v78, v78
    v_exp_f32 v79, v79
    v_smfmac_f32_32x32x32_bf16 v[192:207], v[44:47], v[64:71], v6
    v_exp_f32 v80, v80
    v_exp_f32 v81, v81
    v_exp_f32 v82, v82
    v_smfmac_f32_32x32x32_bf16 v[192:207], v[48:51], v[72:79], v6
    v_exp_f32 v83, v83
    v_exp_f32 v84, v84
    v_exp_f32 v85, v85
    v_mfma_f32_32x32x16_bf16 v[64:79], v[40:43], v[120:123], 0
    v_exp_f32 v86, v86
    v_exp_f32 v87, v87
    v_exp_f32 v88, v88
    v_exp_f32 v89, v89
    v_exp_f32 v90, v90
    v_exp_f32 v91, v91
    v_exp_f32 v92, v92
    v_exp_f32 v93, v93
    v_exp_f32 v94, v94
    v_exp_f32 v95, v95
    v_smfmac_f32_32x32x32_bf16 v[208:223], v[44:47], v[80:87], v6
    v_exp_f32 v64, v64
    v_exp_f32 v65, v65
    v_exp_f32 v66, v66
    v_smfmac_f32_32x32x32_bf16 v[208:223], v[48:51], v[88:95], v6
    v_exp_f32 v67, v67
    v_exp_f32 v68, v68
    v_exp_f32 v69, v69
    v_mfma_f32_32x32x16_bf16 v[80:95], v[40:43], v[124:127], 0
    v_exp_f32 v70, v70
    v_exp_f32 v71, v71
    v_exp_f32 v72, v72
    v_exp_f32 v73, v73
    v_exp_f32 v74, v74
    v_exp_f32 v75, v75
    v_exp_f32 v76, v76
    v_exp_f32 v77, v77
    v_exp_f32 v78, v78
    v_exp_f32 v79, v79
    v_smfmac_f32_32x32x32_bf16 v[224:239], v[44:47], v[64:71], v6
    v_exp_f32 v80, v80
    v_exp_f32 v81, v81
    v_exp_f32 v82, v82
    v_smfmac_f32_32x32x32_bf16 v[224:239], v[48:51], v[72:79], v6
    s_waitcnt vmcnt(3)
    v_exp_f32 v83, v83
    v_exp_f32 v84, v84
    v_exp_f32 v85, v85
    v_mfma_f32_32x32x16_bf16 v[64:79], v[52:55], v[96:99], 0
    v_exp_f32 v86, v86
    v_exp_f32 v87, v87
    v_exp_f32 v88, v88
    v_exp_f32 v89, v89
    v_exp_f32 v90, v90
    v_exp_f32 v91, v91
    v_exp_f32 v92, v92
    v_exp_f32 v93, v93
    v_exp_f32 v94, v94
    v_exp_f32 v95, v95
    v_smfmac_f32_32x32x32_bf16 v[240:255], v[44:47], v[80:87], v6
    v_exp_f32 v64, v64
    v_exp_f32 v65, v65
    v_exp_f32 v66, v66
    v_smfmac_f32_32x32x32_bf16 v[240:255], v[48:51], v[88:95], v6
    v_exp_f32 v67, v67
    v_exp_f32 v68, v68
    v_exp_f32 v69, v69
    v_mfma_f32_32x32x16_bf16 v[80:95], v[52:55], v[100:103], 0
    v_exp_f32 v70, v70
    v_exp_f32 v71, v71
    v_exp_f32 v72, v72
    v_exp_f32 v73, v73
    v_exp_f32 v74, v74
    v_exp_f32 v75, v75
    v_exp_f32 v76, v76
    v_exp_f32 v77, v77
    v_exp_f32 v78, v78
    v_exp_f32 v79, v79
    v_smfmac_f32_32x32x32_bf16 v[128:143], v[56:59], v[64:71], v6
    v_exp_f32 v80, v80
    v_exp_f32 v81, v81
    v_exp_f32 v82, v82
    v_smfmac_f32_32x32x32_bf16 v[128:143], v[60:63], v[72:79], v6
    v_exp_f32 v83, v83
    v_exp_f32 v84, v84
    v_exp_f32 v85, v85
    v_mfma_f32_32x32x16_bf16 v[64:79], v[52:55], v[104:107], 0
    buffer_load_dwordx2 v[40:41], v2, s[8:11], s86 offen offset:0
    buffer_load_dwordx2 v[42:43], v2, s[8:11], s86 offen offset:32
    buffer_load_dwordx2 v[44:45], v2, s[8:11], s86 offen offset:64
    buffer_load_dwordx2 v[46:47], v2, s[8:11], s86 offen offset:96
    buffer_load_dword v50, v10, s[44:47], 0 offen sc1
    ds_read_b64 v[48:49], v11 offset:8
    v_exp_f32 v86, v86
    v_exp_f32 v87, v87
    v_exp_f32 v88, v88
    v_exp_f32 v89, v89
    v_exp_f32 v90, v90
    v_exp_f32 v91, v91
    v_exp_f32 v92, v92
    v_exp_f32 v93, v93
    v_exp_f32 v94, v94
    v_exp_f32 v95, v95
    v_smfmac_f32_32x32x32_bf16 v[144:159], v[56:59], v[80:87], v6
    v_exp_f32 v64, v64
    v_exp_f32 v65, v65
    v_exp_f32 v66, v66
    v_smfmac_f32_32x32x32_bf16 v[144:159], v[60:63], v[88:95], v6
    v_exp_f32 v67, v67
    v_exp_f32 v68, v68
    v_exp_f32 v69, v69
    v_mfma_f32_32x32x16_bf16 v[80:95], v[52:55], v[108:111], 0
    v_exp_f32 v70, v70
    v_exp_f32 v71, v71
    v_exp_f32 v72, v72
    v_exp_f32 v73, v73
    v_exp_f32 v74, v74
    v_exp_f32 v75, v75
    v_exp_f32 v76, v76
    v_exp_f32 v77, v77
    v_exp_f32 v78, v78
    v_exp_f32 v79, v79
    v_smfmac_f32_32x32x32_bf16 v[160:175], v[56:59], v[64:71], v6
    v_exp_f32 v80, v80
    v_exp_f32 v81, v81
    v_exp_f32 v82, v82
    v_smfmac_f32_32x32x32_bf16 v[160:175], v[60:63], v[72:79], v6
    v_exp_f32 v83, v83
    v_exp_f32 v84, v84
    v_exp_f32 v85, v85
    v_mfma_f32_32x32x16_bf16 v[64:79], v[52:55], v[112:115], 0
    v_exp_f32 v86, v86
    v_exp_f32 v87, v87
    v_exp_f32 v88, v88
    v_exp_f32 v89, v89
    v_exp_f32 v90, v90
    v_exp_f32 v91, v91
    v_exp_f32 v92, v92
    v_exp_f32 v93, v93
    v_exp_f32 v94, v94
    v_exp_f32 v95, v95
    v_smfmac_f32_32x32x32_bf16 v[176:191], v[56:59], v[80:87], v6
    v_exp_f32 v64, v64
    v_exp_f32 v65, v65
    v_exp_f32 v66, v66
    v_smfmac_f32_32x32x32_bf16 v[176:191], v[60:63], v[88:95], v6
    v_exp_f32 v67, v67
    v_exp_f32 v68, v68
    v_exp_f32 v69, v69
    v_mfma_f32_32x32x16_bf16 v[80:95], v[52:55], v[116:119], 0
    v_exp_f32 v70, v70
    v_exp_f32 v71, v71
    v_exp_f32 v72, v72
    v_exp_f32 v73, v73
    v_exp_f32 v74, v74
    v_exp_f32 v75, v75
    v_exp_f32 v76, v76
    v_exp_f32 v77, v77
    v_exp_f32 v78, v78
    v_exp_f32 v79, v79
    v_smfmac_f32_32x32x32_bf16 v[192:207], v[56:59], v[64:71], v6
    s_waitcnt lgkmcnt(0)
    v_cmp_ne_u32 vcc, 4, v48
    v_readfirstlane_b32 s49, v49
    v_exp_f32 v80, v80
    v_exp_f32 v81, v81
    v_exp_f32 v82, v82
    v_smfmac_f32_32x32x32_bf16 v[192:207], v[60:63], v[72:79], v6
    s_cbranch_vccnz L_xa
L_xa_ok:
    v_exp_f32 v83, v83
    v_exp_f32 v84, v84
    v_exp_f32 v85, v85
    v_mfma_f32_32x32x16_bf16 v[64:79], v[52:55], v[120:123], 0
    v_exp_f32 v86, v86
    v_exp_f32 v87, v87
    v_exp_f32 v88, v88
    v_exp_f32 v89, v89
    v_exp_f32 v90, v90
    v_exp_f32 v91, v91
    v_exp_f32 v92, v92
    v_exp_f32 v93, v93
    v_exp_f32 v94, v94
    v_exp_f32 v95, v95
    v_smfmac_f32_32x32x32_bf16 v[208:223], v[56:59], v[80:87], v6
    v_exp_f32 v64, v64
    v_exp_f32 v65, v65
    v_exp_f32 v66, v66
    v_smfmac_f32_32x32x32_bf16 v[208:223], v[60:63], v[88:95], v6
    v_exp_f32 v67, v67
    v_exp_f32 v68, v68
    v_exp_f32 v69, v69
    v_mfma_f32_32x32x16_bf16 v[80:95], v[52:55], v[124:127], 0
    v_exp_f32 v70, v70
    v_exp_f32 v71, v71
    v_exp_f32 v72, v72
    v_exp_f32 v73, v73
    v_exp_f32 v74, v74
    v_exp_f32 v75, v75
    v_exp_f32 v76, v76
    v_exp_f32 v77, v77
    v_exp_f32 v78, v78
    v_exp_f32 v79, v79
    v_smfmac_f32_32x32x32_bf16 v[224:239], v[56:59], v[64:71], v6
    v_exp_f32 v80, v80
    v_exp_f32 v81, v81
    v_exp_f32 v82, v82
    v_smfmac_f32_32x32x32_bf16 v[224:239], v[60:63], v[72:79], v6
    s_waitcnt vmcnt(5)
    v_exp_f32 v83, v83
    v_exp_f32 v84, v84
    v_exp_f32 v85, v85
    v_mfma_f32_32x32x16_bf16 v[64:79], v[28:31], v[96:99], 0
    v_exp_f32 v86, v86
    v_exp_f32 v87, v87
    v_exp_f32 v88, v88
    v_exp_f32 v89, v89
    v_exp_f32 v90, v90
    v_exp_f32 v91, v91
    v_exp_f32 v92, v92
    v_exp_f32 v93, v93
    v_exp_f32 v94, v94
    v_exp_f32 v95, v95
    v_smfmac_f32_32x32x32_bf16 v[240:255], v[56:59], v[80:87], v6
    v_exp_f32 v64, v64
    v_exp_f32 v65, v65
    v_exp_f32 v66, v66
    v_smfmac_f32_32x32x32_bf16 v[240:255], v[60:63], v[88:95], v6
    v_exp_f32 v67, v67
    v_exp_f32 v68, v68
    v_exp_f32 v69, v69
    v_mfma_f32_32x32x16_bf16 v[80:95], v[28:31], v[100:103], 0
    v_exp_f32 v70, v70
    v_exp_f32 v71, v71
    v_exp_f32 v72, v72
    v_exp_f32 v73, v73
    v_exp_f32 v74, v74
    v_exp_f32 v75, v75
    v_exp_f32 v76, v76
    v_exp_f32 v77, v77
    v_exp_f32 v78, v78
    v_exp_f32 v79, v79
    v_smfmac_f32_32x32x32_bf16 v[128:143], v[32:35], v[64:71], v6
    v_exp_f32 v80, v80
    v_exp_f32 v81, v81
    v_exp_f32 v82, v82
    v_smfmac_f32_32x32x32_bf16 v[128:143], v[36:39], v[72:79], v6
    v_exp_f32 v83, v83
    v_exp_f32 v84, v84
    v_exp_f32 v85, v85
    v_mfma_f32_32x32x16_bf16 v[64:79], v[28:31], v[104:107], 0
    v_exp_f32 v86, v86
    v_exp_f32 v87, v87
    v_exp_f32 v88, v88
    v_exp_f32 v89, v89
    v_exp_f32 v90, v90
    v_exp_f32 v91, v91
    v_exp_f32 v92, v92
    v_exp_f32 v93, v93
    v_exp_f32 v94, v94
    v_exp_f32 v95, v95
    v_smfmac_f32_32x32x32_bf16 v[144:159], v[32:35], v[80:87], v6
    ds_write_b32 v19, v136 offset:0
    ds_write_b128 v16, v[128:131] offset:0
    v_exp_f32 v64, v64
    v_exp_f32 v65, v65
    v_exp_f32 v66, v66
    v_smfmac_f32_32x32x32_bf16 v[144:159], v[36:39], v[88:95], v6
    v_exp_f32 v67, v67
    v_exp_f32 v68, v68
    v_exp_f32 v69, v69
    v_mfma_f32_32x32x16_bf16 v[80:95], v[28:31], v[108:111], 0
    ds_write_b128 v16, v[132:135] offset:1024
    v_exp_f32 v70, v70
    v_exp_f32 v71, v71
    v_exp_f32 v72, v72
    v_exp_f32 v73, v73
    v_exp_f32 v74, v74
    v_exp_f32 v75, v75
    v_exp_f32 v76, v76
    v_exp_f32 v77, v77
    v_exp_f32 v78, v78
    v_exp_f32 v79, v79
    v_smfmac_f32_32x32x32_bf16 v[160:175], v[32:35], v[64:71], v6
    ds_write_b32 v19, v152 offset:256
    ds_write_b128 v16, v[144:147] offset:2048
    v_exp_f32 v80, v80
    v_exp_f32 v81, v81
    v_exp_f32 v82, v82
    v_smfmac_f32_32x32x32_bf16 v[160:175], v[36:39], v[72:79], v6
    v_exp_f32 v83, v83
    v_exp_f32 v84, v84
    v_exp_f32 v85, v85
    v_mfma_f32_32x32x16_bf16 v[64:79], v[28:31], v[112:115], 0
    ds_write_b128 v16, v[148:151] offset:3072
    v_exp_f32 v86, v86
    v_exp_f32 v87, v87
    v_exp_f32 v88, v88
    v_exp_f32 v89, v89
    v_exp_f32 v90, v90
    v_exp_f32 v91, v91
    v_exp_f32 v92, v92
    v_exp_f32 v93, v93
    v_exp_f32 v94, v94
    v_exp_f32 v95, v95
    v_smfmac_f32_32x32x32_bf16 v[176:191], v[32:35], v[80:87], v6
    ds_write_b32 v20, v168 offset:0
    ds_write_b128 v17, v[160:163] offset:0
    v_exp_f32 v64, v64
    v_exp_f32 v65, v65
    v_exp_f32 v66, v66
    v_smfmac_f32_32x32x32_bf16 v[176:191], v[36:39], v[88:95], v6
    v_exp_f32 v67, v67
    v_exp_f32 v68, v68
    v_exp_f32 v69, v69
    v_mfma_f32_32x32x16_bf16 v[80:95], v[28:31], v[116:119], 0
    ds_write_b128 v17, v[164:167] offset:1024
    v_exp_f32 v70, v70
    v_exp_f32 v71, v71
    v_exp_f32 v72, v72
    v_exp_f32 v73, v73
    v_exp_f32 v74, v74
    v_exp_f32 v75, v75
    v_exp_f32 v76, v76
    v_exp_f32 v77, v77
    v_exp_f32 v78, v78
    v_exp_f32 v79, v79
    v_smfmac_f32_32x32x32_bf16 v[192:207], v[32:35], v[64:71], v6
    ds_write_b32 v20, v184 offset:256
    ds_write_b128 v17, v[176:179] offset:2048
    v_exp_f32 v80, v80
    v_exp_f32 v81, v81
    v_exp_f32 v82, v82
    v_smfmac_f32_32x32x32_bf16 v[192:207], v[36:39], v[72:79], v6
    v_exp_f32 v83, v83
    v_exp_f32 v84, v84
    v_exp_f32 v85, v85
    v_mfma_f32_32x32x16_bf16 v[64:79], v[28:31], v[120:123], 0
    ds_write_b128 v17, v[180:183] offset:3072
    v_exp_f32 v86, v86
    v_exp_f32 v87, v87
    v_exp_f32 v88, v88
    v_exp_f32 v89, v89
    v_exp_f32 v90, v90
    v_exp_f32 v91, v91
    v_exp_f32 v92, v92
    v_exp_f32 v93, v93
    v_exp_f32 v94, v94
    v_exp_f32 v95, v95
    v_smfmac_f32_32x32x32_bf16 v[208:223], v[32:35], v[80:87], v6
    ds_write_b32 v21, v200 offset:0
    ds_write_b128 v18, v[192:195] offset:0
    v_exp_f32 v64, v64
    v_exp_f32 v65, v65
    v_exp_f32 v66, v66
    v_smfmac_f32_32x32x32_bf16 v[208:223], v[36:39], v[88:95], v6
    v_exp_f32 v67, v67
    v_exp_f32 v68, v68
    v_exp_f32 v69, v69
    v_mfma_f32_32x32x16_bf16 v[80:95], v[28:31], v[124:127], 0
    ds_write_b128 v18, v[196:199] offset:1024
    v_exp_f32 v70, v70
    v_exp_f32 v71, v71
    v_exp_f32 v72, v72
    v_exp_f32 v73, v73
    v_exp_f32 v74, v74
    v_exp_f32 v75, v75
    v_exp_f32 v76, v76
    v_exp_f32 v77, v77
    v_exp_f32 v78, v78
    v_exp_f32 v79, v79
    v_smfmac_f32_32x32x32_bf16 v[224:239], v[32:35], v[64:71], v6
    ds_write_b32 v21, v216 offset:256
    ds_write_b128 v18, v[208:211] offset:2048
    v_exp_f32 v80, v80
    v_exp_f32 v81, v81
    v_exp_f32 v82, v82
    v_smfmac_f32_32x32x32_bf16 v[224:239], v[36:39], v[72:79], v6
    ds_write_b128 v18, v[212:215] offset:3072
    s_mov_b64 exec, 1
    ds_add_u32 v11, v12 offset:16
    s_mov_b64 exec, -1
    v_exp_f32 v83, v83
    v_exp_f32 v84, v84
    v_exp_f32 v85, v85
    v_exp_f32 v86, v86
    v_exp_f32 v87, v87
    v_exp_f32 v88, v88
    v_exp_f32 v89, v89
    v_smfmac_f32_32x32x32_bf16 v[240:255], v[32:35], v[80:87], v6
    ds_read_b32 v5, v11 offset:16
    v_exp_f32 v90, v90
    v_exp_f32 v91, v91
    v_exp_f32 v92, v92
    v_exp_f32 v93, v93
    v_exp_f32 v94, v94
    v_exp_f32 v95, v95
    s_mov_b32 s64, 0x30800000
    s_mov_b32 s65, 0x71800000
    v_smfmac_f32_32x32x32_bf16 v[240:255], v[36:39], v[88:95], v6
    s_waitcnt lgkmcnt(0)
    v_cmp_ne_u32 vcc, 4, v5
    s_cbranch_vccz L_spun_a
    s_mov_b32 s84, 1600000
L_spin_a:
    ds_read_b32 v5, v11 offset:16
    s_waitcnt lgkmcnt(0)
    v_cmp_ne_u32 vcc, 4, v5
    s_cbranch_vccz L_spun_a
    s_sub_u32 s84, s84, 1
    s_cmp_lg_u32 s84, 0
    s_cbranch_scc1 L_spin_a
L_spun_a:
    s_setprio 3
    ds_read_b32 v5, v11 offset:20
    ds_read_b32 v136, v23 offset:0
    ds_read_b128 v[128:131], v22 offset:0
    ds_read_b128 v[132:135], v22 offset:1024
    ds_read_b32 v160, v23 offset:512
    ds_read_b128 v[152:155], v22 offset:4096
    ds_read_b128 v[156:159], v22 offset:5120
    ds_read_b32 v184, v23 offset:1024
    ds_read_b128 v[176:179], v22 offset:8192
    ds_read_b128 v[180:183], v22 offset:9216
    ds_read_b32 v148, v23 offset:256
    ds_read_b128 v[140:143], v22 offset:2048
    ds_read_b128 v[144:147], v22 offset:3072
    ds_read_b32 v172, v23 offset:768
    ds_read_b128 v[164:167], v22 offset:6144
    ds_read_b128 v[168:171], v22 offset:7168
    ds_read_b32 v196, v23 offset:1280
    ds_read_b128 v[188:191], v22 offset:10240
    ds_read_b128 v[192:195], v22 offset:11264
    s_waitcnt lgkmcnt(14)
    v_add_f32 v232, v232, v136
    v_add_f32 v224, v224, v128
    v_add_f32 v225, v225, v129
    v_add_f32 v226, v226, v130
    v_add_f32 v227, v227, v131
    v_add_f32 v228, v228, v132
    v_add_f32 v229, v229, v133
    v_add_f32 v230, v230, v134
    v_add_f32 v231, v231, v135
    s_waitcnt lgkmcnt(12)
    v_add_f32 v232, v232, v160
    v_add_f32 v224, v224, v152
    v_add_f32 v225, v225, v153
    v_add_f32 v226, v226, v154
    v_add_f32 v227, v227, v155
    v_add_f32 v228, v228, v156
    v_add_f32 v229, v229, v157
    v_add_f32 v230, v230, v158
    v_add_f32 v231, v231, v159
    s_waitcnt lgkmcnt(9)
    v_add_f32 v232, v232, v184
    v_add_f32 v224, v224, v176
    v_add_f32 v225, v225, v177
    v_add_f32 v226, v226, v178
    v_add_f32 v227, v227, v179
    v_add_f32 v228, v228, v180
    v_add_f32 v229, v229, v181
    v_add_f32 v230, v230, v182
    v_add_f32 v231, v231, v183
    v_rcp_f32 v72, v232
    s_cmp_lg_u32 s49, 0
    v_mul_f32 v64, v224, v72
    v_mul_f32 v65, v225, v72
    v_mul_f32 v66, v226, v72
    v_mul_f32 v67, v227, v72
    v_mul_f32 v68, v228, v72
    v_mul_f32 v69, v229, v72
    v_mul_f32 v70, v230, v72
    v_mul_f32 v71, v231, v72
    v_cvt_pk_bf16_f32 v76, v64, v65
    v_cvt_pk_bf16_f32 v77, v66, v67
    v_cvt_pk_bf16_f32 v78, v68, v69
    v_cvt_pk_bf16_f32 v79, v70, v71
    buffer_store_dwordx4 v[76:79], v7, s[44:47], s72 offen offset:0 sc1
    s_waitcnt lgkmcnt(6)
    v_add_f32 v248, v248, v148
    v_add_f32 v240, v240, v140
    v_add_f32 v241, v241, v141
    v_add_f32 v242, v242, v142
    v_add_f32 v243, v243, v143
    v_add_f32 v244, v244, v144
    v_add_f32 v245, v245, v145
    v_add_f32 v246, v246, v146
    v_add_f32 v247, v247, v147
    s_waitcnt lgkmcnt(3)
    v_add_f32 v248, v248, v172
    v_add_f32 v240, v240, v164
    v_add_f32 v241, v241, v165
    v_add_f32 v242, v242, v166
    v_add_f32 v243, v243, v167
    v_add_f32 v244, v244, v168
    v_add_f32 v245, v245, v169
    v_add_f32 v246, v246, v170
    v_add_f32 v247, v247, v171
    s_waitcnt lgkmcnt(0)
    v_add_f32 v248, v248, v196
    s_mov_b64 exec, 1
    ds_add_u32 v11, v12 offset:24
    s_mov_b64 exec, -1
    v_add_f32 v240, v240, v188
    v_add_f32 v241, v241, v189
    v_add_f32 v242, v242, v190
    v_add_f32 v243, v243, v191
    v_add_f32 v244, v244, v192
    v_add_f32 v245, v245, v193
    v_add_f32 v246, v246, v194
    v_add_f32 v247, v247, v195
    v_rcp_f32 v88, v248
    s_cmp_lg_u32 s49, 0
    v_mul_f32 v80, v240, v88
    v_mul_f32 v81, v241, v88
    v_mul_f32 v82, v242, v88
    v_mul_f32 v83, v243, v88
    v_mul_f32 v84, v244, v88
    v_mul_f32 v85, v245, v88
    v_mul_f32 v86, v246, v88
    v_mul_f32 v87, v247, v88
    v_cvt_pk_bf16_f32 v92, v80, v81
    v_cvt_pk_bf16_f32 v93, v82, v83
    v_cvt_pk_bf16_f32 v94, v84, v85
    v_cvt_pk_bf16_f32 v95, v86, v87
    buffer_store_dwordx4 v[92:95], v7, s[44:47], s72 offen offset:1024 sc1
    v_maximum3_f32 v52, v232, |v224|, v232
    v_maximum3_f32 v52, v52, |v225|, |v226|
    v_maximum3_f32 v52, v52, |v227|, |v228|
    v_maximum3_f32 v52, v52, |v229|, |v230|
    v_maximum3_f32 v52, v52, |v240|, v248
    v_maximum3_f32 v52, v52, |v241|, |v242|
    v_maximum3_f32 v52, v52, |v243|, |v244|
    v_maximum3_f32 v52, v52, |v245|, |v246|
    v_maximum3_f32 v52, v52, |v231|, |v247|
    v_min_f32 v53, v232, v248
    v_cmp_nge_f32 s[66:67], s65, v52
    v_cmp_nle_f32 vcc, s64, v53
    s_nop 1
    s_or_b64 s[66:67], s[66:67], vcc
    s_cbranch_scc1 L_slow
L_safe:
    v_xor_b32 v2, 32, v0
    v_xor_b32 v3, 64, v0
    v_xor_b32 v6, 0x60, v0
    v_add_u32 v9, 4096, v4
    v_cmp_ne_u32 vcc, 4, v5
    s_cbranch_vccz L_spun_w
    s_mov_b32 s84, 1600000
L_spin_w:
    ds_read_b32 v5, v11 offset:20
    s_waitcnt lgkmcnt(0)
    v_cmp_ne_u32 vcc, 4, v5
    s_cbranch_vccz L_spun_w
    s_sub_u32 s84, s84, 1
    s_cmp_lg_u32 s84, 0
    s_cbranch_scc1 L_spin_w
L_spun_w:
    s_waitcnt vmcnt(0)
    s_mov_b64 exec, 1
    s_cmp_lg_u32 s49, 0
    s_cbranch_scc0 L_g1
    buffer_store_dword v27, v13, s[44:47], s83 offen
L_b1:
    s_mov_b64 exec, -1
    v_lshlrev_b32 v96, 16, v40
    v_and_b32 v97, 0xffff0000, v40
    v_lshlrev_b32 v98, 16, v41
    v_and_b32 v99, 0xffff0000, v41
    v_lshlrev_b32 v100, 16, v42
    v_and_b32 v101, 0xffff0000, v42
    v_lshlrev_b32 v102, 16, v43
    v_and_b32 v103, 0xffff0000, v43
    v_lshlrev_b32 v104, 16, v44
    v_and_b32 v105, 0xffff0000, v44
    v_lshlrev_b32 v106, 16, v45
    v_and_b32 v107, 0xffff0000, v45
    v_lshlrev_b32 v108, 16, v46
    v_and_b32 v109, 0xffff0000, v46
    v_lshlrev_b32 v110, 16, v47
    v_and_b32 v111, 0xffff0000, v47
    s_cmp_lg_u32 s6, 0
    s_cbranch_scc1 L_nopoll
    buffer_load_dword v5, v10, s[44:47], 0 offen sc1
    ds_read_b64_tr_b16 v[112:113], v0 offset:0
    ds_read_b64_tr_b16 v[114:115], v0 offset:1024
    ds_read_b64_tr_b16 v[116:117], v2 offset:0
    ds_read_b64_tr_b16 v[118:119], v2 offset:1024
    ds_read_b64_tr_b16 v[120:121], v3 offset:0
    ds_read_b64_tr_b16 v[122:123], v3 offset:1024
    ds_read_b64_tr_b16 v[124:125], v6 offset:0
    ds_read_b64_tr_b16 v[126:127], v6 offset:1024
    ds_read_b64_tr_b16 v[128:129], v0 offset:4096
    ds_read_b64_tr_b16 v[130:131], v0 offset:5120
    ds_read_b64_tr_b16 v[132:133], v2 offset:4096
    ds_read_b64_tr_b16 v[134:135], v2 offset:5120
    ds_read_b64_tr_b16 v[136:137], v3 offset:4096
    ds_read_b64_tr_b16 v[138:139], v3 offset:5120
    ds_read_b64_tr_b16 v[140:141], v6 offset:4096
    ds_read_b64_tr_b16 v[142:143], v6 offset:5120
    s_waitcnt vmcnt(0)
    v_cmp_ne_u32 vcc, s7, v5
    s_cbranch_vccz L_done_o
    s_mov_b32 s84, 400000
L_poll_o:
    buffer_load_dword v5, v10, s[44:47], 0 offen sc1
    s_waitcnt vmcnt(0)
    v_cmp_ne_u32 vcc, s7, v5
    s_cbranch_vccz L_done_o
    s_sleep 1
    s_sub_u32 s84, s84, 1
    s_cmp_lg_u32 s84, 0
    s_cbranch_scc1 L_poll_o
L_done_o:
    s_mov_b64 exec, 1
    ds_add_u32 v11, v12 offset:40
    s_mov_b64 exec, -1
    s_branch L_spun_o
L_nopoll:
    ds_read_b64_tr_b16 v[112:113], v0 offset:0
    ds_read_b64_tr_b16 v[114:115], v0 offset:1024
    ds_read_b64_tr_b16 v[116:117], v2 offset:0
    ds_read_b64_tr_b16 v[118:119], v2 offset:1024
    ds_read_b64_tr_b16 v[120:121], v3 offset:0
    ds_read_b64_tr_b16 v[122:123], v3 offset:1024
    ds_read_b64_tr_b16 v[124:125], v6 offset:0
    ds_read_b64_tr_b16 v[126:127], v6 offset:1024
    ds_read_b64_tr_b16 v[128:129], v0 offset:4096
    ds_read_b64_tr_b16 v[130:131], v0 offset:5120
    ds_read_b64_tr_b16 v[132:133], v2 offset:4096
    ds_read_b64_tr_b16 v[134:135], v2 offset:5120
    ds_read_b64_tr_b16 v[136:137], v3 offset:4096
    ds_read_b64_tr_b16 v[138:139], v3 offset:5120
    ds_read_b64_tr_b16 v[140:141], v6 offset:4096
    ds_read_b64_tr_b16 v[142:143], v6 offset:5120
    s_mov_b32 s84, 1600000
L_spin_o:
    ds_read_b32 v5, v11 offset:40
    s_waitcnt lgkmcnt(0)
    v_cmp_ne_u32 vcc, 1, v5
    s_cbranch_vccz L_spun_o
    s_sub_u32 s84, s84, 1
    s_cmp_lg_u32 s84, 0
    s_cbranch_scc1 L_spin_o
L_spun_o:
    s_setprio 1
    buffer_load_dwordx4 v[16:19], v4, s[44:47], s74 offen sc1
    buffer_load_dwordx4 v[20:23], v9, s[44:47], s74 offen sc1
    buffer_load_dwordx4 v[24:27], v4, s[44:47], s75 offen sc1
    buffer_load_dwordx4 v[28:31], v9, s[44:47], s75 offen sc1
    ds_read_b64_tr_b16 v[144:145], v0 offset:8192
    ds_read_b64_tr_b16 v[146:147], v0 offset:9216
    ds_read_b64_tr_b16 v[148:149], v2 offset:8192
    ds_read_b64_tr_b16 v[150:151], v2 offset:9216
    ds_read_b64_tr_b16 v[152:153], v3 offset:8192
    ds_read_b64_tr_b16 v[154:155], v3 offset:9216
    ds_read_b64_tr_b16 v[156:157], v6 offset:8192
    ds_read_b64_tr_b16 v[158:159], v6 offset:9216
    buffer_load_dwordx4 v[32:35], v4, s[44:47], s76 offen sc1
    ds_read_b64_tr_b16 v[160:161], v0 offset:12288
    ds_read_b64_tr_b16 v[162:163], v0 offset:13312
    ds_read_b64_tr_b16 v[164:165], v2 offset:12288
    ds_read_b64_tr_b16 v[166:167], v2 offset:13312
    ds_read_b64_tr_b16 v[168:169], v3 offset:12288
    ds_read_b64_tr_b16 v[170:171], v3 offset:13312
    ds_read_b64_tr_b16 v[172:173], v6 offset:12288
    ds_read_b64_tr_b16 v[174:175], v6 offset:13312
    buffer_load_dwordx4 v[36:39], v9, s[44:47], s76 offen sc1
    ds_read_b64_tr_b16 v[176:177], v0 offset:16384
    ds_read_b64_tr_b16 v[178:179], v0 offset:17408
    ds_read_b64_tr_b16 v[180:181], v2 offset:16384
    ds_read_b64_tr_b16 v[182:183], v2 offset:17408
    ds_read_b64_tr_b16 v[184:185], v3 offset:16384
    ds_read_b64_tr_b16 v[186:187], v3 offset:17408
    ds_read_b64_tr_b16 v[188:189], v6 offset:16384
    ds_read_b64_tr_b16 v[190:191], v6 offset:17408
    buffer_load_dwordx4 v[40:43], v4, s[44:47], s77 offen sc1
    ds_read_b64_tr_b16 v[192:193], v0 offset:20480
    ds_read_b64_tr_b16 v[194:195], v0 offset:21504
    ds_read_b64_tr_b16 v[196:197], v2 offset:20480
    ds_read_b64_tr_b16 v[198:199], v2 offset:21504
    ds_read_b64_tr_b16 v[200:201], v3 offset:20480
    ds_read_b64_tr_b16 v[202:203], v3 offset:21504
    ds_read_b64_tr_b16 v[204:205], v6 offset:20480
    ds_read_b64_tr_b16 v[206:207], v6 offset:21504
    buffer_load_dwordx4 v[44:47], v9, s[44:47], s77 offen sc1
    ds_read_b64_tr_b16 v[208:209], v0 offset:24576
    ds_read_b64_tr_b16 v[210:211], v0 offset:25600
    ds_read_b64_tr_b16 v[212:213], v2 offset:24576
    ds_read_b64_tr_b16 v[214:215], v2 offset:25600
    ds_read_b64_tr_b16 v[216:217], v3 offset:24576
    ds_read_b64_tr_b16 v[218:219], v3 offset:25600
    ds_read_b64_tr_b16 v[220:221], v6 offset:24576
    ds_read_b64_tr_b16 v[222:223], v6 offset:25600
    buffer_load_dwordx4 v[48:51], v4, s[44:47], s78 offen sc1
    ds_read_b64_tr_b16 v[224:225], v0 offset:28672
    ds_read_b64_tr_b16 v[226:227], v0 offset:29696
    ds_read_b64_tr_b16 v[228:229], v2 offset:28672
    ds_read_b64_tr_b16 v[230:231], v2 offset:29696
    ds_read_b64_tr_b16 v[232:233], v3 offset:28672
    ds_read_b64_tr_b16 v[234:235], v3 offset:29696
    ds_read_b64_tr_b16 v[236:237], v6 offset:28672
    ds_read_b64_tr_b16 v[238:239], v6 offset:29696
    buffer_load_dwordx4 v[52:55], v9, s[44:47], s78 offen sc1
    ds_read_b64_tr_b16 v[240:241], v0 offset:32768
    ds_read_b64_tr_b16 v[242:243], v0 offset:33792
    ds_read_b64_tr_b16 v[244:245], v2 offset:32768
    ds_read_b64_tr_b16 v[246:247], v2 offset:33792
    ds_read_b64_tr_b16 v[248:249], v3 offset:32768
    ds_read_b64_tr_b16 v[250:251], v3 offset:33792
    ds_read_b64_tr_b16 v[252:253], v6 offset:32768
    ds_read_b64_tr_b16 v[254:255], v6 offset:33792
    s_waitcnt vmcnt(9) lgkmcnt(14)
    v_mfma_f32_16x16x32_bf16 v[80:83], v[112:115], v[16:19], 0
    buffer_load_dwordx4 v[56:59], v4, s[44:47], s79 offen sc1
    v_mfma_f32_16x16x32_bf16 v[84:87], v[116:119], v[16:19], 0
    v_mfma_f32_16x16x32_bf16 v[88:91], v[120:123], v[16:19], 0
    v_mfma_f32_16x16x32_bf16 v[92:95], v[124:127], v[16:19], 0
    s_waitcnt vmcnt(9)
    v_mfma_f32_16x16x32_bf16 v[80:83], v[128:131], v[20:23], v[80:83]
    buffer_load_dwordx4 v[60:63], v9, s[44:47], s79 offen sc1
    ds_read_b64_tr_b16 v[112:113], v0 offset:36864
    v_mfma_f32_16x16x32_bf16 v[84:87], v[132:135], v[20:23], v[84:87]
    ds_read_b64_tr_b16 v[114:115], v0 offset:37888
    ds_read_b64_tr_b16 v[116:117], v2 offset:36864
    v_mfma_f32_16x16x32_bf16 v[88:91], v[136:139], v[20:23], v[88:91]
    ds_read_b64_tr_b16 v[118:119], v2 offset:37888
    ds_read_b64_tr_b16 v[120:121], v3 offset:36864
    v_mfma_f32_16x16x32_bf16 v[92:95], v[140:143], v[20:23], v[92:95]
    s_waitcnt vmcnt(9)
    v_mfma_f32_16x16x32_bf16 v[80:83], v[144:147], v[24:27], v[80:83]
    buffer_load_dwordx4 v[64:67], v4, s[44:47], s80 offen sc1
    ds_read_b64_tr_b16 v[122:123], v3 offset:37888
    v_mfma_f32_16x16x32_bf16 v[84:87], v[148:151], v[24:27], v[84:87]
    ds_read_b64_tr_b16 v[124:125], v6 offset:36864
    ds_read_b64_tr_b16 v[126:127], v6 offset:37888
    v_mfma_f32_16x16x32_bf16 v[88:91], v[152:155], v[24:27], v[88:91]
    ds_read_b64_tr_b16 v[128:129], v0 offset:40960
    ds_read_b64_tr_b16 v[130:131], v0 offset:41984
    v_mfma_f32_16x16x32_bf16 v[92:95], v[156:159], v[24:27], v[92:95]
    s_waitcnt vmcnt(9)
    v_mfma_f32_16x16x32_bf16 v[80:83], v[160:163], v[28:31], v[80:83]
    buffer_load_dwordx4 v[68:71], v9, s[44:47], s80 offen sc1
    ds_read_b64_tr_b16 v[132:133], v2 offset:40960
    v_mfma_f32_16x16x32_bf16 v[84:87], v[164:167], v[28:31], v[84:87]
    ds_read_b64_tr_b16 v[134:135], v2 offset:41984
    ds_read_b64_tr_b16 v[136:137], v3 offset:40960
    v_mfma_f32_16x16x32_bf16 v[88:91], v[168:171], v[28:31], v[88:91]
    ds_read_b64_tr_b16 v[138:139], v3 offset:41984
    ds_read_b64_tr_b16 v[140:141], v6 offset:40960
    v_mfma_f32_16x16x32_bf16 v[92:95], v[172:175], v[28:31], v[92:95]
    s_waitcnt vmcnt(9)
    v_mfma_f32_16x16x32_bf16 v[80:83], v[176:179], v[32:35], v[80:83]
    buffer_load_dwordx4 v[72:75], v4, s[44:47], s81 offen sc1
    ds_read_b64_tr_b16 v[142:143], v6 offset:41984
    v_mfma_f32_16x16x32_bf16 v[84:87], v[180:183], v[32:35], v[84:87]
    ds_read_b64_tr_b16 v[144:145], v0 offset:45056
    ds_read_b64_tr_b16 v[146:147], v0 offset:46080
    v_mfma_f32_16x16x32_bf16 v[88:91], v[184:187], v[32:35], v[88:91]
    ds_read_b64_tr_b16 v[148:149], v2 offset:45056
    ds_read_b64_tr_b16 v[150:151], v2 offset:46080
    v_mfma_f32_16x16x32_bf16 v[92:95], v[188:191], v[32:35], v[92:95]
    s_waitcnt vmcnt(9)
    v_mfma_f32_16x16x32_bf16 v[80:83], v[192:195], v[36:39], v[80:83]
    buffer_load_dwordx4 v[76:79], v9, s[44:47], s81 offen sc1
    ds_read_b64_tr_b16 v[152:153], v3 offset:45056
    v_mfma_f32_16x16x32_bf16 v[84:87], v[196:199], v[36:39], v[84:87]
    ds_read_b64_tr_b16 v[154:155], v3 offset:46080
    ds_read_b64_tr_b16 v[156:157], v6 offset:45056
    v_mfma_f32_16x16x32_bf16 v[88:91], v[200:203], v[36:39], v[88:91]
    ds_read_b64_tr_b16 v[158:159], v6 offset:46080
    ds_read_b64_tr_b16 v[160:161], v0 offset:49152
    v_mfma_f32_16x16x32_bf16 v[92:95], v[204:207], v[36:39], v[92:95]
    s_waitcnt vmcnt(9)
    v_mfma_f32_16x16x32_bf16 v[80:83], v[208:211], v[40:43], v[80:83]
    ds_read_b64_tr_b16 v[162:163], v0 offset:50176
    ds_read_b64_tr_b16 v[164:165], v2 offset:49152
    v_mfma_f32_16x16x32_bf16 v[84:87], v[212:215], v[40:43], v[84:87]
    ds_read_b64_tr_b16 v[166:167], v2 offset:50176
    ds_read_b64_tr_b16 v[168:169], v3 offset:49152
    v_mfma_f32_16x16x32_bf16 v[88:91], v[216:219], v[40:43], v[88:91]
    ds_read_b64_tr_b16 v[170:171], v3 offset:50176
    ds_read_b64_tr_b16 v[172:173], v6 offset:49152
    v_mfma_f32_16x16x32_bf16 v[92:95], v[220:223], v[40:43], v[92:95]
    s_waitcnt vmcnt(8) lgkmcnt(14)
    v_mfma_f32_16x16x32_bf16 v[80:83], v[224:227], v[44:47], v[80:83]
    ds_read_b64_tr_b16 v[174:175], v6 offset:50176
    ds_read_b64_tr_b16 v[176:177], v0 offset:53248
    v_mfma_f32_16x16x32_bf16 v[84:87], v[228:231], v[44:47], v[84:87]
    ds_read_b64_tr_b16 v[178:179], v0 offset:54272
    ds_read_b64_tr_b16 v[180:181], v2 offset:53248
    v_mfma_f32_16x16x32_bf16 v[88:91], v[232:235], v[44:47], v[88:91]
    ds_read_b64_tr_b16 v[182:183], v2 offset:54272
    ds_read_b64_tr_b16 v[184:185], v3 offset:53248
    v_mfma_f32_16x16x32_bf16 v[92:95], v[236:239], v[44:47], v[92:95]
    s_waitcnt vmcnt(7)
    v_mfma_f32_16x16x32_bf16 v[80:83], v[240:243], v[48:51], v[80:83]
    ds_read_b64_tr_b16 v[186:187], v3 offset:54272
    ds_read_b64_tr_b16 v[188:189], v6 offset:53248
    v_mfma_f32_16x16x32_bf16 v[84:87], v[244:247], v[48:51], v[84:87]
    ds_read_b64_tr_b16 v[190:191], v6 offset:54272
    ds_read_b64_tr_b16 v[192:193], v0 offset:57344
    v_mfma_f32_16x16x32_bf16 v[88:91], v[248:251], v[48:51], v[88:91]
    ds_read_b64_tr_b16 v[194:195], v0 offset:58368
    ds_read_b64_tr_b16 v[196:197], v2 offset:57344
    v_mfma_f32_16x16x32_bf16 v[92:95], v[252:255], v[48:51], v[92:95]
    s_waitcnt vmcnt(6)
    v_mfma_f32_16x16x32_bf16 v[80:83], v[112:115], v[52:55], v[80:83]
    ds_read_b64_tr_b16 v[198:199], v2 offset:58368
    ds_read_b64_tr_b16 v[200:201], v3 offset:57344
    v_mfma_f32_16x16x32_bf16 v[84:87], v[116:119], v[52:55], v[84:87]
    ds_read_b64_tr_b16 v[202:203], v3 offset:58368
    ds_read_b64_tr_b16 v[204:205], v6 offset:57344
    v_mfma_f32_16x16x32_bf16 v[88:91], v[120:123], v[52:55], v[88:91]
    ds_read_b64_tr_b16 v[206:207], v6 offset:58368
    ds_read_b64_tr_b16 v[208:209], v0 offset:61440
    v_mfma_f32_16x16x32_bf16 v[92:95], v[124:127], v[52:55], v[92:95]
    s_waitcnt vmcnt(5)
    v_mfma_f32_16x16x32_bf16 v[80:83], v[128:131], v[56:59], v[80:83]
    ds_read_b64_tr_b16 v[210:211], v0 offset:62464
    ds_read_b64_tr_b16 v[212:213], v2 offset:61440
    v_mfma_f32_16x16x32_bf16 v[84:87], v[132:135], v[56:59], v[84:87]
    ds_read_b64_tr_b16 v[214:215], v2 offset:62464
    ds_read_b64_tr_b16 v[216:217], v3 offset:61440
    v_mfma_f32_16x16x32_bf16 v[88:91], v[136:139], v[56:59], v[88:91]
    ds_read_b64_tr_b16 v[218:219], v3 offset:62464
    ds_read_b64_tr_b16 v[220:221], v6 offset:61440
    v_mfma_f32_16x16x32_bf16 v[92:95], v[140:143], v[56:59], v[92:95]
    s_waitcnt vmcnt(4) lgkmcnt(14)
    v_mfma_f32_16x16x32_bf16 v[80:83], v[144:147], v[60:63], v[80:83]
    ds_read_b64_tr_b16 v[222:223], v6 offset:62464
    v_mfma_f32_16x16x32_bf16 v[84:87], v[148:151], v[60:63], v[84:87]
    v_mfma_f32_16x16x32_bf16 v[88:91], v[152:155], v[60:63], v[88:91]
    v_mfma_f32_16x16x32_bf16 v[92:95], v[156:159], v[60:63], v[92:95]
    s_waitcnt vmcnt(3)
    v_mfma_f32_16x16x32_bf16 v[80:83], v[160:163], v[64:67], v[80:83]
    v_mfma_f32_16x16x32_bf16 v[84:87], v[164:167], v[64:67], v[84:87]
    v_mfma_f32_16x16x32_bf16 v[88:91], v[168:171], v[64:67], v[88:91]
    v_mfma_f32_16x16x32_bf16 v[92:95], v[172:175], v[64:67], v[92:95]
    s_waitcnt vmcnt(2)
    v_mfma_f32_16x16x32_bf16 v[80:83], v[176:179], v[68:71], v[80:83]
    s_barrier
    ds_read_b128 v[224:227], v14 offset:0
    v_mfma_f32_16x16x32_bf16 v[84:87], v[180:183], v[68:71], v[84:87]
    ds_read_b128 v[228:231], v14 offset:64
    ds_read_b128 v[232:235], v14 offset:128
    v_mfma_f32_16x16x32_bf16 v[88:91], v[184:187], v[68:71], v[88:91]
    ds_read_b128 v[236:239], v14 offset:192
    v_mfma_f32_16x16x32_bf16 v[92:95], v[188:191], v[68:71], v[92:95]
    s_waitcnt vmcnt(1) lgkmcnt(12)
    v_mfma_f32_16x16x32_bf16 v[80:83], v[192:195], v[72:75], v[80:83]
    v_mfma_f32_16x16x32_bf16 v[84:87], v[196:199], v[72:75], v[84:87]
    v_mfma_f32_16x16x32_bf16 v[88:91], v[200:203], v[72:75], v[88:91]
    v_mfma_f32_16x16x32_bf16 v[92:95], v[204:207], v[72:75], v[92:95]
    s_waitcnt vmcnt(0) lgkmcnt(4)
    v_mfma_f32_16x16x32_bf16 v[80:83], v[208:211], v[76:79], v[80:83]
    v_mfma_f32_16x16x32_bf16 v[84:87], v[212:215], v[76:79], v[84:87]
    v_mfma_f32_16x16x32_bf16 v[88:91], v[216:219], v[76:79], v[88:91]
    v_mfma_f32_16x16x32_bf16 v[92:95], v[220:223], v[76:79], v[92:95]
    s_waitcnt lgkmcnt(0)
    s_nop 3
    v_pk_fma_f32 v[96:97], v[80:81], v[224:225], v[96:97]
    v_pk_fma_f32 v[98:99], v[82:83], v[226:227], v[98:99]
    v_pk_fma_f32 v[100:101], v[84:85], v[228:229], v[100:101]
    v_pk_fma_f32 v[102:103], v[86:87], v[230:231], v[102:103]
    v_cvt_pk_bf16_f32 v32, v96, v97
    v_cvt_pk_bf16_f32 v33, v98, v99
    v_cvt_pk_bf16_f32 v34, v100, v101
    v_cvt_pk_bf16_f32 v35, v102, v103
    s_nop 0
    v_permlane16_swap_b32 v32, v34
    v_permlane16_swap_b32 v33, v35
    buffer_store_dwordx4 v[32:35], v8, s[40:43], s86 offen offset:0 sc1
    v_pk_fma_f32 v[104:105], v[88:89], v[232:233], v[104:105]
    v_pk_fma_f32 v[106:107], v[90:91], v[234:235], v[106:107]
    v_pk_fma_f32 v[108:109], v[92:93], v[236:237], v[108:109]
    v_pk_fma_f32 v[110:111], v[94:95], v[238:239], v[110:111]
    v_cvt_pk_bf16_f32 v36, v104, v105
    v_cvt_pk_bf16_f32 v37, v106, v107
    v_cvt_pk_bf16_f32 v38, v108, v109
    v_cvt_pk_bf16_f32 v39, v110, v111
    s_nop 0
    v_permlane16_swap_b32 v36, v38
    v_permlane16_swap_b32 v37, v39
    buffer_store_dwordx4 v[36:39], v8, s[40:43], s86 offen offset:64 sc1
    s_or_b32 s60, s2, s3
    s_cmp_lg_u32 s60, 0
    s_cbranch_scc1 L_noepoch
    v_mov_b32 v5, s7
    s_mov_b64 exec, 1
    buffer_store_dword v5, v13, s[44:47], 0 offen sc1
    s_mov_b64 exec, -1
L_noepoch:
    s_endpgm
L_kva:
    s_mov_b64 exec, s[36:37]
    s_mov_b32 s84, 400000
L_poll_kva:
    buffer_load_dword v5, v3, s[44:47], 0 offen sc1
    s_waitcnt vmcnt(0)
    v_cmp_ne_u32 vcc, s7, v5
    s_cbranch_vccz L_done_kva
    s_sleep 1
    s_sub_u32 s84, s84, 1
    s_cmp_lg_u32 s84, 0
    s_cbranch_scc1 L_poll_kva
L_done_kva:
    s_mov_b64 exec, -1
    s_branch L_kva_ok
L_kvb:
    s_mov_b32 s84, 400000
L_poll_kv1:
    buffer_load_dword v5, v3, s[44:47], 0 offen sc1
    s_waitcnt vmcnt(0)
    v_cmp_ne_u32 vcc, s7, v5
    s_cbranch_vccz L_done_kv1
    s_sleep 4
    s_sub_u32 s84, s84, 1
    s_cmp_lg_u32 s84, 0
    s_cbranch_scc1 L_poll_kv1
L_done_kv1:
    s_branch L_kvb_ok
L_xa:
    s_mov_b32 s84, 1600000
L_spin_xa:
    ds_read_b32 v48, v11 offset:8
    s_waitcnt lgkmcnt(0)
    v_cmp_ne_u32 vcc, 4, v48
    s_cbranch_vccz L_spun_xa
    s_sub_u32 s84, s84, 1
    s_cmp_lg_u32 s84, 0
    s_cbranch_scc1 L_spin_xa
L_spun_xa:
    s_branch L_xa_ok
L_slow:
    s_waitcnt vmcnt(0) lgkmcnt(0)
    s_lshl_b32 s64, s6, 16
    v_subrev_u32 v9, s64, v9
    v_subrev_u32 v24, s64, v24
    v_subrev_u32 v25, s64, v25
    v_mov_b32 v52, 0xff800000
    v_mov_b32 v53, 0xff800000
    s_mov_b32 s85, 0
    s_mov_b32 s89, 64
L_slow1:
    buffer_load_dwordx4 v[28:31], v9, s[44:47], s85 offen sc1
    s_add_u32 s85, s85, 4096
    s_waitcnt vmcnt(0)
    v_mfma_f32_32x32x16_bf16 v[64:79], v[28:31], v[120:123], 0
    v_mfma_f32_32x32x16_bf16 v[80:95], v[28:31], v[124:127], 0
    s_nop 15
    v_max3_f32 v52, v52, v64, v65
    v_max3_f32 v52, v52, v66, v67
    v_max3_f32 v52, v52, v68, v69
    v_max3_f32 v52, v52, v70, v71
    v_max3_f32 v52, v52, v72, v73
    v_max3_f32 v52, v52, v74, v75
    v_max3_f32 v52, v52, v76, v77
    v_max3_f32 v52, v52, v78, v79
    v_max3_f32 v53, v53, v80, v81
    v_max3_f32 v53, v53, v82, v83
    v_max3_f32 v53, v53, v84, v85
    v_max3_f32 v53, v53, v86, v87
    v_max3_f32 v53, v53, v88, v89
    v_max3_f32 v53, v53, v90, v91
    v_max3_f32 v53, v53, v92, v93
    v_max3_f32 v53, v53, v94, v95
    s_sub_u32 s89, s89, 1
    s_cmp_lg_u32 s89, 0
    s_cbranch_scc1 L_slow1
    v_mov_b32 v54, v52
    v_mov_b32 v55, v53
    s_nop 1
    v_permlane32_swap_b32 v52, v54
    v_permlane32_swap_b32 v53, v55
    s_nop 1
    v_max_f32 v52, v52, v54
    v_max_f32 v53, v53, v55
    v_sub_f32 v128, 0, v52
    v_sub_f32 v144, 0, v53
    v_sub_f32 v129, 0, v52
    v_sub_f32 v145, 0, v53
    v_sub_f32 v130, 0, v52
    v_sub_f32 v146, 0, v53
    v_sub_f32 v131, 0, v52
    v_sub_f32 v147, 0, v53
    v_sub_f32 v132, 0, v52
    v_sub_f32 v148, 0, v53
    v_sub_f32 v133, 0, v52
    v_sub_f32 v149, 0, v53
    v_sub_f32 v134, 0, v52
    v_sub_f32 v150, 0, v53
    v_sub_f32 v135, 0, v52
    v_sub_f32 v151, 0, v53
    v_sub_f32 v136, 0, v52
    v_sub_f32 v152, 0, v53
    v_sub_f32 v137, 0, v52
    v_sub_f32 v153, 0, v53
    v_sub_f32 v138, 0, v52
    v_sub_f32 v154, 0, v53
    v_sub_f32 v139, 0, v52
    v_sub_f32 v155, 0, v53
    v_sub_f32 v140, 0, v52
    v_sub_f32 v156, 0, v53
    v_sub_f32 v141, 0, v52
    v_sub_f32 v157, 0, v53
    v_sub_f32 v142, 0, v52
    v_sub_f32 v158, 0, v53
    v_sub_f32 v143, 0, v52
    v_sub_f32 v159, 0, v53
    v_mov_b64 v[224:225], 0
    v_mov_b64 v[226:227], 0
    v_mov_b64 v[228:229], 0
    v_mov_b64 v[230:231], 0
    v_mov_b64 v[232:233], 0
    v_mov_b64 v[234:235], 0
    v_mov_b64 v[236:237], 0
    v_mov_b64 v[238:239], 0
    v_mov_b64 v[240:241], 0
    v_mov_b64 v[242:243], 0
    v_mov_b64 v[244:245], 0
    v_mov_b64 v[246:247], 0
    v_mov_b64 v[248:249], 0
    v_mov_b64 v[250:251], 0
    v_mov_b64 v[252:253], 0
    v_mov_b64 v[254:255], 0
    s_mov_b32 s85, 0
    s_mov_b32 s89, 64
L_slow2:
    buffer_load_dwordx4 v[28:31], v9, s[44:47], s85 offen sc1
    buffer_load_dwordx4 v[32:35], v24, s[44:47], s85 offen sc1
    buffer_load_dwordx4 v[36:39], v25, s[44:47], s85 offen sc1
    s_add_u32 s85, s85, 4096
    s_waitcnt vmcnt(0)
    v_mfma_f32_32x32x16_bf16 v[64:79], v[28:31], v[120:123], v[128:143]
    v_mfma_f32_32x32x16_bf16 v[80:95], v[28:31], v[124:127], v[144:159]
    s_nop 15
    v_exp_f32 v64, v64
    v_exp_f32 v65, v65
    v_exp_f32 v66, v66
    v_exp_f32 v67, v67
    v_exp_f32 v68, v68
    v_exp_f32 v69, v69
    v_exp_f32 v70, v70
    v_exp_f32 v71, v71
    v_exp_f32 v72, v72
    v_exp_f32 v73, v73
    v_exp_f32 v74, v74
    v_exp_f32 v75, v75
    v_exp_f32 v76, v76
    v_exp_f32 v77, v77
    v_exp_f32 v78, v78
    v_exp_f32 v79, v79
    v_exp_f32 v80, v80
    v_exp_f32 v81, v81
    v_exp_f32 v82, v82
    v_exp_f32 v83, v83
    v_exp_f32 v84, v84
    v_exp_f32 v85, v85
    v_exp_f32 v86, v86
    v_exp_f32 v87, v87
    v_exp_f32 v88, v88
    v_exp_f32 v89, v89
    v_exp_f32 v90, v90
    v_exp_f32 v91, v91
    v_exp_f32 v92, v92
    v_exp_f32 v93, v93
    v_exp_f32 v94, v94
    v_exp_f32 v95, v95
    s_nop 1
    v_smfmac_f32_32x32x32_bf16 v[224:239], v[32:35], v[64:71], v6
    v_smfmac_f32_32x32x32_bf16 v[224:239], v[36:39], v[72:79], v6
    v_smfmac_f32_32x32x32_bf16 v[240:255], v[32:35], v[80:87], v6
    v_smfmac_f32_32x32x32_bf16 v[240:255], v[36:39], v[88:95], v6
    s_nop 7
    s_sub_u32 s89, s89, 1
    s_cmp_lg_u32 s89, 0
    s_cbranch_scc1 L_slow2
    s_nop 15
    v_rcp_f32 v72, v232
    s_cmp_lg_u32 s49, 0
    v_mul_f32 v64, v224, v72
    v_mul_f32 v65, v225, v72
    v_mul_f32 v66, v226, v72
    v_mul_f32 v67, v227, v72
    v_mul_f32 v68, v228, v72
    v_mul_f32 v69, v229, v72
    v_mul_f32 v70, v230, v72
    v_mul_f32 v71, v231, v72
    v_cvt_pk_bf16_f32 v76, v64, v65
    v_cvt_pk_bf16_f32 v77, v66, v67
    v_cvt_pk_bf16_f32 v78, v68, v69
    v_cvt_pk_bf16_f32 v79, v70, v71
    buffer_store_dwordx4 v[76:79], v7, s[44:47], s72 offen offset:0 sc1
    v_rcp_f32 v88, v248
    s_cmp_lg_u32 s49, 0
    v_mul_f32 v80, v240, v88
    v_mul_f32 v81, v241, v88
    v_mul_f32 v82, v242, v88
    v_mul_f32 v83, v243, v88
    v_mul_f32 v84, v244, v88
    v_mul_f32 v85, v245, v88
    v_mul_f32 v86, v246, v88
    v_mul_f32 v87, v247, v88
    v_cvt_pk_bf16_f32 v92, v80, v81
    v_cvt_pk_bf16_f32 v93, v82, v83
    v_cvt_pk_bf16_f32 v94, v84, v85
    v_cvt_pk_bf16_f32 v95, v86, v87
    buffer_store_dwordx4 v[92:95], v7, s[44:47], s72 offen offset:1024 sc1
    s_branch L_safe
L_g0:
    buffer_store_dword v9, v13, s[16:19], s98 offen sc1
    s_branch L_b0
L_g1:
    buffer_store_dword v27, v13, s[44:47], s83 offen sc1
    s_branch L_b1
L_end:
s_endpgm
.section .rodata,"a"
.p2align 6
.amdhsa_kernel recurrent_scan__grouped_kv_mqa__dense_activation_squared_relu__prompt_kernel
  .amdhsa_next_free_vgpr 256
  .amdhsa_next_free_sgpr 102
  .amdhsa_accum_offset 256
  .amdhsa_group_segment_fixed_size 0
  .amdhsa_kernarg_size 104
  .amdhsa_user_sgpr_count 2
  .amdhsa_user_sgpr_kernarg_segment_ptr 1
  .amdhsa_system_sgpr_workgroup_id_x 1
.end_amdhsa_kernel
```
